```python
import torch

def _softmax(x, axis=-1):
    return torch.softmax(x, dim=axis)
def _gelu(x):
    return torch.nn.functional.gelu(x, approximate="tanh")
def _silu(x):
    return torch.nn.functional.silu(x)
def _sigmoid(x):
    return torch.sigmoid(x)
def _layernorm(x, axis=-1, eps=1e-5):
    m = x.mean(dim=axis, keepdim=True)
    v = x.var(dim=axis, keepdim=True, unbiased=False)
    return (x - m) / torch.sqrt(v + eps)
def _scatter_add(tgt, idx, src, axis=0):
    return tgt.clone().index_add_(axis, idx, src)
def _segment_sum(src, seg, n):
    out = torch.zeros((n,) + src.shape[1:], dtype=src.dtype)
    return out.index_add_(0, seg, src)
def _pad(x, pw):
    flat = tuple(v for pair in reversed(pw) for v in pair)
    return torch.nn.functional.pad(x, flat)

kernel_name = 'standalone__mha_block_cached__near_ridge'

def setup_inputs():

    _w = (lambda a: (lambda t: t.to(torch.bfloat16) if t.is_floating_point() else t)(torch.as_tensor(a)))
    B, Sq, D = 8, 240, 576
    H, Sk, Dh = 32, 1024, 128
    return {
        "x": _w((lambda *s: torch.randn(*s, dtype=torch.bfloat16) * 0.8)(B, Sq, D)),
        "k_cache": _w((lambda *s: torch.randn(*s, dtype=torch.bfloat16) * 0.8)(B, H, Sk, Dh)),
        "v_cache": _w((lambda *s: torch.randn(*s, dtype=torch.bfloat16) * 0.05)(B, H, Sk, Dh)),
        "wq": _w((lambda *s: torch.randn(*s, dtype=torch.bfloat16) * 0.8)(D, H * Dh) * (D ** -0.5)),
        "wo": _w((lambda *s: torch.randn(*s, dtype=torch.bfloat16) * 0.05)(H * Dh, D) * ((H * Dh) ** -0.5)),
    }

def reference(x, k_cache, v_cache, wq, wo):
    B, Sq, D = x.shape
    H, Dh = 32, 128
    q = (lambda x, *d: x.permute(*d))((x @ wq).reshape(B, Sq, H, Dh), 0, 2, 1, 3)
    scores = torch.einsum("bhqd,bhkd->bhqk", q, k_cache) * (Dh ** -0.5)
    p = _softmax(scores, axis=-1)
    o = torch.einsum("bhqk,bhkd->bhqd", p, v_cache)
    return (lambda x, *d: x.permute(*d))(o, 0, 2, 1, 3).reshape(B, Sq, H * Dh) @ wo
```

```asm
; @launch grid=(256,1,1) block=(256,1,1) lds=163840
.amdgcn_target "amdgcn-amd-amdhsa--gfx950"
.text
.globl standalone__mha_block_cached__near_ridge_kernel
.p2align 8
.type standalone__mha_block_cached__near_ridge_kernel,@function
standalone__mha_block_cached__near_ridge_kernel:
    s_cmp_ge_u32 s2, 256
    s_cbranch_scc1 L_end
    s_load_dwordx8 s[80:87], s[0:1], 0
    s_load_dwordx8 s[88:95], s[0:1], 32
    s_lshr_b32 s68, s2, 3
    s_getpc_b64 s[98:99]
    s_lshl_b32 s96, s68, 11
    v_lshl_add_u32 v62, v0, 3, s96
    global_load_dword v61, v62, s[98:99]
    v_and_b32 v1, 63, v0
    v_lshrrev_b32 v30, 6, v0
    s_nop 0
    v_readfirstlane_b32 s40, v30
    s_and_b32 s41, s2, 1
    s_and_b32 s45, s68, 3
    s_lshl2_add_u32 s41, s41, s45
    s_bfe_u32 s63, s2, 0x20001
    s_lshr_b32 s45, s68, 2
    s_lshl3_add_u32 s42, s63, s45
    v_lshrrev_b32 v24, 4, v1
    v_and_b32 v25, 15, v1
    v_mad_u32_u24 v26, v30, 20, v24
    v_lshlrev_b32 v27, 2, v24
    v_xor_b32 v27, v27, v25
    v_lshlrev_b32 v29, 13, v26
    v_lshl_add_u32 v202, v27, 4, v29
    v_add_u32 v203, 31744, v202
    v_add_u32 v204, 63488, v202
    v_add_u32 v205, 98304, v202
    v_add_u32 v206, 130048, v202
    v_add_u32 v207, 161792, v202
    s_mul_i32 s60, s40, 5120
    v_lshrrev_b32 v26, 3, v1
    v_mul_u32_u24 v26, 1152, v26
    v_and_b32 v27, 7, v1
    v_xor_b32 v27, v27, v24
    v_lshl_add_u32 v27, v27, 4, v26
    s_mul_i32 s43, s40, 73728
    s_mul_i32 s44, s40, 18432
    v_add_u32 v26, s44, v27
    v_add_u32 v27, s43, v27
    v_xor_b32 v28, 64, v27
    v_xor_b32 v29, 64, v26
    v_add_u32 v192, 0, v27
    v_add_u32 v193, 8192, v28
    v_add_u32 v194, 16384, v27
    v_add_u32 v195, 24576, v28
    v_add_u32 v196, 36864, v27
    v_add_u32 v197, 45056, v28
    v_add_u32 v198, 53248, v27
    v_add_u32 v199, 61440, v28
    v_add_u32 v200, 221184, v26
    v_add_u32 v201, 229376, v29
    s_lshl_b32 s59, s40, 11
    s_add_u32 s59, s59, 24576
    s_mul_i32 s43, s42, 4
    s_mul_i32 s44, s41, 2
    s_add_u32 s43, s43, s44
    s_and_b32 s43, s43, 7
    s_lshl_b32 s43, s43, 7
    s_add_u32 s70, s43, 0
    s_and_b32 s70, s70, 1023
    s_lshl_b32 s58, s40, 13
    s_lshl_b32 s43, s42, 8
    s_mul_i32 s44, s41, 276480
    s_waitcnt lgkmcnt(0)
    s_add_u32 s8, s86, s43
    s_addc_u32 s9, s87, 0
    s_sub_u32 s10, 4718592, s43
    s_mov_b32 s11, 0x20000
    s_add_u32 s4, s80, s44
    s_addc_u32 s5, s81, 0
    s_mov_b32 s6, 276480
    s_mov_b32 s7, 0x20000
    s_cmp_eq_u32 s40, 3
    s_cbranch_scc1 L_noload
    s_lshl_b32 s47, s70, 12
    s_add_u32 m0, s60, 0
    s_nop 0
    buffer_load_dwordx4 v202, s[8:11], s47 offen offset:0 lds
    buffer_load_dwordx4 v203, s[8:11], s47 offen offset:1024 lds
    buffer_load_dwordx4 v204, s[8:11], s47 offen offset:2048 lds
    s_add_u32 m0, s60, 3072
    s_nop 0
    buffer_load_dwordx4 v205, s[8:11], s47 offen offset:0 lds
    buffer_load_dwordx4 v206, s[8:11], s47 offen offset:1024 lds
    buffer_load_dwordx4 v207, s[8:11], s47 offen offset:2048 lds
    s_add_u32 m0, s58, 114688
    s_nop 0
    buffer_load_dwordx4 v192, s[4:7], s70 offen offset:0 lds
    buffer_load_dwordx4 v193, s[4:7], s70 offen offset:1024 lds
    buffer_load_dwordx4 v194, s[4:7], s70 offen offset:2048 lds
    buffer_load_dwordx4 v195, s[4:7], s70 offen offset:3072 lds
    s_add_u32 m0, s58, 118784
    s_nop 0
    buffer_load_dwordx4 v196, s[4:7], s70 offen offset:0 lds
    buffer_load_dwordx4 v197, s[4:7], s70 offen offset:1024 lds
    buffer_load_dwordx4 v198, s[4:7], s70 offen offset:2048 lds
    buffer_load_dwordx4 v199, s[4:7], s70 offen offset:3072 lds
L_noload:
    s_mul_i32 s43, s42, 4
    s_mul_i32 s44, s41, 2
    s_add_u32 s43, s43, s44
    s_and_b32 s43, s43, 7
    s_lshl_b32 s43, s43, 7
    s_add_u32 s71, s43, 128
    s_and_b32 s71, s71, 1023
    s_add_u32 s72, s43, 256
    s_and_b32 s72, s72, 1023
    s_add_u32 s73, s43, 384
    s_and_b32 s73, s73, 1023
    s_add_u32 s74, s43, 512
    s_and_b32 s74, s74, 1023
    s_add_u32 s75, s43, 640
    s_and_b32 s75, s75, 1023
    s_add_u32 s76, s43, 768
    s_and_b32 s76, s76, 1023
    s_add_u32 s77, s43, 896
    s_and_b32 s77, s77, 1023
    s_movk_i32 s78, 1024
    v_lshlrev_b32 v26, 1, v24
    v_xor_b32 v26, v26, v25
    v_lshlrev_b32 v26, 4, v26
    v_lshl_add_u32 v14, v24, 8, v26
    v_xor_b32 v15, 128, v14
    s_lshl_b32 s54, s40, 12
    s_lshl_b32 s43, s41, 5
    s_add_u32 s43, s43, s42
    s_lshl_b32 s43, s43, 18
    s_add_u32 s12, s82, s43
    s_addc_u32 s13, s83, 0
    s_mov_b32 s14, 262144
    s_mov_b32 s15, 0x20000
    s_add_u32 s16, s84, s43
    s_addc_u32 s17, s85, 0
    s_mov_b32 s18, 262144
    s_mov_b32 s19, 0x20000
    s_add_u32 s20, s12, 16384
    s_addc_u32 s21, s13, 0
    s_mov_b32 s22, 245760
    s_mov_b32 s23, 0x20000
    s_mov_b32 s36, s92
    s_mov_b32 s37, s93
    s_mov_b32 s38, 256
    s_mov_b32 s39, 0x20000
    s_cmp_lg_u32 s2, 0
    s_cbranch_scc1 L_notag
    s_cmp_lg_u32 s40, 3
    s_cbranch_scc1 L_notag
    s_memrealtime s[64:65]
    s_cmp_eq_u32 s2, 0
    s_cselect_b32 s43, 0, 256
    v_lshlrev_b32 v26, 8, v1
    s_waitcnt lgkmcnt(0)
    v_mov_b32 v24, s64
    v_mov_b32 v25, s65
    buffer_store_dwordx2 v[24:25], v26, s[36:39], s43 offen offset:128 sc1
L_notag:
    v_lshrrev_b32 v24, 4, v1
    v_and_b32 v25, 15, v1
    v_lshrrev_b32 v26, 1, v25
    v_xor_b32 v26, v26, v24
    v_lshlrev_b32 v27, 4, v26
    v_lshl_add_u32 v27, v25, 7, v27
    s_sub_u32 s43, s41, s63
    s_sub_u32 s43, s43, 1
    s_and_b32 s43, s43, 3
    s_sub_u32 s43, 3, s43
    s_lshl_b32 s43, s43, 2
    s_lshr_b32 s43, 840172321, s43
    s_add_u32 s80, s40, 0
    s_min_u32 s80, s80, 14
    s_mul_i32 s44, s80, 11
    s_lshr_b32 s44, s44, 5
    s_lshl_b32 s45, s44, 2
    s_lshr_b32 s45, s43, s45
    s_and_b32 s45, s45, 15
    s_sub_u32 s45, s45, s44
    s_mul_i32 s45, s45, 3
    s_add_u32 s80, s80, s45
    s_lshl_b32 s44, s80, 11
    s_add_u32 s44, s44, 81920
    v_add_u32 v208, s44, v27
    v_xor_b32 v209, 64, v208
    s_add_u32 s81, s40, 4
    s_min_u32 s81, s81, 14
    s_mul_i32 s44, s81, 11
    s_lshr_b32 s44, s44, 5
    s_lshl_b32 s45, s44, 2
    s_lshr_b32 s45, s43, s45
    s_and_b32 s45, s45, 15
    s_sub_u32 s45, s45, s44
    s_mul_i32 s45, s45, 3
    s_add_u32 s81, s81, s45
    s_lshl_b32 s44, s81, 11
    s_add_u32 s44, s44, 81920
    v_add_u32 v210, s44, v27
    v_xor_b32 v211, 64, v210
    s_add_u32 s82, s40, 8
    s_min_u32 s82, s82, 14
    s_mul_i32 s44, s82, 11
    s_lshr_b32 s44, s44, 5
    s_lshl_b32 s45, s44, 2
    s_lshr_b32 s45, s43, s45
    s_and_b32 s45, s45, 15
    s_sub_u32 s45, s45, s44
    s_mul_i32 s45, s45, 3
    s_add_u32 s82, s82, s45
    s_lshl_b32 s44, s82, 11
    s_add_u32 s44, s44, 81920
    v_add_u32 v212, s44, v27
    v_xor_b32 v213, 64, v212
    s_add_u32 s83, s40, 12
    s_min_u32 s83, s83, 14
    s_mul_i32 s44, s83, 11
    s_lshr_b32 s44, s44, 5
    s_lshl_b32 s45, s44, 2
    s_lshr_b32 s45, s43, s45
    s_and_b32 s45, s45, 15
    s_sub_u32 s45, s45, s44
    s_mul_i32 s45, s45, 3
    s_add_u32 s83, s83, s45
    s_lshl_b32 s44, s83, 11
    s_add_u32 s44, s44, 81920
    v_add_u32 v214, s44, v27
    v_xor_b32 v215, 64, v214
    v_lshrrev_b32 v26, 2, v25
    v_and_b32 v27, 1, v24
    v_lshl_add_u32 v27, v27, 2, v26
    v_and_b32 v28, 3, v1
    v_lshlrev_b32 v28, 4, v28
    v_lshl_add_u32 v29, v24, 3, v26
    v_lshl_add_u32 v29, v29, 8, v28
    v_xor_b32 v30, 0, v26
    v_lshl_add_u32 v32, v30, 6, v29
    v_add_u32 v33, 8, v32
    v_xor_b32 v30, 1, v26
    v_lshl_add_u32 v34, v30, 6, v29
    v_add_u32 v35, 8, v34
    v_xor_b32 v30, 2, v26
    v_lshl_add_u32 v36, v30, 6, v29
    v_add_u32 v37, 8, v36
    v_xor_b32 v30, 3, v26
    v_lshl_add_u32 v38, v30, 6, v29
    v_add_u32 v39, 8, v38
    s_cmp_eq_u32 s40, 3
    s_cbranch_scc1 L_noload2
    s_add_u32 m0, s59, 114688
    s_nop 0
    buffer_load_dwordx4 v200, s[4:7], s70 offen offset:0 lds
    buffer_load_dwordx4 v201, s[4:7], s70 offen offset:1024 lds
L_noload2:
    s_mov_b32 s24, s94
    s_mov_b32 s25, s95
    s_mov_b32 s26, 50331648
    s_mov_b32 s27, 0x20000
    s_mov_b32 s32, s90
    s_mov_b32 s33, s91
    s_mov_b32 s34, 2211840
    s_mov_b32 s35, 0x20000
    s_mov_b32 s56, 0x3e0293ee
    s_mov_b32 s57, 0x3e0293ee
    s_mov_b32 s55, 0
    v_lshlrev_b32 v16, 4, v1
    s_and_b32 s45, s2, 7
    s_mul_i32 s62, s45, 1966080
    s_and_b32 s43, s41, 3
    s_mul_i32 s43, s43, 15
    s_lshl_b32 s43, s43, 15
    s_and_b32 s44, s42, 7
    s_lshl_b32 s44, s44, 12
    s_add_u32 s43, s43, s44
    s_add_u32 s43, s43, s62
    s_lshl_b32 s80, s80, 15
    s_add_u32 s80, s80, s43
    s_lshl_b32 s81, s81, 15
    s_add_u32 s81, s81, s43
    s_lshl_b32 s82, s82, 15
    s_add_u32 s82, s82, s43
    s_lshl_b32 s83, s83, 15
    s_add_u32 s83, s83, s43
    s_cmp_eq_u32 s40, 3
    s_cselect_b32 s83, 50331648, s83
    s_lshl_b32 s43, s41, 5
    s_add_u32 s43, s43, s42
    s_lshl2_add_u32 s43, s43, s40
    s_lshl_b32 s43, s43, 8
    s_add_u32 s84, s43, 16777216
    s_add_u32 s85, s43, 16777344
    s_min_u32 s43, s68, 29
    s_mul_i32 s44, s43, 43
    s_lshr_b32 s44, s44, 8
    s_mul_i32 s45, s44, 6
    s_sub_u32 s43, s43, s45
    s_mul_i32 s43, s43, 192
    s_mul_i32 s44, s44, 12
    s_lshl_b32 s45, s44, 15
    s_add_u32 s62, s62, s45
    s_and_b32 s45, s2, 1
    s_mul_i32 s45, s45, 60
    s_add_u32 s44, s44, s45
    s_mul_i32 s45, s63, 1179648
    s_add_u32 s45, s45, s43
    s_add_u32 s28, s88, s45
    s_addc_u32 s29, s89, 0
    s_sub_u32 s30, 4718592, s45
    s_mov_b32 s31, 0x20000
    s_lshl_b32 s45, s40, 13
    s_add_u32 s62, s62, s45
    s_add_u32 s45, s63, 1
    s_and_b32 s45, s45, 3
    s_mul_i32 s45, s45, 98304
    s_add_u32 s96, s45, s62
    s_add_u32 s45, s63, 2
    s_and_b32 s45, s45, 3
    s_mul_i32 s45, s45, 98304
    s_add_u32 s97, s45, s62
    s_add_u32 s45, s63, 3
    s_and_b32 s45, s45, 3
    s_mul_i32 s45, s45, 98304
    s_add_u32 s98, s45, s62
    s_add_u32 s45, s63, 4
    s_and_b32 s45, s45, 3
    s_mul_i32 s45, s45, 98304
    s_add_u32 s99, s45, s62
    v_and_b32 v24, 2, v1
    v_mul_u32_u24 v24, 5, v24
    v_add_u32 v24, s44, v24
    v_mul_u32_u24 v24, 137, v24
    v_lshrrev_b32 v24, 11, v24
    v_and_b32 v25, 1, v1
    v_lshl_add_u32 v24, v24, 5, v25
    s_lshl_b32 s45, s63, 3
    s_lshl_b32 s3, s40, 1
    s_add_u32 s45, s45, s3
    v_add_u32 v24, s45, v24
    v_lshlrev_b32 v24, 10, v24
    v_and_b32 v25, 12, v1
    v_lshl_add_u32 v24, v25, 6, v24
    v_add_u32 v58, 16777216, v24
    s_mul_i32 s45, s63, 3
    s_add_u32 s44, s44, s45
    s_mul_i32 s44, s44, 18432
    s_add_u32 s44, s44, s43
    s_lshl_b32 s3, s40, 2
    v_add_u32 v24, 0, v1
    v_mul_u32_u24 v25, 171, v24
    v_lshrrev_b32 v25, 12, v25
    v_mul_u32_u24 v26, 24, v25
    v_sub_u32 v26, v24, v26
    v_and_b32 v28, 12, v25
    v_mad_u32_u24 v25, v28, 3, v25
    v_add_u32 v25, s3, v25
    v_and_b32 v28, 7, v25
    v_xor_b32 v28, v28, v26
    v_mul_u32_u24 v27, 384, v25
    v_lshl_add_u32 v46, v28, 4, v27
    v_mul_u32_u24 v27, 1152, v25
    v_lshl_add_u32 v27, v26, 3, v27
    v_add_u32 v51, s44, v27
    v_add_u32 v24, 64, v1
    v_mul_u32_u24 v25, 171, v24
    v_lshrrev_b32 v25, 12, v25
    v_mul_u32_u24 v26, 24, v25
    v_sub_u32 v26, v24, v26
    v_and_b32 v28, 12, v25
    v_mad_u32_u24 v25, v28, 3, v25
    v_add_u32 v25, s3, v25
    v_and_b32 v28, 7, v25
    v_xor_b32 v28, v28, v26
    v_mul_u32_u24 v27, 384, v25
    v_lshl_add_u32 v47, v28, 4, v27
    v_mul_u32_u24 v27, 1152, v25
    v_lshl_add_u32 v27, v26, 3, v27
    v_add_u32 v52, s44, v27
    v_add_u32 v24, 128, v1
    v_mul_u32_u24 v25, 171, v24
    v_lshrrev_b32 v25, 12, v25
    v_mul_u32_u24 v26, 24, v25
    v_sub_u32 v26, v24, v26
    v_and_b32 v28, 12, v25
    v_mad_u32_u24 v25, v28, 3, v25
    v_add_u32 v25, s3, v25
    v_and_b32 v28, 7, v25
    v_xor_b32 v28, v28, v26
    v_mul_u32_u24 v27, 384, v25
    v_lshl_add_u32 v48, v28, 4, v27
    v_mul_u32_u24 v27, 1152, v25
    v_lshl_add_u32 v27, v26, 3, v27
    v_add_u32 v53, s44, v27
    v_add_u32 v24, 192, v1
    v_mul_u32_u24 v25, 171, v24
    v_lshrrev_b32 v25, 12, v25
    v_mul_u32_u24 v26, 24, v25
    v_sub_u32 v26, v24, v26
    v_and_b32 v28, 12, v25
    v_mad_u32_u24 v25, v28, 3, v25
    v_add_u32 v25, s3, v25
    v_and_b32 v28, 7, v25
    v_xor_b32 v28, v28, v26
    v_mul_u32_u24 v27, 384, v25
    v_lshl_add_u32 v49, v28, 4, v27
    v_mul_u32_u24 v27, 1152, v25
    v_lshl_add_u32 v27, v26, 3, v27
    v_add_u32 v54, s44, v27
    v_add_u32 v24, 256, v1
    v_min_u32 v24, 287, v24
    v_mul_u32_u24 v25, 171, v24
    v_lshrrev_b32 v25, 12, v25
    v_mul_u32_u24 v26, 24, v25
    v_sub_u32 v26, v24, v26
    v_and_b32 v28, 12, v25
    v_mad_u32_u24 v25, v28, 3, v25
    v_add_u32 v25, s3, v25
    v_and_b32 v28, 7, v25
    v_xor_b32 v28, v28, v26
    v_mul_u32_u24 v27, 384, v25
    v_lshl_add_u32 v50, v28, 4, v27
    v_mul_u32_u24 v27, 1152, v25
    v_lshl_add_u32 v27, v26, 3, v27
    v_add_u32 v55, s44, v27
    v_cmp_gt_u32 vcc, 32, v1
    v_mov_b32 v24, 0x7ffffff0
    v_lshrrev_b32 v25, 4, v1
    v_cndmask_b32 v55, v24, v55, vcc
    v_and_b32 v26, 15, v1
    s_mul_i32 s45, s40, 36864
    v_mul_u32_u24 v27, 384, v26
    v_and_b32 v28, 7, v26
    v_xor_b32 v28, v28, v25
    v_lshl_add_u32 v27, v28, 4, v27
    v_add_u32 v19, s45, v27
    v_xor_b32 v18, 64, v19
    v_lshlrev_b32 v17, 26, v25
    v_lshl_add_u32 v17, v26, 3, v17
    s_mul_i32 s69, s40, 36864
    v_lshrrev_b32 v27, 2, v1
    v_and_b32 v28, 3, v1
    v_mul_u32_u24 v29, 192, v27
    v_lshl_add_u32 v29, v28, 3, v29
    v_and_b32 v30, 1, v25
    v_lshl_add_u32 v29, v30, 5, v29
    v_add_u32 v44, s69, v29
    v_xor_b32 v45, 32, v44
    v_add_u32 v27, 0, v1
    v_mul_u32_u24 v28, 171, v27
    v_lshrrev_b32 v28, 11, v28
    v_mul_u32_u24 v29, 12, v28
    v_sub_u32 v27, v27, v29
    v_lshrrev_b32 v29, 1, v28
    v_and_b32 v29, 2, v29
    v_xor_b32 v27, v27, v29
    v_mul_u32_u24 v28, 1152, v28
    v_lshl_add_u32 v41, v27, 4, v28
    v_add_u32 v27, 64, v1
    v_mul_u32_u24 v28, 171, v27
    v_lshrrev_b32 v28, 11, v28
    v_mul_u32_u24 v29, 12, v28
    v_sub_u32 v27, v27, v29
    v_lshrrev_b32 v29, 1, v28
    v_and_b32 v29, 2, v29
    v_xor_b32 v27, v27, v29
    v_mul_u32_u24 v28, 1152, v28
    v_lshl_add_u32 v42, v27, 4, v28
    v_subrev_u32 v42, 1024, v42
    v_add_u32 v27, 128, v1
    v_mul_u32_u24 v28, 171, v27
    v_lshrrev_b32 v28, 11, v28
    v_mul_u32_u24 v29, 12, v28
    v_sub_u32 v27, v27, v29
    v_lshrrev_b32 v29, 1, v28
    v_and_b32 v29, 2, v29
    v_xor_b32 v27, v27, v29
    v_mul_u32_u24 v28, 1152, v28
    v_lshl_add_u32 v43, v27, 4, v28
    v_subrev_u32 v43, 2048, v43
    s_lshl_b32 s45, s2, 11
    s_add_u32 s45, s45, 17301504
    s_lshl_b32 s79, s40, 9
    s_add_u32 s45, s45, s79
    v_and_b32 v24, 1, v1
    v_lshlrev_b32 v24, 7, v24
    v_add_u32 v60, s45, v24
    s_mul_i32 s45, s2, 61440
    s_mul_i32 s79, s40, 5120
    s_add_u32 s79, s79, s45
    s_add_u32 s79, s79, 20971520
    v_lshrrev_b32 v24, 4, v1
    v_and_b32 v25, 15, v1
    v_and_b32 v26, 7, v25
    v_lshlrev_b32 v26, 1, v26
    v_xor_b32 v26, v24, v26
    v_lshlrev_b32 v28, 8, v25
    v_add_u32 v28, 49152, v28
    v_xor_b32 v27, 0, v26
    v_lshl_add_u32 v2, v27, 4, v28
    v_xor_b32 v27, 4, v26
    v_lshl_add_u32 v3, v27, 4, v28
    v_xor_b32 v27, 8, v26
    v_lshl_add_u32 v4, v27, 4, v28
    v_xor_b32 v27, 12, v26
    v_lshl_add_u32 v5, v27, 4, v28
    v_lshrrev_b32 v26, 2, v25
    v_and_b32 v27, 1, v24
    v_lshl_add_u32 v27, v27, 2, v26
    v_and_b32 v28, 3, v1
    v_cmp_eq_u32 vcc, 0, v28
    v_lshlrev_b32 v28, 3, v28
    v_lshl_add_u32 v29, v24, 2, v26
    v_lshl_add_u32 v29, v29, 8, v28
    v_add_u32 v29, 131072, v29
    v_xor_b32 v30, 0, v27
    v_lshl_add_u32 v6, v30, 5, v29
    v_xor_b32 v30, 1, v27
    v_lshl_add_u32 v7, v30, 5, v29
    v_xor_b32 v30, 2, v27
    v_lshl_add_u32 v8, v30, 5, v29
    v_xor_b32 v30, 3, v27
    v_lshl_add_u32 v9, v30, 5, v29
    v_xor_b32 v30, 4, v27
    v_lshl_add_u32 v10, v30, 5, v29
    v_xor_b32 v30, 5, v27
    v_lshl_add_u32 v11, v30, 5, v29
    v_xor_b32 v30, 6, v27
    v_lshl_add_u32 v12, v30, 5, v29
    v_xor_b32 v30, 7, v27
    v_lshl_add_u32 v13, v30, 5, v29
    v_mov_b32 v27, 0x3f803f80
    v_xor_b32 v26, v24, v25
    v_and_b32 v26, 2, v26
    v_cmp_eq_u32 vcc, 0, v26
    v_and_b32 v26, 1, v1
    v_mul_u32_u24 v26, 0xaaaa, v26
    v_add_u32 v59, 0x4444, v26
    v_cndmask_b32 v20, 0, v27, vcc
    v_cndmask_b32 v21, 0, v27, vcc
    v_cndmask_b32 v22, 0, v27, vcc
    v_cndmask_b32 v23, 0, v27, vcc
    s_mov_b32 s48, 49152
    s_mov_b32 s50, -65536
    s_mov_b32 s51, 16384
    s_mov_b32 s52, 32768
    v_accvgpr_write_b32 a0, 0
    v_accvgpr_write_b32 a1, 0
    v_accvgpr_write_b32 a2, 0
    v_accvgpr_write_b32 a3, 0
    v_accvgpr_write_b32 a4, 0
    v_accvgpr_write_b32 a5, 0
    v_accvgpr_write_b32 a6, 0
    v_accvgpr_write_b32 a7, 0
    v_accvgpr_write_b32 a8, 0
    v_accvgpr_write_b32 a9, 0
    v_accvgpr_write_b32 a10, 0
    v_accvgpr_write_b32 a11, 0
    v_accvgpr_write_b32 a12, 0
    v_accvgpr_write_b32 a13, 0
    v_accvgpr_write_b32 a14, 0
    v_accvgpr_write_b32 a15, 0
    v_accvgpr_write_b32 a16, 0
    v_accvgpr_write_b32 a17, 0
    v_accvgpr_write_b32 a18, 0
    v_accvgpr_write_b32 a19, 0
    v_accvgpr_write_b32 a20, 0
    v_accvgpr_write_b32 a21, 0
    v_accvgpr_write_b32 a22, 0
    v_accvgpr_write_b32 a23, 0
    v_accvgpr_write_b32 a24, 0
    v_accvgpr_write_b32 a25, 0
    v_accvgpr_write_b32 a26, 0
    v_accvgpr_write_b32 a27, 0
    v_accvgpr_write_b32 a28, 0
    v_accvgpr_write_b32 a29, 0
    v_accvgpr_write_b32 a30, 0
    v_accvgpr_write_b32 a31, 0
    v_accvgpr_write_b32 a32, 0
    v_accvgpr_write_b32 a33, 0
    v_accvgpr_write_b32 a34, 0
    v_accvgpr_write_b32 a35, 0
    v_accvgpr_write_b32 a36, 0
    v_accvgpr_write_b32 a37, 0
    v_accvgpr_write_b32 a38, 0
    v_accvgpr_write_b32 a39, 0
    v_accvgpr_write_b32 a40, 0
    v_accvgpr_write_b32 a41, 0
    v_accvgpr_write_b32 a42, 0
    v_accvgpr_write_b32 a43, 0
    v_accvgpr_write_b32 a44, 0
    v_accvgpr_write_b32 a45, 0
    v_accvgpr_write_b32 a46, 0
    v_accvgpr_write_b32 a47, 0
    v_accvgpr_write_b32 a48, 0
    v_accvgpr_write_b32 a49, 0
    v_accvgpr_write_b32 a50, 0
    v_accvgpr_write_b32 a51, 0
    v_accvgpr_write_b32 a52, 0
    v_accvgpr_write_b32 a53, 0
    v_accvgpr_write_b32 a54, 0
    v_accvgpr_write_b32 a55, 0
    v_accvgpr_write_b32 a56, 0
    v_accvgpr_write_b32 a57, 0
    v_accvgpr_write_b32 a58, 0
    v_accvgpr_write_b32 a59, 0
    v_accvgpr_write_b32 a60, 0
    v_accvgpr_write_b32 a61, 0
    v_accvgpr_write_b32 a62, 0
    v_accvgpr_write_b32 a63, 0
    v_accvgpr_write_b32 a64, 0
    v_accvgpr_write_b32 a65, 0
    v_accvgpr_write_b32 a66, 0
    v_accvgpr_write_b32 a67, 0
    v_accvgpr_write_b32 a68, 0
    v_accvgpr_write_b32 a69, 0
    v_accvgpr_write_b32 a70, 0
    v_accvgpr_write_b32 a71, 0
    v_accvgpr_write_b32 a72, 0
    v_accvgpr_write_b32 a73, 0
    v_accvgpr_write_b32 a74, 0
    v_accvgpr_write_b32 a75, 0
    v_accvgpr_write_b32 a76, 0
    v_accvgpr_write_b32 a77, 0
    v_accvgpr_write_b32 a78, 0
    v_accvgpr_write_b32 a79, 0
    v_accvgpr_write_b32 a80, 0
    v_accvgpr_write_b32 a81, 0
    v_accvgpr_write_b32 a82, 0
    v_accvgpr_write_b32 a83, 0
    v_accvgpr_write_b32 a84, 0
    v_accvgpr_write_b32 a85, 0
    v_accvgpr_write_b32 a86, 0
    v_accvgpr_write_b32 a87, 0
    v_accvgpr_write_b32 a88, 0
    v_accvgpr_write_b32 a89, 0
    v_accvgpr_write_b32 a90, 0
    v_accvgpr_write_b32 a91, 0
    v_accvgpr_write_b32 a92, 0
    v_accvgpr_write_b32 a93, 0
    v_accvgpr_write_b32 a94, 0
    v_accvgpr_write_b32 a95, 0
    v_accvgpr_write_b32 a96, 0
    v_accvgpr_write_b32 a97, 0
    v_accvgpr_write_b32 a98, 0
    v_accvgpr_write_b32 a99, 0
    v_accvgpr_write_b32 a100, 0
    v_accvgpr_write_b32 a101, 0
    v_accvgpr_write_b32 a102, 0
    v_accvgpr_write_b32 a103, 0
    v_accvgpr_write_b32 a104, 0
    v_accvgpr_write_b32 a105, 0
    v_accvgpr_write_b32 a106, 0
    v_accvgpr_write_b32 a107, 0
    v_accvgpr_write_b32 a108, 0
    v_accvgpr_write_b32 a109, 0
    v_accvgpr_write_b32 a110, 0
    v_accvgpr_write_b32 a111, 0
    v_accvgpr_write_b32 a112, 0
    v_accvgpr_write_b32 a113, 0
    v_accvgpr_write_b32 a114, 0
    v_accvgpr_write_b32 a115, 0
    v_accvgpr_write_b32 a116, 0
    v_accvgpr_write_b32 a117, 0
    v_accvgpr_write_b32 a118, 0
    v_accvgpr_write_b32 a119, 0
    v_accvgpr_write_b32 a120, 0
    v_accvgpr_write_b32 a121, 0
    v_accvgpr_write_b32 a122, 0
    v_accvgpr_write_b32 a123, 0
    v_accvgpr_write_b32 a124, 0
    v_accvgpr_write_b32 a125, 0
    v_accvgpr_write_b32 a126, 0
    v_accvgpr_write_b32 a127, 0
    s_cmp_eq_u32 s40, 3
    s_cbranch_scc1 L_role_q3
L_role_q4:
    s_lshl_b32 s47, s71, 12
    s_add_u32 m0, s60, 16384
    s_nop 0
    buffer_load_dwordx4 v202, s[8:11], s47 offen offset:0 lds
    buffer_load_dwordx4 v203, s[8:11], s47 offen offset:1024 lds
    buffer_load_dwordx4 v204, s[8:11], s47 offen offset:2048 lds
    s_add_u32 m0, s60, 19456
    s_nop 0
    buffer_load_dwordx4 v205, s[8:11], s47 offen offset:0 lds
    buffer_load_dwordx4 v206, s[8:11], s47 offen offset:1024 lds
    buffer_load_dwordx4 v207, s[8:11], s47 offen offset:2048 lds
    s_add_u32 m0, s58, 81920
    s_nop 0
    buffer_load_dwordx4 v192, s[4:7], s71 offen offset:0 lds
    buffer_load_dwordx4 v193, s[4:7], s71 offen offset:1024 lds
    buffer_load_dwordx4 v194, s[4:7], s71 offen offset:2048 lds
    buffer_load_dwordx4 v195, s[4:7], s71 offen offset:3072 lds
    s_add_u32 m0, s58, 86016
    s_nop 0
    buffer_load_dwordx4 v196, s[4:7], s71 offen offset:0 lds
    buffer_load_dwordx4 v197, s[4:7], s71 offen offset:1024 lds
    buffer_load_dwordx4 v198, s[4:7], s71 offen offset:2048 lds
    buffer_load_dwordx4 v199, s[4:7], s71 offen offset:3072 lds
    s_add_u32 m0, s59, 81920
    s_nop 0
    buffer_load_dwordx4 v200, s[4:7], s71 offen offset:0 lds
    buffer_load_dwordx4 v201, s[4:7], s71 offen offset:1024 lds
    s_waitcnt vmcnt(16)
    s_waitcnt lgkmcnt(0)
    s_barrier
    ds_read_b128 a[224:227], v208 offset:32768
    ds_read_b64_tr_b16 a[128:129], v32 offset:0
    ds_read_b64_tr_b16 a[130:131], v32 offset:1024
    ds_read_b128 a[232:235], v210 offset:32768
    ds_read_b128 a[240:243], v212 offset:32768
    ds_read_b128 a[248:251], v214 offset:32768
    ds_read_b64_tr_b16 a[132:133], v33 offset:0
    ds_read_b64_tr_b16 a[134:135], v33 offset:1024
    ds_read_b64_tr_b16 a[136:137], v34 offset:0
    ds_read_b64_tr_b16 a[138:139], v34 offset:1024
    ds_read_b128 a[228:231], v209 offset:32768
    ds_read_b128 a[236:239], v211 offset:32768
    ds_read_b128 a[244:247], v213 offset:32768
    ds_read_b128 a[252:255], v215 offset:32768
    ds_read_b64_tr_b16 a[140:141], v35 offset:0
    ds_read_b64_tr_b16 a[142:143], v35 offset:1024
    s_waitcnt lgkmcnt(10)
    v_mfma_f32_16x16x32_bf16 v[64:67], a[128:131], a[224:227], 0
    ds_read_b64_tr_b16 a[144:145], v36 offset:0
    v_mfma_f32_16x16x32_bf16 v[96:99], a[128:131], a[232:235], 0
    ds_read_b64_tr_b16 a[146:147], v36 offset:1024
    v_mfma_f32_16x16x32_bf16 v[128:131], a[128:131], a[240:243], 0
    s_lshl_b32 s47, s72, 12
    v_mfma_f32_16x16x32_bf16 v[160:163], a[128:131], a[248:251], 0
    s_waitcnt lgkmcnt(10)
    s_add_u32 m0, s60, 32768
    ds_read_b64_tr_b16 a[148:149], v37 offset:0
    v_mfma_f32_16x16x32_bf16 v[68:71], a[132:135], a[224:227], 0
    buffer_load_dwordx4 v202, s[8:11], s47 offen offset:0 lds
    v_mfma_f32_16x16x32_bf16 v[100:103], a[132:135], a[232:235], 0
    ds_read_b64_tr_b16 a[150:151], v37 offset:1024
    buffer_load_dwordx4 v203, s[8:11], s47 offen offset:1024 lds
    v_mfma_f32_16x16x32_bf16 v[132:135], a[132:135], a[240:243], 0
    ds_read_b64_tr_b16 a[152:153], v38 offset:0
    v_mfma_f32_16x16x32_bf16 v[164:167], a[132:135], a[248:251], 0
    s_waitcnt lgkmcnt(11)
    buffer_load_dwordx4 v204, s[8:11], s47 offen offset:2048 lds
    s_add_u32 m0, s60, 35840
    v_mfma_f32_16x16x32_bf16 v[72:75], a[136:139], a[224:227], 0
    ds_read_b64_tr_b16 a[154:155], v38 offset:1024
    buffer_load_dwordx4 v205, s[8:11], s47 offen offset:0 lds
    v_mfma_f32_16x16x32_bf16 v[104:107], a[136:139], a[232:235], 0
    v_mfma_f32_16x16x32_bf16 v[136:139], a[136:139], a[240:243], 0
    ds_read_b64_tr_b16 a[156:157], v39 offset:0
    buffer_load_dwordx4 v206, s[8:11], s47 offen offset:1024 lds
    v_mfma_f32_16x16x32_bf16 v[168:171], a[136:139], a[248:251], 0
    s_waitcnt lgkmcnt(7)
    s_barrier
    ds_read_b64_tr_b16 a[158:159], v39 offset:1024
    buffer_load_dwordx4 v207, s[8:11], s47 offen offset:2048 lds
    v_mfma_f32_16x16x32_bf16 v[76:79], a[140:143], a[224:227], 0
    v_mfma_f32_16x16x32_bf16 v[108:111], a[140:143], a[232:235], 0
    s_add_u32 m0, s58, 114688
    ds_read_b64_tr_b16 a[160:161], v32 offset:8192
    v_mfma_f32_16x16x32_bf16 v[140:143], a[140:143], a[240:243], 0
    buffer_load_dwordx4 v192, s[4:7], s72 offen offset:0 lds
    v_mfma_f32_16x16x32_bf16 v[172:175], a[140:143], a[248:251], 0
    s_waitcnt lgkmcnt(7)
    ds_read_b64_tr_b16 a[162:163], v32 offset:9216
    v_mfma_f32_16x16x32_bf16 v[80:83], a[144:147], a[224:227], 0
    ds_read_b64_tr_b16 a[164:165], v33 offset:8192
    buffer_load_dwordx4 v193, s[4:7], s72 offen offset:1024 lds
    v_mfma_f32_16x16x32_bf16 v[112:115], a[144:147], a[232:235], 0
    v_mfma_f32_16x16x32_bf16 v[144:147], a[144:147], a[240:243], 0
    ds_read_b64_tr_b16 a[166:167], v33 offset:9216
    buffer_load_dwordx4 v194, s[4:7], s72 offen offset:2048 lds
    v_mfma_f32_16x16x32_bf16 v[176:179], a[144:147], a[248:251], 0
    s_waitcnt lgkmcnt(8)
    v_mfma_f32_16x16x32_bf16 v[84:87], a[148:151], a[224:227], 0
    ds_read_b64_tr_b16 a[168:169], v34 offset:8192
    buffer_load_dwordx4 v195, s[4:7], s72 offen offset:3072 lds
    v_mfma_f32_16x16x32_bf16 v[116:119], a[148:151], a[232:235], 0
    s_add_u32 m0, s58, 118784
    ds_read_b64_tr_b16 a[170:171], v34 offset:9216
    v_mfma_f32_16x16x32_bf16 v[148:151], a[148:151], a[240:243], 0
    buffer_load_dwordx4 v196, s[4:7], s72 offen offset:0 lds
    v_mfma_f32_16x16x32_bf16 v[180:183], a[148:151], a[248:251], 0
    s_waitcnt lgkmcnt(8)
    ds_read_b64_tr_b16 a[172:173], v35 offset:8192
    v_mfma_f32_16x16x32_bf16 v[88:91], a[152:155], a[224:227], 0
    buffer_load_dwordx4 v197, s[4:7], s72 offen offset:1024 lds
    v_mfma_f32_16x16x32_bf16 v[120:123], a[152:155], a[232:235], 0
    ds_read_b64_tr_b16 a[174:175], v35 offset:9216
    v_mfma_f32_16x16x32_bf16 v[152:155], a[152:155], a[240:243], 0
    ds_read_b64_tr_b16 a[176:177], v36 offset:8192
    buffer_load_dwordx4 v198, s[4:7], s72 offen offset:2048 lds
    v_mfma_f32_16x16x32_bf16 v[184:187], a[152:155], a[248:251], 0
    s_waitcnt lgkmcnt(9)
    v_mfma_f32_16x16x32_bf16 v[92:95], a[156:159], a[224:227], 0
    ds_read_b64_tr_b16 a[178:179], v36 offset:9216
    buffer_load_dwordx4 v199, s[4:7], s72 offen offset:3072 lds
    v_mfma_f32_16x16x32_bf16 v[124:127], a[156:159], a[232:235], 0
    s_add_u32 m0, s59, 114688
    v_mfma_f32_16x16x32_bf16 v[156:159], a[156:159], a[240:243], 0
    ds_read_b64_tr_b16 a[180:181], v37 offset:8192
    buffer_load_dwordx4 v200, s[4:7], s72 offen offset:0 lds
    v_mfma_f32_16x16x32_bf16 v[188:191], a[156:159], a[248:251], 0
    s_waitcnt lgkmcnt(9)
    ds_read_b64_tr_b16 a[182:183], v37 offset:9216
    v_mfma_f32_16x16x32_bf16 v[64:67], a[160:163], a[228:231], v[64:67]
    buffer_load_dwordx4 v201, s[4:7], s72 offen offset:1024 lds
    v_mfma_f32_16x16x32_bf16 v[96:99], a[160:163], a[236:239], v[96:99]
    ds_read_b64_tr_b16 a[184:185], v38 offset:8192
    v_mfma_f32_16x16x32_bf16 v[128:131], a[160:163], a[244:247], v[128:131]
    v_mfma_f32_16x16x32_bf16 v[160:163], a[160:163], a[252:255], v[160:163]
    s_waitcnt lgkmcnt(9)
    ds_read_b64_tr_b16 a[186:187], v38 offset:9216
    v_mfma_f32_16x16x32_bf16 v[68:71], a[164:167], a[228:231], v[68:71]
    ds_read_b64_tr_b16 a[188:189], v39 offset:8192
    v_mfma_f32_16x16x32_bf16 v[100:103], a[164:167], a[236:239], v[100:103]
    v_mfma_f32_16x16x32_bf16 v[132:135], a[164:167], a[244:247], v[132:135]
    ds_read_b64_tr_b16 a[190:191], v39 offset:9216
    v_mfma_f32_16x16x32_bf16 v[164:167], a[164:167], a[252:255], v[164:167]
    s_waitcnt lgkmcnt(10)
    v_mfma_f32_16x16x32_bf16 v[72:75], a[168:171], a[228:231], v[72:75]
    v_mfma_f32_16x16x32_bf16 v[104:107], a[168:171], a[236:239], v[104:107]
    v_mfma_f32_16x16x32_bf16 v[136:139], a[168:171], a[244:247], v[136:139]
    v_mfma_f32_16x16x32_bf16 v[168:171], a[168:171], a[252:255], v[168:171]
    s_waitcnt lgkmcnt(8)
    v_mfma_f32_16x16x32_bf16 v[76:79], a[172:175], a[228:231], v[76:79]
    v_mfma_f32_16x16x32_bf16 v[108:111], a[172:175], a[236:239], v[108:111]
    v_mfma_f32_16x16x32_bf16 v[140:143], a[172:175], a[244:247], v[140:143]
    v_mfma_f32_16x16x32_bf16 v[172:175], a[172:175], a[252:255], v[172:175]
    s_waitcnt lgkmcnt(6)
    v_mfma_f32_16x16x32_bf16 v[80:83], a[176:179], a[228:231], v[80:83]
    s_waitcnt vmcnt(16)
    s_waitcnt lgkmcnt(0)
    s_barrier
    ds_read_b128 a[192:195], v208 offset:0
    v_mfma_f32_16x16x32_bf16 v[112:115], a[176:179], a[236:239], v[112:115]
    ds_read_b64_tr_b16 a[128:129], v32 offset:16384
    v_mfma_f32_16x16x32_bf16 v[144:147], a[176:179], a[244:247], v[144:147]
    ds_read_b64_tr_b16 a[130:131], v32 offset:17408
    v_mfma_f32_16x16x32_bf16 v[176:179], a[176:179], a[252:255], v[176:179]
    ds_read_b128 a[200:203], v210 offset:0
    v_mfma_f32_16x16x32_bf16 v[84:87], a[180:183], a[228:231], v[84:87]
    ds_read_b128 a[208:211], v212 offset:0
    v_mfma_f32_16x16x32_bf16 v[116:119], a[180:183], a[236:239], v[116:119]
    ds_read_b128 a[216:219], v214 offset:0
    v_mfma_f32_16x16x32_bf16 v[148:151], a[180:183], a[244:247], v[148:151]
    ds_read_b64_tr_b16 a[132:133], v33 offset:16384
    v_mfma_f32_16x16x32_bf16 v[180:183], a[180:183], a[252:255], v[180:183]
    ds_read_b64_tr_b16 a[134:135], v33 offset:17408
    v_mfma_f32_16x16x32_bf16 v[88:91], a[184:187], a[228:231], v[88:91]
    ds_read_b64_tr_b16 a[136:137], v34 offset:16384
    v_mfma_f32_16x16x32_bf16 v[120:123], a[184:187], a[236:239], v[120:123]
    ds_read_b64_tr_b16 a[138:139], v34 offset:17408
    v_mfma_f32_16x16x32_bf16 v[152:155], a[184:187], a[244:247], v[152:155]
    ds_read_b128 a[196:199], v209 offset:0
    v_mfma_f32_16x16x32_bf16 v[184:187], a[184:187], a[252:255], v[184:187]
    ds_read_b128 a[204:207], v211 offset:0
    v_mfma_f32_16x16x32_bf16 v[92:95], a[188:191], a[228:231], v[92:95]
    ds_read_b128 a[212:215], v213 offset:0
    v_mfma_f32_16x16x32_bf16 v[124:127], a[188:191], a[236:239], v[124:127]
    ds_read_b128 a[220:223], v215 offset:0
    v_mfma_f32_16x16x32_bf16 v[156:159], a[188:191], a[244:247], v[156:159]
    ds_read_b64_tr_b16 a[140:141], v35 offset:16384
    v_mfma_f32_16x16x32_bf16 v[188:191], a[188:191], a[252:255], v[188:191]
    ds_read_b64_tr_b16 a[142:143], v35 offset:17408
    s_waitcnt lgkmcnt(10)
    v_mfma_f32_16x16x32_bf16 v[64:67], a[128:131], a[192:195], v[64:67]
    ds_read_b64_tr_b16 a[144:145], v36 offset:16384
    v_mfma_f32_16x16x32_bf16 v[96:99], a[128:131], a[200:203], v[96:99]
    ds_read_b64_tr_b16 a[146:147], v36 offset:17408
    v_mfma_f32_16x16x32_bf16 v[128:131], a[128:131], a[208:211], v[128:131]
    s_lshl_b32 s47, s73, 12
    v_mfma_f32_16x16x32_bf16 v[160:163], a[128:131], a[216:219], v[160:163]
    s_waitcnt lgkmcnt(10)
    s_add_u32 m0, s60, 0
    ds_read_b64_tr_b16 a[148:149], v37 offset:16384
    v_mfma_f32_16x16x32_bf16 v[68:71], a[132:135], a[192:195], v[68:71]
    buffer_load_dwordx4 v202, s[8:11], s47 offen offset:0 lds
    v_mfma_f32_16x16x32_bf16 v[100:103], a[132:135], a[200:203], v[100:103]
    ds_read_b64_tr_b16 a[150:151], v37 offset:17408
    buffer_load_dwordx4 v203, s[8:11], s47 offen offset:1024 lds
    v_mfma_f32_16x16x32_bf16 v[132:135], a[132:135], a[208:211], v[132:135]
    ds_read_b64_tr_b16 a[152:153], v38 offset:16384
    v_mfma_f32_16x16x32_bf16 v[164:167], a[132:135], a[216:219], v[164:167]
    s_waitcnt lgkmcnt(11)
    buffer_load_dwordx4 v204, s[8:11], s47 offen offset:2048 lds
    s_add_u32 m0, s60, 3072
    v_mfma_f32_16x16x32_bf16 v[72:75], a[136:139], a[192:195], v[72:75]
    ds_read_b64_tr_b16 a[154:155], v38 offset:17408
    buffer_load_dwordx4 v205, s[8:11], s47 offen offset:0 lds
    v_mfma_f32_16x16x32_bf16 v[104:107], a[136:139], a[200:203], v[104:107]
    v_mfma_f32_16x16x32_bf16 v[136:139], a[136:139], a[208:211], v[136:139]
    ds_read_b64_tr_b16 a[156:157], v39 offset:16384
    buffer_load_dwordx4 v206, s[8:11], s47 offen offset:1024 lds
    v_mfma_f32_16x16x32_bf16 v[168:171], a[136:139], a[216:219], v[168:171]
    s_waitcnt lgkmcnt(7)
    s_barrier
    ds_read_b64_tr_b16 a[158:159], v39 offset:17408
    buffer_load_dwordx4 v207, s[8:11], s47 offen offset:2048 lds
    v_mfma_f32_16x16x32_bf16 v[76:79], a[140:143], a[192:195], v[76:79]
    v_mfma_f32_16x16x32_bf16 v[108:111], a[140:143], a[200:203], v[108:111]
    s_add_u32 m0, s58, 81920
    ds_read_b64_tr_b16 a[160:161], v32 offset:24576
    v_mfma_f32_16x16x32_bf16 v[140:143], a[140:143], a[208:211], v[140:143]
    buffer_load_dwordx4 v192, s[4:7], s73 offen offset:0 lds
    v_mfma_f32_16x16x32_bf16 v[172:175], a[140:143], a[216:219], v[172:175]
    s_waitcnt lgkmcnt(7)
    ds_read_b64_tr_b16 a[162:163], v32 offset:25600
    v_mfma_f32_16x16x32_bf16 v[80:83], a[144:147], a[192:195], v[80:83]
    ds_read_b64_tr_b16 a[164:165], v33 offset:24576
    buffer_load_dwordx4 v193, s[4:7], s73 offen offset:1024 lds
    v_mfma_f32_16x16x32_bf16 v[112:115], a[144:147], a[200:203], v[112:115]
    v_mfma_f32_16x16x32_bf16 v[144:147], a[144:147], a[208:211], v[144:147]
    ds_read_b64_tr_b16 a[166:167], v33 offset:25600
    buffer_load_dwordx4 v194, s[4:7], s73 offen offset:2048 lds
    v_mfma_f32_16x16x32_bf16 v[176:179], a[144:147], a[216:219], v[176:179]
    s_waitcnt lgkmcnt(8)
    v_mfma_f32_16x16x32_bf16 v[84:87], a[148:151], a[192:195], v[84:87]
    ds_read_b64_tr_b16 a[168:169], v34 offset:24576
    buffer_load_dwordx4 v195, s[4:7], s73 offen offset:3072 lds
    v_mfma_f32_16x16x32_bf16 v[116:119], a[148:151], a[200:203], v[116:119]
    s_add_u32 m0, s58, 86016
    ds_read_b64_tr_b16 a[170:171], v34 offset:25600
    v_mfma_f32_16x16x32_bf16 v[148:151], a[148:151], a[208:211], v[148:151]
    buffer_load_dwordx4 v196, s[4:7], s73 offen offset:0 lds
    v_mfma_f32_16x16x32_bf16 v[180:183], a[148:151], a[216:219], v[180:183]
    s_waitcnt lgkmcnt(8)
    ds_read_b64_tr_b16 a[172:173], v35 offset:24576
    v_mfma_f32_16x16x32_bf16 v[88:91], a[152:155], a[192:195], v[88:91]
    buffer_load_dwordx4 v197, s[4:7], s73 offen offset:1024 lds
    v_mfma_f32_16x16x32_bf16 v[120:123], a[152:155], a[200:203], v[120:123]
    ds_read_b64_tr_b16 a[174:175], v35 offset:25600
    v_mfma_f32_16x16x32_bf16 v[152:155], a[152:155], a[208:211], v[152:155]
    ds_read_b64_tr_b16 a[176:177], v36 offset:24576
    buffer_load_dwordx4 v198, s[4:7], s73 offen offset:2048 lds
    v_mfma_f32_16x16x32_bf16 v[184:187], a[152:155], a[216:219], v[184:187]
    s_waitcnt lgkmcnt(9)
    v_mfma_f32_16x16x32_bf16 v[92:95], a[156:159], a[192:195], v[92:95]
    ds_read_b64_tr_b16 a[178:179], v36 offset:25600
    buffer_load_dwordx4 v199, s[4:7], s73 offen offset:3072 lds
    v_mfma_f32_16x16x32_bf16 v[124:127], a[156:159], a[200:203], v[124:127]
    s_add_u32 m0, s59, 81920
    v_mfma_f32_16x16x32_bf16 v[156:159], a[156:159], a[208:211], v[156:159]
    ds_read_b64_tr_b16 a[180:181], v37 offset:24576
    buffer_load_dwordx4 v200, s[4:7], s73 offen offset:0 lds
    v_mfma_f32_16x16x32_bf16 v[188:191], a[156:159], a[216:219], v[188:191]
    s_waitcnt lgkmcnt(9)
    ds_read_b64_tr_b16 a[182:183], v37 offset:25600
    v_mfma_f32_16x16x32_bf16 v[64:67], a[160:163], a[196:199], v[64:67]
    buffer_load_dwordx4 v201, s[4:7], s73 offen offset:1024 lds
    v_mfma_f32_16x16x32_bf16 v[96:99], a[160:163], a[204:207], v[96:99]
    ds_read_b64_tr_b16 a[184:185], v38 offset:24576
    v_mfma_f32_16x16x32_bf16 v[128:131], a[160:163], a[212:215], v[128:131]
    v_mfma_f32_16x16x32_bf16 v[160:163], a[160:163], a[220:223], v[160:163]
    s_waitcnt lgkmcnt(9)
    ds_read_b64_tr_b16 a[186:187], v38 offset:25600
    v_mfma_f32_16x16x32_bf16 v[68:71], a[164:167], a[196:199], v[68:71]
    ds_read_b64_tr_b16 a[188:189], v39 offset:24576
    v_mfma_f32_16x16x32_bf16 v[100:103], a[164:167], a[204:207], v[100:103]
    v_mfma_f32_16x16x32_bf16 v[132:135], a[164:167], a[212:215], v[132:135]
    ds_read_b64_tr_b16 a[190:191], v39 offset:25600
    v_mfma_f32_16x16x32_bf16 v[164:167], a[164:167], a[220:223], v[164:167]
    s_waitcnt lgkmcnt(10)
    v_mfma_f32_16x16x32_bf16 v[72:75], a[168:171], a[196:199], v[72:75]
    v_mfma_f32_16x16x32_bf16 v[104:107], a[168:171], a[204:207], v[104:107]
    v_mfma_f32_16x16x32_bf16 v[136:139], a[168:171], a[212:215], v[136:139]
    v_mfma_f32_16x16x32_bf16 v[168:171], a[168:171], a[220:223], v[168:171]
    s_waitcnt lgkmcnt(8)
    v_mfma_f32_16x16x32_bf16 v[76:79], a[172:175], a[196:199], v[76:79]
    v_mfma_f32_16x16x32_bf16 v[108:111], a[172:175], a[204:207], v[108:111]
    v_mfma_f32_16x16x32_bf16 v[140:143], a[172:175], a[212:215], v[140:143]
    v_mfma_f32_16x16x32_bf16 v[172:175], a[172:175], a[220:223], v[172:175]
    s_waitcnt lgkmcnt(6)
    v_mfma_f32_16x16x32_bf16 v[80:83], a[176:179], a[196:199], v[80:83]
    s_waitcnt vmcnt(16)
    s_waitcnt lgkmcnt(0)
    s_barrier
    ds_read_b128 a[224:227], v208 offset:32768
    v_mfma_f32_16x16x32_bf16 v[112:115], a[176:179], a[204:207], v[112:115]
    ds_read_b64_tr_b16 a[128:129], v32 offset:32768
    v_mfma_f32_16x16x32_bf16 v[144:147], a[176:179], a[212:215], v[144:147]
    ds_read_b64_tr_b16 a[130:131], v32 offset:33792
    v_mfma_f32_16x16x32_bf16 v[176:179], a[176:179], a[220:223], v[176:179]
    ds_read_b128 a[232:235], v210 offset:32768
    v_mfma_f32_16x16x32_bf16 v[84:87], a[180:183], a[196:199], v[84:87]
    ds_read_b128 a[240:243], v212 offset:32768
    v_mfma_f32_16x16x32_bf16 v[116:119], a[180:183], a[204:207], v[116:119]
    ds_read_b128 a[248:251], v214 offset:32768
    v_mfma_f32_16x16x32_bf16 v[148:151], a[180:183], a[212:215], v[148:151]
    ds_read_b64_tr_b16 a[132:133], v33 offset:32768
    v_mfma_f32_16x16x32_bf16 v[180:183], a[180:183], a[220:223], v[180:183]
    ds_read_b64_tr_b16 a[134:135], v33 offset:33792
    v_mfma_f32_16x16x32_bf16 v[88:91], a[184:187], a[196:199], v[88:91]
    ds_read_b64_tr_b16 a[136:137], v34 offset:32768
    v_mfma_f32_16x16x32_bf16 v[120:123], a[184:187], a[204:207], v[120:123]
    ds_read_b64_tr_b16 a[138:139], v34 offset:33792
    v_mfma_f32_16x16x32_bf16 v[152:155], a[184:187], a[212:215], v[152:155]
    ds_read_b128 a[228:231], v209 offset:32768
    v_mfma_f32_16x16x32_bf16 v[184:187], a[184:187], a[220:223], v[184:187]
    ds_read_b128 a[236:239], v211 offset:32768
    v_mfma_f32_16x16x32_bf16 v[92:95], a[188:191], a[196:199], v[92:95]
    ds_read_b128 a[244:247], v213 offset:32768
    v_mfma_f32_16x16x32_bf16 v[124:127], a[188:191], a[204:207], v[124:127]
    ds_read_b128 a[252:255], v215 offset:32768
    v_mfma_f32_16x16x32_bf16 v[156:159], a[188:191], a[212:215], v[156:159]
    ds_read_b64_tr_b16 a[140:141], v35 offset:32768
    v_mfma_f32_16x16x32_bf16 v[188:191], a[188:191], a[220:223], v[188:191]
    ds_read_b64_tr_b16 a[142:143], v35 offset:33792
    s_waitcnt lgkmcnt(10)
    v_mfma_f32_16x16x32_bf16 v[64:67], a[128:131], a[224:227], v[64:67]
    ds_read_b64_tr_b16 a[144:145], v36 offset:32768
    v_mfma_f32_16x16x32_bf16 v[96:99], a[128:131], a[232:235], v[96:99]
    ds_read_b64_tr_b16 a[146:147], v36 offset:33792
    v_mfma_f32_16x16x32_bf16 v[128:131], a[128:131], a[240:243], v[128:131]
    s_lshl_b32 s47, s74, 12
    v_mfma_f32_16x16x32_bf16 v[160:163], a[128:131], a[248:251], v[160:163]
    s_waitcnt lgkmcnt(10)
    s_add_u32 m0, s60, 16384
    ds_read_b64_tr_b16 a[148:149], v37 offset:32768
    v_mfma_f32_16x16x32_bf16 v[68:71], a[132:135], a[224:227], v[68:71]
    buffer_load_dwordx4 v202, s[8:11], s47 offen offset:0 lds
    v_mfma_f32_16x16x32_bf16 v[100:103], a[132:135], a[232:235], v[100:103]
    ds_read_b64_tr_b16 a[150:151], v37 offset:33792
    buffer_load_dwordx4 v203, s[8:11], s47 offen offset:1024 lds
    v_mfma_f32_16x16x32_bf16 v[132:135], a[132:135], a[240:243], v[132:135]
    ds_read_b64_tr_b16 a[152:153], v38 offset:32768
    v_mfma_f32_16x16x32_bf16 v[164:167], a[132:135], a[248:251], v[164:167]
    s_waitcnt lgkmcnt(11)
    buffer_load_dwordx4 v204, s[8:11], s47 offen offset:2048 lds
    s_add_u32 m0, s60, 19456
    v_mfma_f32_16x16x32_bf16 v[72:75], a[136:139], a[224:227], v[72:75]
    ds_read_b64_tr_b16 a[154:155], v38 offset:33792
    buffer_load_dwordx4 v205, s[8:11], s47 offen offset:0 lds
    v_mfma_f32_16x16x32_bf16 v[104:107], a[136:139], a[232:235], v[104:107]
    v_mfma_f32_16x16x32_bf16 v[136:139], a[136:139], a[240:243], v[136:139]
    ds_read_b64_tr_b16 a[156:157], v39 offset:32768
    buffer_load_dwordx4 v206, s[8:11], s47 offen offset:1024 lds
    v_mfma_f32_16x16x32_bf16 v[168:171], a[136:139], a[248:251], v[168:171]
    s_waitcnt lgkmcnt(7)
    s_barrier
    ds_read_b64_tr_b16 a[158:159], v39 offset:33792
    buffer_load_dwordx4 v207, s[8:11], s47 offen offset:2048 lds
    v_mfma_f32_16x16x32_bf16 v[76:79], a[140:143], a[224:227], v[76:79]
    v_mfma_f32_16x16x32_bf16 v[108:111], a[140:143], a[232:235], v[108:111]
    s_add_u32 m0, s58, 114688
    ds_read_b64_tr_b16 a[160:161], v32 offset:40960
    v_mfma_f32_16x16x32_bf16 v[140:143], a[140:143], a[240:243], v[140:143]
    buffer_load_dwordx4 v192, s[4:7], s74 offen offset:0 lds
    v_mfma_f32_16x16x32_bf16 v[172:175], a[140:143], a[248:251], v[172:175]
    s_waitcnt lgkmcnt(7)
    ds_read_b64_tr_b16 a[162:163], v32 offset:41984
    v_mfma_f32_16x16x32_bf16 v[80:83], a[144:147], a[224:227], v[80:83]
    ds_read_b64_tr_b16 a[164:165], v33 offset:40960
    buffer_load_dwordx4 v193, s[4:7], s74 offen offset:1024 lds
    v_mfma_f32_16x16x32_bf16 v[112:115], a[144:147], a[232:235], v[112:115]
    v_mfma_f32_16x16x32_bf16 v[144:147], a[144:147], a[240:243], v[144:147]
    ds_read_b64_tr_b16 a[166:167], v33 offset:41984
    buffer_load_dwordx4 v194, s[4:7], s74 offen offset:2048 lds
    v_mfma_f32_16x16x32_bf16 v[176:179], a[144:147], a[248:251], v[176:179]
    s_waitcnt lgkmcnt(8)
    v_mfma_f32_16x16x32_bf16 v[84:87], a[148:151], a[224:227], v[84:87]
    ds_read_b64_tr_b16 a[168:169], v34 offset:40960
    buffer_load_dwordx4 v195, s[4:7], s74 offen offset:3072 lds
    v_mfma_f32_16x16x32_bf16 v[116:119], a[148:151], a[232:235], v[116:119]
    s_add_u32 m0, s58, 118784
    ds_read_b64_tr_b16 a[170:171], v34 offset:41984
    v_mfma_f32_16x16x32_bf16 v[148:151], a[148:151], a[240:243], v[148:151]
    buffer_load_dwordx4 v196, s[4:7], s74 offen offset:0 lds
    v_mfma_f32_16x16x32_bf16 v[180:183], a[148:151], a[248:251], v[180:183]
    s_waitcnt lgkmcnt(8)
    ds_read_b64_tr_b16 a[172:173], v35 offset:40960
    v_mfma_f32_16x16x32_bf16 v[88:91], a[152:155], a[224:227], v[88:91]
    buffer_load_dwordx4 v197, s[4:7], s74 offen offset:1024 lds
    v_mfma_f32_16x16x32_bf16 v[120:123], a[152:155], a[232:235], v[120:123]
    ds_read_b64_tr_b16 a[174:175], v35 offset:41984
    v_mfma_f32_16x16x32_bf16 v[152:155], a[152:155], a[240:243], v[152:155]
    ds_read_b64_tr_b16 a[176:177], v36 offset:40960
    buffer_load_dwordx4 v198, s[4:7], s74 offen offset:2048 lds
    v_mfma_f32_16x16x32_bf16 v[184:187], a[152:155], a[248:251], v[184:187]
    s_waitcnt lgkmcnt(9)
    v_mfma_f32_16x16x32_bf16 v[92:95], a[156:159], a[224:227], v[92:95]
    ds_read_b64_tr_b16 a[178:179], v36 offset:41984
    buffer_load_dwordx4 v199, s[4:7], s74 offen offset:3072 lds
    v_mfma_f32_16x16x32_bf16 v[124:127], a[156:159], a[232:235], v[124:127]
    s_add_u32 m0, s59, 114688
    v_mfma_f32_16x16x32_bf16 v[156:159], a[156:159], a[240:243], v[156:159]
    ds_read_b64_tr_b16 a[180:181], v37 offset:40960
    buffer_load_dwordx4 v200, s[4:7], s74 offen offset:0 lds
    v_mfma_f32_16x16x32_bf16 v[188:191], a[156:159], a[248:251], v[188:191]
    s_waitcnt lgkmcnt(9)
    ds_read_b64_tr_b16 a[182:183], v37 offset:41984
    v_mfma_f32_16x16x32_bf16 v[64:67], a[160:163], a[228:231], v[64:67]
    buffer_load_dwordx4 v201, s[4:7], s74 offen offset:1024 lds
    v_mfma_f32_16x16x32_bf16 v[96:99], a[160:163], a[236:239], v[96:99]
    ds_read_b64_tr_b16 a[184:185], v38 offset:40960
    v_mfma_f32_16x16x32_bf16 v[128:131], a[160:163], a[244:247], v[128:131]
    v_mfma_f32_16x16x32_bf16 v[160:163], a[160:163], a[252:255], v[160:163]
    s_waitcnt lgkmcnt(9)
    ds_read_b64_tr_b16 a[186:187], v38 offset:41984
    v_mfma_f32_16x16x32_bf16 v[68:71], a[164:167], a[228:231], v[68:71]
    ds_read_b64_tr_b16 a[188:189], v39 offset:40960
    v_mfma_f32_16x16x32_bf16 v[100:103], a[164:167], a[236:239], v[100:103]
    v_mfma_f32_16x16x32_bf16 v[132:135], a[164:167], a[244:247], v[132:135]
    ds_read_b64_tr_b16 a[190:191], v39 offset:41984
    v_mfma_f32_16x16x32_bf16 v[164:167], a[164:167], a[252:255], v[164:167]
    s_waitcnt lgkmcnt(10)
    v_mfma_f32_16x16x32_bf16 v[72:75], a[168:171], a[228:231], v[72:75]
    v_mfma_f32_16x16x32_bf16 v[104:107], a[168:171], a[236:239], v[104:107]
    v_mfma_f32_16x16x32_bf16 v[136:139], a[168:171], a[244:247], v[136:139]
    v_mfma_f32_16x16x32_bf16 v[168:171], a[168:171], a[252:255], v[168:171]
    s_waitcnt lgkmcnt(8)
    v_mfma_f32_16x16x32_bf16 v[76:79], a[172:175], a[228:231], v[76:79]
    v_mfma_f32_16x16x32_bf16 v[108:111], a[172:175], a[236:239], v[108:111]
    v_mfma_f32_16x16x32_bf16 v[140:143], a[172:175], a[244:247], v[140:143]
    v_mfma_f32_16x16x32_bf16 v[172:175], a[172:175], a[252:255], v[172:175]
    s_waitcnt lgkmcnt(6)
    v_mfma_f32_16x16x32_bf16 v[80:83], a[176:179], a[228:231], v[80:83]
    s_waitcnt vmcnt(16)
    s_waitcnt lgkmcnt(0)
    s_barrier
    ds_read_b128 a[192:195], v208 offset:0
    v_mfma_f32_16x16x32_bf16 v[112:115], a[176:179], a[236:239], v[112:115]
    ds_read_b64_tr_b16 a[128:129], v32 offset:0
    v_mfma_f32_16x16x32_bf16 v[144:147], a[176:179], a[244:247], v[144:147]
    ds_read_b64_tr_b16 a[130:131], v32 offset:1024
    v_mfma_f32_16x16x32_bf16 v[176:179], a[176:179], a[252:255], v[176:179]
    ds_read_b128 a[200:203], v210 offset:0
    v_mfma_f32_16x16x32_bf16 v[84:87], a[180:183], a[228:231], v[84:87]
    ds_read_b128 a[208:211], v212 offset:0
    v_mfma_f32_16x16x32_bf16 v[116:119], a[180:183], a[236:239], v[116:119]
    ds_read_b128 a[216:219], v214 offset:0
    v_mfma_f32_16x16x32_bf16 v[148:151], a[180:183], a[244:247], v[148:151]
    ds_read_b64_tr_b16 a[132:133], v33 offset:0
    v_mfma_f32_16x16x32_bf16 v[180:183], a[180:183], a[252:255], v[180:183]
    ds_read_b64_tr_b16 a[134:135], v33 offset:1024
    v_mfma_f32_16x16x32_bf16 v[88:91], a[184:187], a[228:231], v[88:91]
    ds_read_b64_tr_b16 a[136:137], v34 offset:0
    v_mfma_f32_16x16x32_bf16 v[120:123], a[184:187], a[236:239], v[120:123]
    ds_read_b64_tr_b16 a[138:139], v34 offset:1024
    v_mfma_f32_16x16x32_bf16 v[152:155], a[184:187], a[244:247], v[152:155]
    ds_read_b128 a[196:199], v209 offset:0
    v_mfma_f32_16x16x32_bf16 v[184:187], a[184:187], a[252:255], v[184:187]
    ds_read_b128 a[204:207], v211 offset:0
    v_mfma_f32_16x16x32_bf16 v[92:95], a[188:191], a[228:231], v[92:95]
    ds_read_b128 a[212:215], v213 offset:0
    v_mfma_f32_16x16x32_bf16 v[124:127], a[188:191], a[236:239], v[124:127]
    ds_read_b128 a[220:223], v215 offset:0
    v_mfma_f32_16x16x32_bf16 v[156:159], a[188:191], a[244:247], v[156:159]
    ds_read_b64_tr_b16 a[140:141], v35 offset:0
    v_mfma_f32_16x16x32_bf16 v[188:191], a[188:191], a[252:255], v[188:191]
    ds_read_b64_tr_b16 a[142:143], v35 offset:1024
    s_waitcnt lgkmcnt(10)
    v_mfma_f32_16x16x32_bf16 v[64:67], a[128:131], a[192:195], v[64:67]
    ds_read_b64_tr_b16 a[144:145], v36 offset:0
    v_mfma_f32_16x16x32_bf16 v[96:99], a[128:131], a[200:203], v[96:99]
    ds_read_b64_tr_b16 a[146:147], v36 offset:1024
    v_mfma_f32_16x16x32_bf16 v[128:131], a[128:131], a[208:211], v[128:131]
    s_lshl_b32 s47, s75, 12
    v_mfma_f32_16x16x32_bf16 v[160:163], a[128:131], a[216:219], v[160:163]
    s_waitcnt lgkmcnt(10)
    s_add_u32 m0, s60, 32768
    ds_read_b64_tr_b16 a[148:149], v37 offset:0
    v_mfma_f32_16x16x32_bf16 v[68:71], a[132:135], a[192:195], v[68:71]
    buffer_load_dwordx4 v202, s[8:11], s47 offen offset:0 lds
    v_mfma_f32_16x16x32_bf16 v[100:103], a[132:135], a[200:203], v[100:103]
    ds_read_b64_tr_b16 a[150:151], v37 offset:1024
    buffer_load_dwordx4 v203, s[8:11], s47 offen offset:1024 lds
    v_mfma_f32_16x16x32_bf16 v[132:135], a[132:135], a[208:211], v[132:135]
    ds_read_b64_tr_b16 a[152:153], v38 offset:0
    v_mfma_f32_16x16x32_bf16 v[164:167], a[132:135], a[216:219], v[164:167]
    s_waitcnt lgkmcnt(11)
    buffer_load_dwordx4 v204, s[8:11], s47 offen offset:2048 lds
    s_add_u32 m0, s60, 35840
    v_mfma_f32_16x16x32_bf16 v[72:75], a[136:139], a[192:195], v[72:75]
    ds_read_b64_tr_b16 a[154:155], v38 offset:1024
    buffer_load_dwordx4 v205, s[8:11], s47 offen offset:0 lds
    v_mfma_f32_16x16x32_bf16 v[104:107], a[136:139], a[200:203], v[104:107]
    v_mfma_f32_16x16x32_bf16 v[136:139], a[136:139], a[208:211], v[136:139]
    ds_read_b64_tr_b16 a[156:157], v39 offset:0
    buffer_load_dwordx4 v206, s[8:11], s47 offen offset:1024 lds
    v_mfma_f32_16x16x32_bf16 v[168:171], a[136:139], a[216:219], v[168:171]
    s_waitcnt lgkmcnt(7)
    s_barrier
    ds_read_b64_tr_b16 a[158:159], v39 offset:1024
    buffer_load_dwordx4 v207, s[8:11], s47 offen offset:2048 lds
    v_mfma_f32_16x16x32_bf16 v[76:79], a[140:143], a[192:195], v[76:79]
    v_mfma_f32_16x16x32_bf16 v[108:111], a[140:143], a[200:203], v[108:111]
    s_add_u32 m0, s58, 81920
    ds_read_b64_tr_b16 a[160:161], v32 offset:8192
    v_mfma_f32_16x16x32_bf16 v[140:143], a[140:143], a[208:211], v[140:143]
    buffer_load_dwordx4 v192, s[4:7], s75 offen offset:0 lds
    v_mfma_f32_16x16x32_bf16 v[172:175], a[140:143], a[216:219], v[172:175]
    s_waitcnt lgkmcnt(7)
    ds_read_b64_tr_b16 a[162:163], v32 offset:9216
    v_mfma_f32_16x16x32_bf16 v[80:83], a[144:147], a[192:195], v[80:83]
    ds_read_b64_tr_b16 a[164:165], v33 offset:8192
    buffer_load_dwordx4 v193, s[4:7], s75 offen offset:1024 lds
    v_mfma_f32_16x16x32_bf16 v[112:115], a[144:147], a[200:203], v[112:115]
    v_mfma_f32_16x16x32_bf16 v[144:147], a[144:147], a[208:211], v[144:147]
    ds_read_b64_tr_b16 a[166:167], v33 offset:9216
    buffer_load_dwordx4 v194, s[4:7], s75 offen offset:2048 lds
    v_mfma_f32_16x16x32_bf16 v[176:179], a[144:147], a[216:219], v[176:179]
    s_waitcnt lgkmcnt(8)
    v_mfma_f32_16x16x32_bf16 v[84:87], a[148:151], a[192:195], v[84:87]
    ds_read_b64_tr_b16 a[168:169], v34 offset:8192
    buffer_load_dwordx4 v195, s[4:7], s75 offen offset:3072 lds
    v_mfma_f32_16x16x32_bf16 v[116:119], a[148:151], a[200:203], v[116:119]
    s_add_u32 m0, s58, 86016
    ds_read_b64_tr_b16 a[170:171], v34 offset:9216
    v_mfma_f32_16x16x32_bf16 v[148:151], a[148:151], a[208:211], v[148:151]
    buffer_load_dwordx4 v196, s[4:7], s75 offen offset:0 lds
    v_mfma_f32_16x16x32_bf16 v[180:183], a[148:151], a[216:219], v[180:183]
    s_waitcnt lgkmcnt(8)
    ds_read_b64_tr_b16 a[172:173], v35 offset:8192
    v_mfma_f32_16x16x32_bf16 v[88:91], a[152:155], a[192:195], v[88:91]
    buffer_load_dwordx4 v197, s[4:7], s75 offen offset:1024 lds
    v_mfma_f32_16x16x32_bf16 v[120:123], a[152:155], a[200:203], v[120:123]
    ds_read_b64_tr_b16 a[174:175], v35 offset:9216
    v_mfma_f32_16x16x32_bf16 v[152:155], a[152:155], a[208:211], v[152:155]
    ds_read_b64_tr_b16 a[176:177], v36 offset:8192
    buffer_load_dwordx4 v198, s[4:7], s75 offen offset:2048 lds
    v_mfma_f32_16x16x32_bf16 v[184:187], a[152:155], a[216:219], v[184:187]
    s_waitcnt lgkmcnt(9)
    v_mfma_f32_16x16x32_bf16 v[92:95], a[156:159], a[192:195], v[92:95]
    ds_read_b64_tr_b16 a[178:179], v36 offset:9216
    buffer_load_dwordx4 v199, s[4:7], s75 offen offset:3072 lds
    v_mfma_f32_16x16x32_bf16 v[124:127], a[156:159], a[200:203], v[124:127]
    s_add_u32 m0, s59, 81920
    v_mfma_f32_16x16x32_bf16 v[156:159], a[156:159], a[208:211], v[156:159]
    ds_read_b64_tr_b16 a[180:181], v37 offset:8192
    buffer_load_dwordx4 v200, s[4:7], s75 offen offset:0 lds
    v_mfma_f32_16x16x32_bf16 v[188:191], a[156:159], a[216:219], v[188:191]
    s_waitcnt lgkmcnt(9)
    ds_read_b64_tr_b16 a[182:183], v37 offset:9216
    v_mfma_f32_16x16x32_bf16 v[64:67], a[160:163], a[196:199], v[64:67]
    buffer_load_dwordx4 v201, s[4:7], s75 offen offset:1024 lds
    v_mfma_f32_16x16x32_bf16 v[96:99], a[160:163], a[204:207], v[96:99]
    ds_read_b64_tr_b16 a[184:185], v38 offset:8192
    v_mfma_f32_16x16x32_bf16 v[128:131], a[160:163], a[212:215], v[128:131]
    v_mfma_f32_16x16x32_bf16 v[160:163], a[160:163], a[220:223], v[160:163]
    s_waitcnt lgkmcnt(9)
    ds_read_b64_tr_b16 a[186:187], v38 offset:9216
    v_mfma_f32_16x16x32_bf16 v[68:71], a[164:167], a[196:199], v[68:71]
    ds_read_b64_tr_b16 a[188:189], v39 offset:8192
    v_mfma_f32_16x16x32_bf16 v[100:103], a[164:167], a[204:207], v[100:103]
    v_mfma_f32_16x16x32_bf16 v[132:135], a[164:167], a[212:215], v[132:135]
    ds_read_b64_tr_b16 a[190:191], v39 offset:9216
    v_mfma_f32_16x16x32_bf16 v[164:167], a[164:167], a[220:223], v[164:167]
    s_waitcnt lgkmcnt(10)
    v_mfma_f32_16x16x32_bf16 v[72:75], a[168:171], a[196:199], v[72:75]
    v_mfma_f32_16x16x32_bf16 v[104:107], a[168:171], a[204:207], v[104:107]
    v_mfma_f32_16x16x32_bf16 v[136:139], a[168:171], a[212:215], v[136:139]
    v_mfma_f32_16x16x32_bf16 v[168:171], a[168:171], a[220:223], v[168:171]
    s_waitcnt lgkmcnt(8)
    v_mfma_f32_16x16x32_bf16 v[76:79], a[172:175], a[196:199], v[76:79]
    v_mfma_f32_16x16x32_bf16 v[108:111], a[172:175], a[204:207], v[108:111]
    v_mfma_f32_16x16x32_bf16 v[140:143], a[172:175], a[212:215], v[140:143]
    v_mfma_f32_16x16x32_bf16 v[172:175], a[172:175], a[220:223], v[172:175]
    s_waitcnt lgkmcnt(6)
    v_mfma_f32_16x16x32_bf16 v[80:83], a[176:179], a[196:199], v[80:83]
    s_waitcnt vmcnt(16)
    s_waitcnt lgkmcnt(0)
    s_barrier
    ds_read_b128 a[224:227], v208 offset:32768
    v_mfma_f32_16x16x32_bf16 v[112:115], a[176:179], a[204:207], v[112:115]
    ds_read_b64_tr_b16 a[128:129], v32 offset:16384
    v_mfma_f32_16x16x32_bf16 v[144:147], a[176:179], a[212:215], v[144:147]
    ds_read_b64_tr_b16 a[130:131], v32 offset:17408
    v_mfma_f32_16x16x32_bf16 v[176:179], a[176:179], a[220:223], v[176:179]
    ds_read_b128 a[232:235], v210 offset:32768
    v_mfma_f32_16x16x32_bf16 v[84:87], a[180:183], a[196:199], v[84:87]
    ds_read_b128 a[240:243], v212 offset:32768
    v_mfma_f32_16x16x32_bf16 v[116:119], a[180:183], a[204:207], v[116:119]
    ds_read_b128 a[248:251], v214 offset:32768
    v_mfma_f32_16x16x32_bf16 v[148:151], a[180:183], a[212:215], v[148:151]
    ds_read_b64_tr_b16 a[132:133], v33 offset:16384
    v_mfma_f32_16x16x32_bf16 v[180:183], a[180:183], a[220:223], v[180:183]
    ds_read_b64_tr_b16 a[134:135], v33 offset:17408
    v_mfma_f32_16x16x32_bf16 v[88:91], a[184:187], a[196:199], v[88:91]
    ds_read_b64_tr_b16 a[136:137], v34 offset:16384
    v_mfma_f32_16x16x32_bf16 v[120:123], a[184:187], a[204:207], v[120:123]
    ds_read_b64_tr_b16 a[138:139], v34 offset:17408
    v_mfma_f32_16x16x32_bf16 v[152:155], a[184:187], a[212:215], v[152:155]
    ds_read_b128 a[228:231], v209 offset:32768
    v_mfma_f32_16x16x32_bf16 v[184:187], a[184:187], a[220:223], v[184:187]
    ds_read_b128 a[236:239], v211 offset:32768
    v_mfma_f32_16x16x32_bf16 v[92:95], a[188:191], a[196:199], v[92:95]
    ds_read_b128 a[244:247], v213 offset:32768
    v_mfma_f32_16x16x32_bf16 v[124:127], a[188:191], a[204:207], v[124:127]
    ds_read_b128 a[252:255], v215 offset:32768
    v_mfma_f32_16x16x32_bf16 v[156:159], a[188:191], a[212:215], v[156:159]
    ds_read_b64_tr_b16 a[140:141], v35 offset:16384
    v_mfma_f32_16x16x32_bf16 v[188:191], a[188:191], a[220:223], v[188:191]
    ds_read_b64_tr_b16 a[142:143], v35 offset:17408
    s_waitcnt lgkmcnt(10)
    v_mfma_f32_16x16x32_bf16 v[64:67], a[128:131], a[224:227], v[64:67]
    ds_read_b64_tr_b16 a[144:145], v36 offset:16384
    v_mfma_f32_16x16x32_bf16 v[96:99], a[128:131], a[232:235], v[96:99]
    ds_read_b64_tr_b16 a[146:147], v36 offset:17408
    v_mfma_f32_16x16x32_bf16 v[128:131], a[128:131], a[240:243], v[128:131]
    s_lshl_b32 s47, s76, 12
    v_mfma_f32_16x16x32_bf16 v[160:163], a[128:131], a[248:251], v[160:163]
    s_waitcnt lgkmcnt(10)
    s_add_u32 m0, s60, 0
    ds_read_b64_tr_b16 a[148:149], v37 offset:16384
    v_mfma_f32_16x16x32_bf16 v[68:71], a[132:135], a[224:227], v[68:71]
    buffer_load_dwordx4 v202, s[8:11], s47 offen offset:0 lds
    v_mfma_f32_16x16x32_bf16 v[100:103], a[132:135], a[232:235], v[100:103]
    ds_read_b64_tr_b16 a[150:151], v37 offset:17408
    buffer_load_dwordx4 v203, s[8:11], s47 offen offset:1024 lds
    v_mfma_f32_16x16x32_bf16 v[132:135], a[132:135], a[240:243], v[132:135]
    ds_read_b64_tr_b16 a[152:153], v38 offset:16384
    v_mfma_f32_16x16x32_bf16 v[164:167], a[132:135], a[248:251], v[164:167]
    s_waitcnt lgkmcnt(11)
    buffer_load_dwordx4 v204, s[8:11], s47 offen offset:2048 lds
    s_add_u32 m0, s60, 3072
    v_mfma_f32_16x16x32_bf16 v[72:75], a[136:139], a[224:227], v[72:75]
    ds_read_b64_tr_b16 a[154:155], v38 offset:17408
    buffer_load_dwordx4 v205, s[8:11], s47 offen offset:0 lds
    v_mfma_f32_16x16x32_bf16 v[104:107], a[136:139], a[232:235], v[104:107]
    v_mfma_f32_16x16x32_bf16 v[136:139], a[136:139], a[240:243], v[136:139]
    ds_read_b64_tr_b16 a[156:157], v39 offset:16384
    buffer_load_dwordx4 v206, s[8:11], s47 offen offset:1024 lds
    v_mfma_f32_16x16x32_bf16 v[168:171], a[136:139], a[248:251], v[168:171]
    s_waitcnt lgkmcnt(7)
    s_barrier
    ds_read_b64_tr_b16 a[158:159], v39 offset:17408
    buffer_load_dwordx4 v207, s[8:11], s47 offen offset:2048 lds
    v_mfma_f32_16x16x32_bf16 v[76:79], a[140:143], a[224:227], v[76:79]
    v_mfma_f32_16x16x32_bf16 v[108:111], a[140:143], a[232:235], v[108:111]
    s_add_u32 m0, s58, 114688
    ds_read_b64_tr_b16 a[160:161], v32 offset:24576
    v_mfma_f32_16x16x32_bf16 v[140:143], a[140:143], a[240:243], v[140:143]
    buffer_load_dwordx4 v192, s[4:7], s76 offen offset:0 lds
    v_mfma_f32_16x16x32_bf16 v[172:175], a[140:143], a[248:251], v[172:175]
    s_waitcnt lgkmcnt(7)
    ds_read_b64_tr_b16 a[162:163], v32 offset:25600
    v_mfma_f32_16x16x32_bf16 v[80:83], a[144:147], a[224:227], v[80:83]
    ds_read_b64_tr_b16 a[164:165], v33 offset:24576
    buffer_load_dwordx4 v193, s[4:7], s76 offen offset:1024 lds
    v_mfma_f32_16x16x32_bf16 v[112:115], a[144:147], a[232:235], v[112:115]
    v_mfma_f32_16x16x32_bf16 v[144:147], a[144:147], a[240:243], v[144:147]
    ds_read_b64_tr_b16 a[166:167], v33 offset:25600
    buffer_load_dwordx4 v194, s[4:7], s76 offen offset:2048 lds
    v_mfma_f32_16x16x32_bf16 v[176:179], a[144:147], a[248:251], v[176:179]
    s_waitcnt lgkmcnt(8)
    v_mfma_f32_16x16x32_bf16 v[84:87], a[148:151], a[224:227], v[84:87]
    ds_read_b64_tr_b16 a[168:169], v34 offset:24576
    buffer_load_dwordx4 v195, s[4:7], s76 offen offset:3072 lds
    v_mfma_f32_16x16x32_bf16 v[116:119], a[148:151], a[232:235], v[116:119]
    s_add_u32 m0, s58, 118784
    ds_read_b64_tr_b16 a[170:171], v34 offset:25600
    v_mfma_f32_16x16x32_bf16 v[148:151], a[148:151], a[240:243], v[148:151]
    buffer_load_dwordx4 v196, s[4:7], s76 offen offset:0 lds
    v_mfma_f32_16x16x32_bf16 v[180:183], a[148:151], a[248:251], v[180:183]
    s_waitcnt lgkmcnt(8)
    ds_read_b64_tr_b16 a[172:173], v35 offset:24576
    v_mfma_f32_16x16x32_bf16 v[88:91], a[152:155], a[224:227], v[88:91]
    buffer_load_dwordx4 v197, s[4:7], s76 offen offset:1024 lds
    v_mfma_f32_16x16x32_bf16 v[120:123], a[152:155], a[232:235], v[120:123]
    ds_read_b64_tr_b16 a[174:175], v35 offset:25600
    v_mfma_f32_16x16x32_bf16 v[152:155], a[152:155], a[240:243], v[152:155]
    ds_read_b64_tr_b16 a[176:177], v36 offset:24576
    buffer_load_dwordx4 v198, s[4:7], s76 offen offset:2048 lds
    v_mfma_f32_16x16x32_bf16 v[184:187], a[152:155], a[248:251], v[184:187]
    s_waitcnt lgkmcnt(9)
    v_mfma_f32_16x16x32_bf16 v[92:95], a[156:159], a[224:227], v[92:95]
    ds_read_b64_tr_b16 a[178:179], v36 offset:25600
    buffer_load_dwordx4 v199, s[4:7], s76 offen offset:3072 lds
    v_mfma_f32_16x16x32_bf16 v[124:127], a[156:159], a[232:235], v[124:127]
    s_add_u32 m0, s59, 114688
    v_mfma_f32_16x16x32_bf16 v[156:159], a[156:159], a[240:243], v[156:159]
    ds_read_b64_tr_b16 a[180:181], v37 offset:24576
    buffer_load_dwordx4 v200, s[4:7], s76 offen offset:0 lds
    v_mfma_f32_16x16x32_bf16 v[188:191], a[156:159], a[248:251], v[188:191]
    s_waitcnt lgkmcnt(9)
    ds_read_b64_tr_b16 a[182:183], v37 offset:25600
    v_mfma_f32_16x16x32_bf16 v[64:67], a[160:163], a[228:231], v[64:67]
    buffer_load_dwordx4 v201, s[4:7], s76 offen offset:1024 lds
    v_mfma_f32_16x16x32_bf16 v[96:99], a[160:163], a[236:239], v[96:99]
    ds_read_b64_tr_b16 a[184:185], v38 offset:24576
    v_mfma_f32_16x16x32_bf16 v[128:131], a[160:163], a[244:247], v[128:131]
    v_mfma_f32_16x16x32_bf16 v[160:163], a[160:163], a[252:255], v[160:163]
    s_waitcnt lgkmcnt(9)
    ds_read_b64_tr_b16 a[186:187], v38 offset:25600
    v_mfma_f32_16x16x32_bf16 v[68:71], a[164:167], a[228:231], v[68:71]
    ds_read_b64_tr_b16 a[188:189], v39 offset:24576
    v_mfma_f32_16x16x32_bf16 v[100:103], a[164:167], a[236:239], v[100:103]
    v_mfma_f32_16x16x32_bf16 v[132:135], a[164:167], a[244:247], v[132:135]
    ds_read_b64_tr_b16 a[190:191], v39 offset:25600
    v_mfma_f32_16x16x32_bf16 v[164:167], a[164:167], a[252:255], v[164:167]
    s_waitcnt lgkmcnt(10)
    v_mfma_f32_16x16x32_bf16 v[72:75], a[168:171], a[228:231], v[72:75]
    v_mfma_f32_16x16x32_bf16 v[104:107], a[168:171], a[236:239], v[104:107]
    v_mfma_f32_16x16x32_bf16 v[136:139], a[168:171], a[244:247], v[136:139]
    v_mfma_f32_16x16x32_bf16 v[168:171], a[168:171], a[252:255], v[168:171]
    s_waitcnt lgkmcnt(8)
    v_mfma_f32_16x16x32_bf16 v[76:79], a[172:175], a[228:231], v[76:79]
    v_mfma_f32_16x16x32_bf16 v[108:111], a[172:175], a[236:239], v[108:111]
    v_mfma_f32_16x16x32_bf16 v[140:143], a[172:175], a[244:247], v[140:143]
    v_mfma_f32_16x16x32_bf16 v[172:175], a[172:175], a[252:255], v[172:175]
    s_waitcnt lgkmcnt(6)
    v_mfma_f32_16x16x32_bf16 v[80:83], a[176:179], a[228:231], v[80:83]
    s_waitcnt vmcnt(16)
    s_waitcnt lgkmcnt(0)
    s_barrier
    ds_read_b128 a[192:195], v208 offset:0
    v_mfma_f32_16x16x32_bf16 v[112:115], a[176:179], a[236:239], v[112:115]
    ds_read_b64_tr_b16 a[128:129], v32 offset:32768
    v_mfma_f32_16x16x32_bf16 v[144:147], a[176:179], a[244:247], v[144:147]
    ds_read_b64_tr_b16 a[130:131], v32 offset:33792
    v_mfma_f32_16x16x32_bf16 v[176:179], a[176:179], a[252:255], v[176:179]
    ds_read_b128 a[200:203], v210 offset:0
    v_mfma_f32_16x16x32_bf16 v[84:87], a[180:183], a[228:231], v[84:87]
    ds_read_b128 a[208:211], v212 offset:0
    v_mfma_f32_16x16x32_bf16 v[116:119], a[180:183], a[236:239], v[116:119]
    ds_read_b128 a[216:219], v214 offset:0
    v_mfma_f32_16x16x32_bf16 v[148:151], a[180:183], a[244:247], v[148:151]
    ds_read_b64_tr_b16 a[132:133], v33 offset:32768
    v_mfma_f32_16x16x32_bf16 v[180:183], a[180:183], a[252:255], v[180:183]
    ds_read_b64_tr_b16 a[134:135], v33 offset:33792
    v_mfma_f32_16x16x32_bf16 v[88:91], a[184:187], a[228:231], v[88:91]
    ds_read_b64_tr_b16 a[136:137], v34 offset:32768
    v_mfma_f32_16x16x32_bf16 v[120:123], a[184:187], a[236:239], v[120:123]
    ds_read_b64_tr_b16 a[138:139], v34 offset:33792
    v_mfma_f32_16x16x32_bf16 v[152:155], a[184:187], a[244:247], v[152:155]
    ds_read_b128 a[196:199], v209 offset:0
    v_mfma_f32_16x16x32_bf16 v[184:187], a[184:187], a[252:255], v[184:187]
    ds_read_b128 a[204:207], v211 offset:0
    v_mfma_f32_16x16x32_bf16 v[92:95], a[188:191], a[228:231], v[92:95]
    ds_read_b128 a[212:215], v213 offset:0
    v_mfma_f32_16x16x32_bf16 v[124:127], a[188:191], a[236:239], v[124:127]
    ds_read_b128 a[220:223], v215 offset:0
    v_mfma_f32_16x16x32_bf16 v[156:159], a[188:191], a[244:247], v[156:159]
    ds_read_b64_tr_b16 a[140:141], v35 offset:32768
    v_mfma_f32_16x16x32_bf16 v[188:191], a[188:191], a[252:255], v[188:191]
    ds_read_b64_tr_b16 a[142:143], v35 offset:33792
    s_waitcnt lgkmcnt(10)
    v_mfma_f32_16x16x32_bf16 v[64:67], a[128:131], a[192:195], v[64:67]
    ds_read_b64_tr_b16 a[144:145], v36 offset:32768
    v_mfma_f32_16x16x32_bf16 v[96:99], a[128:131], a[200:203], v[96:99]
    ds_read_b64_tr_b16 a[146:147], v36 offset:33792
    v_mfma_f32_16x16x32_bf16 v[128:131], a[128:131], a[208:211], v[128:131]
    s_lshl_b32 s47, s77, 12
    v_mfma_f32_16x16x32_bf16 v[160:163], a[128:131], a[216:219], v[160:163]
    s_waitcnt lgkmcnt(10)
    s_add_u32 m0, s60, 16384
    ds_read_b64_tr_b16 a[148:149], v37 offset:32768
    v_mfma_f32_16x16x32_bf16 v[68:71], a[132:135], a[192:195], v[68:71]
    buffer_load_dwordx4 v202, s[8:11], s47 offen offset:0 lds
    v_mfma_f32_16x16x32_bf16 v[100:103], a[132:135], a[200:203], v[100:103]
    ds_read_b64_tr_b16 a[150:151], v37 offset:33792
    buffer_load_dwordx4 v203, s[8:11], s47 offen offset:1024 lds
    v_mfma_f32_16x16x32_bf16 v[132:135], a[132:135], a[208:211], v[132:135]
    ds_read_b64_tr_b16 a[152:153], v38 offset:32768
    v_mfma_f32_16x16x32_bf16 v[164:167], a[132:135], a[216:219], v[164:167]
    s_waitcnt lgkmcnt(11)
    buffer_load_dwordx4 v204, s[8:11], s47 offen offset:2048 lds
    s_add_u32 m0, s60, 19456
    v_mfma_f32_16x16x32_bf16 v[72:75], a[136:139], a[192:195], v[72:75]
    ds_read_b64_tr_b16 a[154:155], v38 offset:33792
    buffer_load_dwordx4 v205, s[8:11], s47 offen offset:0 lds
    v_mfma_f32_16x16x32_bf16 v[104:107], a[136:139], a[200:203], v[104:107]
    v_mfma_f32_16x16x32_bf16 v[136:139], a[136:139], a[208:211], v[136:139]
    ds_read_b64_tr_b16 a[156:157], v39 offset:32768
    buffer_load_dwordx4 v206, s[8:11], s47 offen offset:1024 lds
    v_mfma_f32_16x16x32_bf16 v[168:171], a[136:139], a[216:219], v[168:171]
    s_waitcnt lgkmcnt(7)
    s_barrier
    ds_read_b64_tr_b16 a[158:159], v39 offset:33792
    buffer_load_dwordx4 v207, s[8:11], s47 offen offset:2048 lds
    v_mfma_f32_16x16x32_bf16 v[76:79], a[140:143], a[192:195], v[76:79]
    v_mfma_f32_16x16x32_bf16 v[108:111], a[140:143], a[200:203], v[108:111]
    s_add_u32 m0, s58, 81920
    ds_read_b64_tr_b16 a[160:161], v32 offset:40960
    v_mfma_f32_16x16x32_bf16 v[140:143], a[140:143], a[208:211], v[140:143]
    buffer_load_dwordx4 v192, s[4:7], s77 offen offset:0 lds
    v_mfma_f32_16x16x32_bf16 v[172:175], a[140:143], a[216:219], v[172:175]
    s_waitcnt lgkmcnt(7)
    ds_read_b64_tr_b16 a[162:163], v32 offset:41984
    v_mfma_f32_16x16x32_bf16 v[80:83], a[144:147], a[192:195], v[80:83]
    ds_read_b64_tr_b16 a[164:165], v33 offset:40960
    buffer_load_dwordx4 v193, s[4:7], s77 offen offset:1024 lds
    v_mfma_f32_16x16x32_bf16 v[112:115], a[144:147], a[200:203], v[112:115]
    v_mfma_f32_16x16x32_bf16 v[144:147], a[144:147], a[208:211], v[144:147]
    ds_read_b64_tr_b16 a[166:167], v33 offset:41984
    buffer_load_dwordx4 v194, s[4:7], s77 offen offset:2048 lds
    v_mfma_f32_16x16x32_bf16 v[176:179], a[144:147], a[216:219], v[176:179]
    s_waitcnt lgkmcnt(8)
    v_mfma_f32_16x16x32_bf16 v[84:87], a[148:151], a[192:195], v[84:87]
    ds_read_b64_tr_b16 a[168:169], v34 offset:40960
    buffer_load_dwordx4 v195, s[4:7], s77 offen offset:3072 lds
    v_mfma_f32_16x16x32_bf16 v[116:119], a[148:151], a[200:203], v[116:119]
    s_add_u32 m0, s58, 86016
    ds_read_b64_tr_b16 a[170:171], v34 offset:41984
    v_mfma_f32_16x16x32_bf16 v[148:151], a[148:151], a[208:211], v[148:151]
    buffer_load_dwordx4 v196, s[4:7], s77 offen offset:0 lds
    v_mfma_f32_16x16x32_bf16 v[180:183], a[148:151], a[216:219], v[180:183]
    s_waitcnt lgkmcnt(8)
    ds_read_b64_tr_b16 a[172:173], v35 offset:40960
    v_mfma_f32_16x16x32_bf16 v[88:91], a[152:155], a[192:195], v[88:91]
    buffer_load_dwordx4 v197, s[4:7], s77 offen offset:1024 lds
    v_mfma_f32_16x16x32_bf16 v[120:123], a[152:155], a[200:203], v[120:123]
    ds_read_b64_tr_b16 a[174:175], v35 offset:41984
    v_mfma_f32_16x16x32_bf16 v[152:155], a[152:155], a[208:211], v[152:155]
    ds_read_b64_tr_b16 a[176:177], v36 offset:40960
    buffer_load_dwordx4 v198, s[4:7], s77 offen offset:2048 lds
    v_mfma_f32_16x16x32_bf16 v[184:187], a[152:155], a[216:219], v[184:187]
    s_waitcnt lgkmcnt(9)
    v_mfma_f32_16x16x32_bf16 v[92:95], a[156:159], a[192:195], v[92:95]
    ds_read_b64_tr_b16 a[178:179], v36 offset:41984
    buffer_load_dwordx4 v199, s[4:7], s77 offen offset:3072 lds
    v_mfma_f32_16x16x32_bf16 v[124:127], a[156:159], a[200:203], v[124:127]
    s_add_u32 m0, s59, 81920
    v_mfma_f32_16x16x32_bf16 v[156:159], a[156:159], a[208:211], v[156:159]
    ds_read_b64_tr_b16 a[180:181], v37 offset:40960
    buffer_load_dwordx4 v200, s[4:7], s77 offen offset:0 lds
    v_mfma_f32_16x16x32_bf16 v[188:191], a[156:159], a[216:219], v[188:191]
    s_waitcnt lgkmcnt(9)
    ds_read_b64_tr_b16 a[182:183], v37 offset:41984
    v_mfma_f32_16x16x32_bf16 v[64:67], a[160:163], a[196:199], v[64:67]
    buffer_load_dwordx4 v201, s[4:7], s77 offen offset:1024 lds
    v_mfma_f32_16x16x32_bf16 v[96:99], a[160:163], a[204:207], v[96:99]
    ds_read_b64_tr_b16 a[184:185], v38 offset:40960
    v_mfma_f32_16x16x32_bf16 v[128:131], a[160:163], a[212:215], v[128:131]
    v_mfma_f32_16x16x32_bf16 v[160:163], a[160:163], a[220:223], v[160:163]
    s_waitcnt lgkmcnt(9)
    ds_read_b64_tr_b16 a[186:187], v38 offset:41984
    v_mfma_f32_16x16x32_bf16 v[68:71], a[164:167], a[196:199], v[68:71]
    ds_read_b64_tr_b16 a[188:189], v39 offset:40960
    v_mfma_f32_16x16x32_bf16 v[100:103], a[164:167], a[204:207], v[100:103]
    v_mfma_f32_16x16x32_bf16 v[132:135], a[164:167], a[212:215], v[132:135]
    ds_read_b64_tr_b16 a[190:191], v39 offset:41984
    v_mfma_f32_16x16x32_bf16 v[164:167], a[164:167], a[220:223], v[164:167]
    s_waitcnt lgkmcnt(10)
    v_mfma_f32_16x16x32_bf16 v[72:75], a[168:171], a[196:199], v[72:75]
    v_mfma_f32_16x16x32_bf16 v[104:107], a[168:171], a[204:207], v[104:107]
    v_mfma_f32_16x16x32_bf16 v[136:139], a[168:171], a[212:215], v[136:139]
    v_mfma_f32_16x16x32_bf16 v[168:171], a[168:171], a[220:223], v[168:171]
    s_waitcnt lgkmcnt(8)
    v_mfma_f32_16x16x32_bf16 v[76:79], a[172:175], a[196:199], v[76:79]
    v_mfma_f32_16x16x32_bf16 v[108:111], a[172:175], a[204:207], v[108:111]
    v_mfma_f32_16x16x32_bf16 v[140:143], a[172:175], a[212:215], v[140:143]
    v_mfma_f32_16x16x32_bf16 v[172:175], a[172:175], a[220:223], v[172:175]
    s_waitcnt lgkmcnt(6)
    v_mfma_f32_16x16x32_bf16 v[80:83], a[176:179], a[196:199], v[80:83]
    s_waitcnt vmcnt(16)
    s_waitcnt lgkmcnt(0)
    s_barrier
    ds_read_b128 a[224:227], v208 offset:32768
    v_mfma_f32_16x16x32_bf16 v[112:115], a[176:179], a[204:207], v[112:115]
    ds_read_b64_tr_b16 a[128:129], v32 offset:0
    v_mfma_f32_16x16x32_bf16 v[144:147], a[176:179], a[212:215], v[144:147]
    ds_read_b64_tr_b16 a[130:131], v32 offset:1024
    v_mfma_f32_16x16x32_bf16 v[176:179], a[176:179], a[220:223], v[176:179]
    ds_read_b128 a[232:235], v210 offset:32768
    v_mfma_f32_16x16x32_bf16 v[84:87], a[180:183], a[196:199], v[84:87]
    ds_read_b128 a[240:243], v212 offset:32768
    v_mfma_f32_16x16x32_bf16 v[116:119], a[180:183], a[204:207], v[116:119]
    ds_read_b128 a[248:251], v214 offset:32768
    v_mfma_f32_16x16x32_bf16 v[148:151], a[180:183], a[212:215], v[148:151]
    ds_read_b64_tr_b16 a[132:133], v33 offset:0
    v_mfma_f32_16x16x32_bf16 v[180:183], a[180:183], a[220:223], v[180:183]
    ds_read_b64_tr_b16 a[134:135], v33 offset:1024
    v_mfma_f32_16x16x32_bf16 v[88:91], a[184:187], a[196:199], v[88:91]
    ds_read_b64_tr_b16 a[136:137], v34 offset:0
    v_mfma_f32_16x16x32_bf16 v[120:123], a[184:187], a[204:207], v[120:123]
    ds_read_b64_tr_b16 a[138:139], v34 offset:1024
    v_mfma_f32_16x16x32_bf16 v[152:155], a[184:187], a[212:215], v[152:155]
    ds_read_b128 a[228:231], v209 offset:32768
    v_mfma_f32_16x16x32_bf16 v[184:187], a[184:187], a[220:223], v[184:187]
    ds_read_b128 a[236:239], v211 offset:32768
    v_mfma_f32_16x16x32_bf16 v[92:95], a[188:191], a[196:199], v[92:95]
    ds_read_b128 a[244:247], v213 offset:32768
    v_mfma_f32_16x16x32_bf16 v[124:127], a[188:191], a[204:207], v[124:127]
    ds_read_b128 a[252:255], v215 offset:32768
    v_mfma_f32_16x16x32_bf16 v[156:159], a[188:191], a[212:215], v[156:159]
    ds_read_b64_tr_b16 a[140:141], v35 offset:0
    v_mfma_f32_16x16x32_bf16 v[188:191], a[188:191], a[220:223], v[188:191]
    ds_read_b64_tr_b16 a[142:143], v35 offset:1024
    s_waitcnt lgkmcnt(10)
    v_mfma_f32_16x16x32_bf16 v[64:67], a[128:131], a[224:227], v[64:67]
    ds_read_b64_tr_b16 a[144:145], v36 offset:0
    v_mfma_f32_16x16x32_bf16 v[96:99], a[128:131], a[232:235], v[96:99]
    ds_read_b64_tr_b16 a[146:147], v36 offset:1024
    v_mfma_f32_16x16x32_bf16 v[128:131], a[128:131], a[240:243], v[128:131]
    s_lshl_b32 s47, s78, 12
    v_mfma_f32_16x16x32_bf16 v[160:163], a[128:131], a[248:251], v[160:163]
    s_waitcnt lgkmcnt(10)
    s_add_u32 m0, s60, 32768
    ds_read_b64_tr_b16 a[148:149], v37 offset:0
    v_mfma_f32_16x16x32_bf16 v[68:71], a[132:135], a[224:227], v[68:71]
    buffer_load_dwordx4 v202, s[8:11], s47 offen offset:0 lds
    v_mfma_f32_16x16x32_bf16 v[100:103], a[132:135], a[232:235], v[100:103]
    ds_read_b64_tr_b16 a[150:151], v37 offset:1024
    buffer_load_dwordx4 v203, s[8:11], s47 offen offset:1024 lds
    v_mfma_f32_16x16x32_bf16 v[132:135], a[132:135], a[240:243], v[132:135]
    ds_read_b64_tr_b16 a[152:153], v38 offset:0
    v_mfma_f32_16x16x32_bf16 v[164:167], a[132:135], a[248:251], v[164:167]
    s_waitcnt lgkmcnt(11)
    buffer_load_dwordx4 v204, s[8:11], s47 offen offset:2048 lds
    s_add_u32 m0, s60, 35840
    v_mfma_f32_16x16x32_bf16 v[72:75], a[136:139], a[224:227], v[72:75]
    ds_read_b64_tr_b16 a[154:155], v38 offset:1024
    buffer_load_dwordx4 v205, s[8:11], s47 offen offset:0 lds
    v_mfma_f32_16x16x32_bf16 v[104:107], a[136:139], a[232:235], v[104:107]
    v_mfma_f32_16x16x32_bf16 v[136:139], a[136:139], a[240:243], v[136:139]
    ds_read_b64_tr_b16 a[156:157], v39 offset:0
    buffer_load_dwordx4 v206, s[8:11], s47 offen offset:1024 lds
    v_mfma_f32_16x16x32_bf16 v[168:171], a[136:139], a[248:251], v[168:171]
    s_waitcnt lgkmcnt(7)
    s_barrier
    ds_read_b64_tr_b16 a[158:159], v39 offset:1024
    buffer_load_dwordx4 v207, s[8:11], s47 offen offset:2048 lds
    v_mfma_f32_16x16x32_bf16 v[76:79], a[140:143], a[224:227], v[76:79]
    v_mfma_f32_16x16x32_bf16 v[108:111], a[140:143], a[232:235], v[108:111]
    s_add_u32 m0, s58, 114688
    ds_read_b64_tr_b16 a[160:161], v32 offset:8192
    v_mfma_f32_16x16x32_bf16 v[140:143], a[140:143], a[240:243], v[140:143]
    buffer_load_dwordx4 v192, s[4:7], s78 offen offset:0 lds
    v_mfma_f32_16x16x32_bf16 v[172:175], a[140:143], a[248:251], v[172:175]
    s_waitcnt lgkmcnt(7)
    ds_read_b64_tr_b16 a[162:163], v32 offset:9216
    v_mfma_f32_16x16x32_bf16 v[80:83], a[144:147], a[224:227], v[80:83]
    ds_read_b64_tr_b16 a[164:165], v33 offset:8192
    buffer_load_dwordx4 v193, s[4:7], s78 offen offset:1024 lds
    v_mfma_f32_16x16x32_bf16 v[112:115], a[144:147], a[232:235], v[112:115]
    v_mfma_f32_16x16x32_bf16 v[144:147], a[144:147], a[240:243], v[144:147]
    ds_read_b64_tr_b16 a[166:167], v33 offset:9216
    buffer_load_dwordx4 v194, s[4:7], s78 offen offset:2048 lds
    v_mfma_f32_16x16x32_bf16 v[176:179], a[144:147], a[248:251], v[176:179]
    s_waitcnt lgkmcnt(8)
    v_mfma_f32_16x16x32_bf16 v[84:87], a[148:151], a[224:227], v[84:87]
    ds_read_b64_tr_b16 a[168:169], v34 offset:8192
    buffer_load_dwordx4 v195, s[4:7], s78 offen offset:3072 lds
    v_mfma_f32_16x16x32_bf16 v[116:119], a[148:151], a[232:235], v[116:119]
    s_add_u32 m0, s58, 118784
    ds_read_b64_tr_b16 a[170:171], v34 offset:9216
    v_mfma_f32_16x16x32_bf16 v[148:151], a[148:151], a[240:243], v[148:151]
    buffer_load_dwordx4 v196, s[4:7], s78 offen offset:0 lds
    v_mfma_f32_16x16x32_bf16 v[180:183], a[148:151], a[248:251], v[180:183]
    s_waitcnt lgkmcnt(8)
    ds_read_b64_tr_b16 a[172:173], v35 offset:8192
    v_mfma_f32_16x16x32_bf16 v[88:91], a[152:155], a[224:227], v[88:91]
    buffer_load_dwordx4 v197, s[4:7], s78 offen offset:1024 lds
    v_mfma_f32_16x16x32_bf16 v[120:123], a[152:155], a[232:235], v[120:123]
    ds_read_b64_tr_b16 a[174:175], v35 offset:9216
    v_mfma_f32_16x16x32_bf16 v[152:155], a[152:155], a[240:243], v[152:155]
    ds_read_b64_tr_b16 a[176:177], v36 offset:8192
    buffer_load_dwordx4 v198, s[4:7], s78 offen offset:2048 lds
    v_mfma_f32_16x16x32_bf16 v[184:187], a[152:155], a[248:251], v[184:187]
    s_waitcnt lgkmcnt(9)
    v_mfma_f32_16x16x32_bf16 v[92:95], a[156:159], a[224:227], v[92:95]
    ds_read_b64_tr_b16 a[178:179], v36 offset:9216
    buffer_load_dwordx4 v199, s[4:7], s78 offen offset:3072 lds
    v_mfma_f32_16x16x32_bf16 v[124:127], a[156:159], a[232:235], v[124:127]
    s_add_u32 m0, s59, 114688
    v_mfma_f32_16x16x32_bf16 v[156:159], a[156:159], a[240:243], v[156:159]
    ds_read_b64_tr_b16 a[180:181], v37 offset:8192
    buffer_load_dwordx4 v200, s[4:7], s78 offen offset:0 lds
    v_mfma_f32_16x16x32_bf16 v[188:191], a[156:159], a[248:251], v[188:191]
    s_waitcnt lgkmcnt(9)
    ds_read_b64_tr_b16 a[182:183], v37 offset:9216
    v_mfma_f32_16x16x32_bf16 v[64:67], a[160:163], a[228:231], v[64:67]
    buffer_load_dwordx4 v201, s[4:7], s78 offen offset:1024 lds
    v_mfma_f32_16x16x32_bf16 v[96:99], a[160:163], a[236:239], v[96:99]
    ds_read_b64_tr_b16 a[184:185], v38 offset:8192
    v_mfma_f32_16x16x32_bf16 v[128:131], a[160:163], a[244:247], v[128:131]
    v_mfma_f32_16x16x32_bf16 v[160:163], a[160:163], a[252:255], v[160:163]
    s_waitcnt lgkmcnt(9)
    ds_read_b64_tr_b16 a[186:187], v38 offset:9216
    v_mfma_f32_16x16x32_bf16 v[68:71], a[164:167], a[228:231], v[68:71]
    ds_read_b64_tr_b16 a[188:189], v39 offset:8192
    v_mfma_f32_16x16x32_bf16 v[100:103], a[164:167], a[236:239], v[100:103]
    v_mfma_f32_16x16x32_bf16 v[132:135], a[164:167], a[244:247], v[132:135]
    ds_read_b64_tr_b16 a[190:191], v39 offset:9216
    v_mfma_f32_16x16x32_bf16 v[164:167], a[164:167], a[252:255], v[164:167]
    s_waitcnt lgkmcnt(10)
    v_mfma_f32_16x16x32_bf16 v[72:75], a[168:171], a[228:231], v[72:75]
    v_mfma_f32_16x16x32_bf16 v[104:107], a[168:171], a[236:239], v[104:107]
    v_mfma_f32_16x16x32_bf16 v[136:139], a[168:171], a[244:247], v[136:139]
    v_mfma_f32_16x16x32_bf16 v[168:171], a[168:171], a[252:255], v[168:171]
    s_waitcnt lgkmcnt(8)
    v_mfma_f32_16x16x32_bf16 v[76:79], a[172:175], a[228:231], v[76:79]
    v_mfma_f32_16x16x32_bf16 v[108:111], a[172:175], a[236:239], v[108:111]
    v_mfma_f32_16x16x32_bf16 v[140:143], a[172:175], a[244:247], v[140:143]
    v_mfma_f32_16x16x32_bf16 v[172:175], a[172:175], a[252:255], v[172:175]
    s_waitcnt lgkmcnt(6)
    v_mfma_f32_16x16x32_bf16 v[80:83], a[176:179], a[228:231], v[80:83]
    s_waitcnt vmcnt(16)
    s_waitcnt lgkmcnt(0)
    s_barrier
    ds_read_b128 a[192:195], v208 offset:0
    v_mfma_f32_16x16x32_bf16 v[112:115], a[176:179], a[236:239], v[112:115]
    ds_read_b64_tr_b16 a[128:129], v32 offset:16384
    buffer_load_dwordx2 v[56:57], off, s[36:39], 0 offset:128 sc1
    v_mfma_f32_16x16x32_bf16 v[144:147], a[176:179], a[244:247], v[144:147]
    ds_read_b64_tr_b16 a[130:131], v32 offset:17408
    v_mfma_f32_16x16x32_bf16 v[176:179], a[176:179], a[252:255], v[176:179]
    ds_read_b128 a[200:203], v210 offset:0
    v_mfma_f32_16x16x32_bf16 v[84:87], a[180:183], a[228:231], v[84:87]
    ds_read_b128 a[208:211], v212 offset:0
    v_mfma_f32_16x16x32_bf16 v[116:119], a[180:183], a[236:239], v[116:119]
    ds_read_b128 a[216:219], v214 offset:0
    v_mfma_f32_16x16x32_bf16 v[148:151], a[180:183], a[244:247], v[148:151]
    ds_read_b64_tr_b16 a[132:133], v33 offset:16384
    v_mfma_f32_16x16x32_bf16 v[180:183], a[180:183], a[252:255], v[180:183]
    ds_read_b64_tr_b16 a[134:135], v33 offset:17408
    v_mfma_f32_16x16x32_bf16 v[88:91], a[184:187], a[228:231], v[88:91]
    ds_read_b64_tr_b16 a[136:137], v34 offset:16384
    v_mfma_f32_16x16x32_bf16 v[120:123], a[184:187], a[236:239], v[120:123]
    ds_read_b64_tr_b16 a[138:139], v34 offset:17408
    v_mfma_f32_16x16x32_bf16 v[152:155], a[184:187], a[244:247], v[152:155]
    ds_read_b128 a[196:199], v209 offset:0
    v_mfma_f32_16x16x32_bf16 v[184:187], a[184:187], a[252:255], v[184:187]
    ds_read_b128 a[204:207], v211 offset:0
    v_mfma_f32_16x16x32_bf16 v[92:95], a[188:191], a[228:231], v[92:95]
    ds_read_b128 a[212:215], v213 offset:0
    v_mfma_f32_16x16x32_bf16 v[124:127], a[188:191], a[236:239], v[124:127]
    ds_read_b128 a[220:223], v215 offset:0
    v_mfma_f32_16x16x32_bf16 v[156:159], a[188:191], a[244:247], v[156:159]
    ds_read_b64_tr_b16 a[140:141], v35 offset:16384
    v_mfma_f32_16x16x32_bf16 v[188:191], a[188:191], a[252:255], v[188:191]
    ds_read_b64_tr_b16 a[142:143], v35 offset:17408
    s_waitcnt lgkmcnt(10)
    v_mfma_f32_16x16x32_bf16 v[64:67], a[128:131], a[192:195], v[64:67]
    ds_read_b64_tr_b16 a[144:145], v36 offset:16384
    v_mfma_f32_16x16x32_bf16 v[96:99], a[128:131], a[200:203], v[96:99]
    ds_read_b64_tr_b16 a[146:147], v36 offset:17408
    v_mfma_f32_16x16x32_bf16 v[128:131], a[128:131], a[208:211], v[128:131]
    v_mfma_f32_16x16x32_bf16 v[160:163], a[128:131], a[216:219], v[160:163]
    s_waitcnt lgkmcnt(10)
    ds_read_b64_tr_b16 a[148:149], v37 offset:16384
    v_mfma_f32_16x16x32_bf16 v[68:71], a[132:135], a[192:195], v[68:71]
    v_mfma_f32_16x16x32_bf16 v[100:103], a[132:135], a[200:203], v[100:103]
    ds_read_b64_tr_b16 a[150:151], v37 offset:17408
    v_mfma_f32_16x16x32_bf16 v[132:135], a[132:135], a[208:211], v[132:135]
    ds_read_b64_tr_b16 a[152:153], v38 offset:16384
    v_mfma_f32_16x16x32_bf16 v[164:167], a[132:135], a[216:219], v[164:167]
    s_waitcnt lgkmcnt(11)
    v_mfma_f32_16x16x32_bf16 v[72:75], a[136:139], a[192:195], v[72:75]
    ds_read_b64_tr_b16 a[154:155], v38 offset:17408
    v_mfma_f32_16x16x32_bf16 v[104:107], a[136:139], a[200:203], v[104:107]
    v_mfma_f32_16x16x32_bf16 v[136:139], a[136:139], a[208:211], v[136:139]
    ds_read_b64_tr_b16 a[156:157], v39 offset:16384
    v_mfma_f32_16x16x32_bf16 v[168:171], a[136:139], a[216:219], v[168:171]
    s_waitcnt lgkmcnt(7)
    s_barrier
    ds_read_b64_tr_b16 a[158:159], v39 offset:17408
    v_mfma_f32_16x16x32_bf16 v[76:79], a[140:143], a[192:195], v[76:79]
    v_mfma_f32_16x16x32_bf16 v[108:111], a[140:143], a[200:203], v[108:111]
    ds_read_b64_tr_b16 a[160:161], v32 offset:24576
    v_mfma_f32_16x16x32_bf16 v[140:143], a[140:143], a[208:211], v[140:143]
    v_mfma_f32_16x16x32_bf16 v[172:175], a[140:143], a[216:219], v[172:175]
    s_waitcnt lgkmcnt(7)
    ds_read_b64_tr_b16 a[162:163], v32 offset:25600
    v_mfma_f32_16x16x32_bf16 v[80:83], a[144:147], a[192:195], v[80:83]
    ds_read_b64_tr_b16 a[164:165], v33 offset:24576
    v_mfma_f32_16x16x32_bf16 v[112:115], a[144:147], a[200:203], v[112:115]
    v_mfma_f32_16x16x32_bf16 v[144:147], a[144:147], a[208:211], v[144:147]
    ds_read_b64_tr_b16 a[166:167], v33 offset:25600
    v_mfma_f32_16x16x32_bf16 v[176:179], a[144:147], a[216:219], v[176:179]
    s_waitcnt lgkmcnt(8)
    v_mfma_f32_16x16x32_bf16 v[84:87], a[148:151], a[192:195], v[84:87]
    ds_read_b64_tr_b16 a[168:169], v34 offset:24576
    v_mfma_f32_16x16x32_bf16 v[116:119], a[148:151], a[200:203], v[116:119]
    ds_read_b64_tr_b16 a[170:171], v34 offset:25600
    v_mfma_f32_16x16x32_bf16 v[148:151], a[148:151], a[208:211], v[148:151]
    v_mfma_f32_16x16x32_bf16 v[180:183], a[148:151], a[216:219], v[180:183]
    s_waitcnt lgkmcnt(8)
    ds_read_b64_tr_b16 a[172:173], v35 offset:24576
    v_mfma_f32_16x16x32_bf16 v[88:91], a[152:155], a[192:195], v[88:91]
    v_mfma_f32_16x16x32_bf16 v[120:123], a[152:155], a[200:203], v[120:123]
    ds_read_b64_tr_b16 a[174:175], v35 offset:25600
    v_mfma_f32_16x16x32_bf16 v[152:155], a[152:155], a[208:211], v[152:155]
    ds_read_b64_tr_b16 a[176:177], v36 offset:24576
    v_mfma_f32_16x16x32_bf16 v[184:187], a[152:155], a[216:219], v[184:187]
    s_waitcnt lgkmcnt(9)
    v_mfma_f32_16x16x32_bf16 v[92:95], a[156:159], a[192:195], v[92:95]
    ds_read_b64_tr_b16 a[178:179], v36 offset:25600
    v_mfma_f32_16x16x32_bf16 v[124:127], a[156:159], a[200:203], v[124:127]
    v_mfma_f32_16x16x32_bf16 v[156:159], a[156:159], a[208:211], v[156:159]
    ds_read_b64_tr_b16 a[180:181], v37 offset:24576
    v_mfma_f32_16x16x32_bf16 v[188:191], a[156:159], a[216:219], v[188:191]
    s_waitcnt lgkmcnt(9)
    ds_read_b64_tr_b16 a[182:183], v37 offset:25600
    v_mfma_f32_16x16x32_bf16 v[64:67], a[160:163], a[196:199], v[64:67]
    v_mfma_f32_16x16x32_bf16 v[96:99], a[160:163], a[204:207], v[96:99]
    ds_read_b64_tr_b16 a[184:185], v38 offset:24576
    v_mfma_f32_16x16x32_bf16 v[128:131], a[160:163], a[212:215], v[128:131]
    v_mfma_f32_16x16x32_bf16 v[160:163], a[160:163], a[220:223], v[160:163]
    s_waitcnt lgkmcnt(9)
    ds_read_b64_tr_b16 a[186:187], v38 offset:25600
    v_mfma_f32_16x16x32_bf16 v[68:71], a[164:167], a[196:199], v[68:71]
    ds_read_b64_tr_b16 a[188:189], v39 offset:24576
    v_mfma_f32_16x16x32_bf16 v[100:103], a[164:167], a[204:207], v[100:103]
    v_mfma_f32_16x16x32_bf16 v[132:135], a[164:167], a[212:215], v[132:135]
    ds_read_b64_tr_b16 a[190:191], v39 offset:25600
    v_mfma_f32_16x16x32_bf16 v[164:167], a[164:167], a[220:223], v[164:167]
    s_waitcnt lgkmcnt(10)
    v_mfma_f32_16x16x32_bf16 v[72:75], a[168:171], a[196:199], v[72:75]
    v_mfma_f32_16x16x32_bf16 v[104:107], a[168:171], a[204:207], v[104:107]
    v_mfma_f32_16x16x32_bf16 v[136:139], a[168:171], a[212:215], v[136:139]
    v_mfma_f32_16x16x32_bf16 v[168:171], a[168:171], a[220:223], v[168:171]
    s_waitcnt lgkmcnt(8)
    v_mfma_f32_16x16x32_bf16 v[76:79], a[172:175], a[196:199], v[76:79]
    v_mfma_f32_16x16x32_bf16 v[108:111], a[172:175], a[204:207], v[108:111]
    v_mfma_f32_16x16x32_bf16 v[140:143], a[172:175], a[212:215], v[140:143]
    v_mfma_f32_16x16x32_bf16 v[172:175], a[172:175], a[220:223], v[172:175]
    s_waitcnt lgkmcnt(6)
    v_mfma_f32_16x16x32_bf16 v[80:83], a[176:179], a[196:199], v[80:83]
    s_waitcnt vmcnt(1)
    s_waitcnt lgkmcnt(0)
    s_barrier
    ds_read_b128 a[224:227], v208 offset:32768
    v_mfma_f32_16x16x32_bf16 v[112:115], a[176:179], a[204:207], v[112:115]
    ds_read_b64_tr_b16 a[128:129], v32 offset:32768
    v_mfma_f32_16x16x32_bf16 v[144:147], a[176:179], a[212:215], v[144:147]
    ds_read_b64_tr_b16 a[130:131], v32 offset:33792
    v_mfma_f32_16x16x32_bf16 v[176:179], a[176:179], a[220:223], v[176:179]
    ds_read_b128 a[232:235], v210 offset:32768
    v_mfma_f32_16x16x32_bf16 v[84:87], a[180:183], a[196:199], v[84:87]
    ds_read_b128 a[240:243], v212 offset:32768
    v_mfma_f32_16x16x32_bf16 v[116:119], a[180:183], a[204:207], v[116:119]
    ds_read_b128 a[248:251], v214 offset:32768
    v_mfma_f32_16x16x32_bf16 v[148:151], a[180:183], a[212:215], v[148:151]
    ds_read_b64_tr_b16 a[132:133], v33 offset:32768
    v_mfma_f32_16x16x32_bf16 v[180:183], a[180:183], a[220:223], v[180:183]
    ds_read_b64_tr_b16 a[134:135], v33 offset:33792
    v_mfma_f32_16x16x32_bf16 v[88:91], a[184:187], a[196:199], v[88:91]
    ds_read_b64_tr_b16 a[136:137], v34 offset:32768
    v_mfma_f32_16x16x32_bf16 v[120:123], a[184:187], a[204:207], v[120:123]
    ds_read_b64_tr_b16 a[138:139], v34 offset:33792
    v_mfma_f32_16x16x32_bf16 v[152:155], a[184:187], a[212:215], v[152:155]
    ds_read_b128 a[228:231], v209 offset:32768
    v_mfma_f32_16x16x32_bf16 v[184:187], a[184:187], a[220:223], v[184:187]
    ds_read_b128 a[236:239], v211 offset:32768
    v_mfma_f32_16x16x32_bf16 v[92:95], a[188:191], a[196:199], v[92:95]
    ds_read_b128 a[244:247], v213 offset:32768
    v_mfma_f32_16x16x32_bf16 v[124:127], a[188:191], a[204:207], v[124:127]
    ds_read_b128 a[252:255], v215 offset:32768
    v_mfma_f32_16x16x32_bf16 v[156:159], a[188:191], a[212:215], v[156:159]
    ds_read_b64_tr_b16 a[140:141], v35 offset:32768
    v_mfma_f32_16x16x32_bf16 v[188:191], a[188:191], a[220:223], v[188:191]
    ds_read_b64_tr_b16 a[142:143], v35 offset:33792
    s_waitcnt lgkmcnt(10)
    v_mfma_f32_16x16x32_bf16 v[64:67], a[128:131], a[224:227], v[64:67]
    ds_read_b64_tr_b16 a[144:145], v36 offset:32768
    v_mfma_f32_16x16x32_bf16 v[96:99], a[128:131], a[232:235], v[96:99]
    ds_read_b64_tr_b16 a[146:147], v36 offset:33792
    v_mfma_f32_16x16x32_bf16 v[128:131], a[128:131], a[240:243], v[128:131]
    ds_read_b64_tr_b16 a[148:149], v37 offset:32768
    v_accvgpr_write_b32 a192, 0
    v_mfma_f32_16x16x32_bf16 v[160:163], a[128:131], a[248:251], v[160:163]
    s_waitcnt lgkmcnt(11)
    ds_read_b64_tr_b16 a[150:151], v37 offset:33792
    v_accvgpr_write_b32 a193, 0
    v_mfma_f32_16x16x32_bf16 v[68:71], a[132:135], a[224:227], v[68:71]
    ds_read_b64_tr_b16 a[152:153], v38 offset:32768
    v_accvgpr_write_b32 a194, 0
    v_mfma_f32_16x16x32_bf16 v[100:103], a[132:135], a[232:235], v[100:103]
    ds_read_b64_tr_b16 a[154:155], v38 offset:33792
    v_accvgpr_write_b32 a195, 0
    v_mfma_f32_16x16x32_bf16 v[132:135], a[132:135], a[240:243], v[132:135]
    ds_read_b64_tr_b16 a[156:157], v39 offset:32768
    v_accvgpr_write_b32 a196, 0
    v_mfma_f32_16x16x32_bf16 v[164:167], a[132:135], a[248:251], v[164:167]
    s_waitcnt lgkmcnt(13)
    ds_read_b64_tr_b16 a[158:159], v39 offset:33792
    v_accvgpr_write_b32 a197, 0
    v_mfma_f32_16x16x32_bf16 v[72:75], a[136:139], a[224:227], v[72:75]
    ds_read_b64_tr_b16 a[160:161], v32 offset:40960
    v_accvgpr_write_b32 a198, 0
    v_mfma_f32_16x16x32_bf16 v[104:107], a[136:139], a[232:235], v[104:107]
    ds_read_b64_tr_b16 a[162:163], v32 offset:41984
    v_accvgpr_write_b32 a199, 0
    v_mfma_f32_16x16x32_bf16 v[136:139], a[136:139], a[240:243], v[136:139]
    ds_read_b64_tr_b16 a[164:165], v33 offset:40960
    v_mfma_f32_16x16x32_bf16 v[168:171], a[136:139], a[248:251], v[168:171]
    s_waitcnt lgkmcnt(11)
    ds_read_b64_tr_b16 a[166:167], v33 offset:41984
    v_mfma_f32_16x16x32_bf16 v[76:79], a[140:143], a[224:227], v[76:79]
    ds_read_b64_tr_b16 a[168:169], v34 offset:40960
    v_mfma_f32_16x16x32_bf16 v[108:111], a[140:143], a[232:235], v[108:111]
    ds_read_b64_tr_b16 a[170:171], v34 offset:41984
    v_mfma_f32_16x16x32_bf16 v[140:143], a[140:143], a[240:243], v[140:143]
    ds_read_b64_tr_b16 a[172:173], v35 offset:40960
    v_mfma_f32_16x16x32_bf16 v[172:175], a[140:143], a[248:251], v[172:175]
    s_waitcnt lgkmcnt(13)
    ds_read_b64_tr_b16 a[174:175], v35 offset:41984
    v_mfma_f32_16x16x32_bf16 v[80:83], a[144:147], a[224:227], v[80:83]
    ds_read_b64_tr_b16 a[176:177], v36 offset:40960
    v_mfma_f32_16x16x32_bf16 v[112:115], a[144:147], a[232:235], v[112:115]
    ds_read_b64_tr_b16 a[178:179], v36 offset:41984
    v_mfma_f32_16x16x32_bf16 v[144:147], a[144:147], a[240:243], v[144:147]
    ds_read_b64_tr_b16 a[180:181], v37 offset:40960
    v_mfma_f32_16x16x32_bf16 v[176:179], a[144:147], a[248:251], v[176:179]
    s_waitcnt lgkmcnt(15)
    ds_read_b64_tr_b16 a[182:183], v37 offset:41984
    v_mfma_f32_16x16x32_bf16 v[84:87], a[148:151], a[224:227], v[84:87]
    ds_read_b64_tr_b16 a[184:185], v38 offset:40960
    v_mfma_f32_16x16x32_bf16 v[116:119], a[148:151], a[232:235], v[116:119]
    ds_read_b64_tr_b16 a[186:187], v38 offset:41984
    v_mfma_f32_16x16x32_bf16 v[148:151], a[148:151], a[240:243], v[148:151]
    ds_read_b64_tr_b16 a[188:189], v39 offset:40960
    v_mfma_f32_16x16x32_bf16 v[180:183], a[148:151], a[248:251], v[180:183]
    s_waitcnt lgkmcnt(15)
    ds_read_b64_tr_b16 a[190:191], v39 offset:41984
    v_mfma_f32_16x16x32_bf16 v[88:91], a[152:155], a[224:227], v[88:91]
    v_mfma_f32_16x16x32_bf16 v[120:123], a[152:155], a[232:235], v[120:123]
    v_mfma_f32_16x16x32_bf16 v[152:155], a[152:155], a[240:243], v[152:155]
    v_mfma_f32_16x16x32_bf16 v[184:187], a[152:155], a[248:251], v[184:187]
    s_waitcnt lgkmcnt(15)
    v_mfma_f32_16x16x32_bf16 v[92:95], a[156:159], a[224:227], v[92:95]
    v_mfma_f32_16x16x32_bf16 v[124:127], a[156:159], a[232:235], v[124:127]
    v_mfma_f32_16x16x32_bf16 v[156:159], a[156:159], a[240:243], v[156:159]
    v_mfma_f32_16x16x32_bf16 v[188:191], a[156:159], a[248:251], v[188:191]
    s_waitcnt lgkmcnt(0)
    s_barrier
    v_mfma_f32_16x16x32_bf16 v[64:67], a[160:163], a[228:231], v[64:67]
    ds_read_b128 a[128:131], v2 offset:0
    v_mfma_f32_16x16x32_bf16 v[68:71], a[164:167], a[228:231], v[68:71]
    ds_read_b128 a[132:135], v3 offset:0
    v_mfma_f32_16x16x32_bf16 v[72:75], a[168:171], a[228:231], v[72:75]
    ds_read_b128 a[136:139], v4 offset:0
    v_mfma_f32_16x16x32_bf16 v[76:79], a[172:175], a[228:231], v[76:79]
    ds_read_b128 a[140:143], v5 offset:0
    v_mfma_f32_16x16x32_bf16 v[80:83], a[176:179], a[228:231], v[80:83]
    ds_read_b128 a[144:147], v2 offset:4096
    v_mul_f32 v64, s56, v64
    v_mfma_f32_16x16x32_bf16 v[84:87], a[180:183], a[228:231], v[84:87]
    ds_read_b128 a[148:151], v3 offset:4096
    v_mul_f32 v65, s56, v65
    v_mfma_f32_16x16x32_bf16 v[88:91], a[184:187], a[228:231], v[88:91]
    ds_read_b128 a[152:155], v4 offset:4096
    v_mul_f32 v66, s56, v66
    v_mfma_f32_16x16x32_bf16 v[92:95], a[188:191], a[228:231], v[92:95]
    ds_read_b128 a[156:159], v5 offset:4096
    v_mul_f32 v67, s56, v67
    v_mfma_f32_16x16x32_bf16 v[96:99], a[160:163], a[236:239], v[96:99]
    v_mul_f32 v68, s56, v68
    v_mul_f32 v69, s56, v69
    v_mfma_f32_16x16x32_bf16 v[100:103], a[164:167], a[236:239], v[100:103]
    v_mul_f32 v70, s56, v70
    v_mul_f32 v71, s56, v71
    v_mfma_f32_16x16x32_bf16 v[104:107], a[168:171], a[236:239], v[104:107]
    v_cvt_pk_bf16_f32 v192, v64, v65
    v_cvt_pk_bf16_f32 v193, v66, v67
    v_mfma_f32_16x16x32_bf16 v[108:111], a[172:175], a[236:239], v[108:111]
    v_cvt_pk_bf16_f32 v194, v68, v69
    v_cvt_pk_bf16_f32 v195, v70, v71
    v_mfma_f32_16x16x32_bf16 v[112:115], a[176:179], a[236:239], v[112:115]
    v_mul_f32 v72, s56, v72
    v_mul_f32 v73, s56, v73
    v_mfma_f32_16x16x32_bf16 v[116:119], a[180:183], a[236:239], v[116:119]
    v_mul_f32 v74, s56, v74
    v_mul_f32 v75, s56, v75
    v_mfma_f32_16x16x32_bf16 v[120:123], a[184:187], a[236:239], v[120:123]
    v_mul_f32 v76, s56, v76
    v_mul_f32 v77, s56, v77
    v_mfma_f32_16x16x32_bf16 v[124:127], a[188:191], a[236:239], v[124:127]
    v_mul_f32 v78, s56, v78
    v_mul_f32 v79, s56, v79
    v_mfma_f32_16x16x32_bf16 v[128:131], a[160:163], a[244:247], v[128:131]
    v_cvt_pk_bf16_f32 v196, v72, v73
    v_cvt_pk_bf16_f32 v197, v74, v75
    v_mfma_f32_16x16x32_bf16 v[132:135], a[164:167], a[244:247], v[132:135]
    v_cvt_pk_bf16_f32 v198, v76, v77
    v_cvt_pk_bf16_f32 v199, v78, v79
    v_mfma_f32_16x16x32_bf16 v[136:139], a[168:171], a[244:247], v[136:139]
    v_mul_f32 v80, s56, v80
    v_mul_f32 v81, s56, v81
    v_mfma_f32_16x16x32_bf16 v[140:143], a[172:175], a[244:247], v[140:143]
    v_mul_f32 v82, s56, v82
    v_mul_f32 v83, s56, v83
    v_mfma_f32_16x16x32_bf16 v[144:147], a[176:179], a[244:247], v[144:147]
    v_mul_f32 v84, s56, v84
    v_mul_f32 v85, s56, v85
    v_mfma_f32_16x16x32_bf16 v[148:151], a[180:183], a[244:247], v[148:151]
    v_mul_f32 v86, s56, v86
    v_mul_f32 v87, s56, v87
    v_mfma_f32_16x16x32_bf16 v[152:155], a[184:187], a[244:247], v[152:155]
    v_cvt_pk_bf16_f32 v200, v80, v81
    v_cvt_pk_bf16_f32 v201, v82, v83
    v_mfma_f32_16x16x32_bf16 v[156:159], a[188:191], a[244:247], v[156:159]
    v_cvt_pk_bf16_f32 v202, v84, v85
    v_cvt_pk_bf16_f32 v203, v86, v87
    v_mfma_f32_16x16x32_bf16 v[160:163], a[160:163], a[252:255], v[160:163]
    v_mul_f32 v88, s56, v88
    v_mul_f32 v89, s56, v89
    v_mfma_f32_16x16x32_bf16 v[164:167], a[164:167], a[252:255], v[164:167]
    v_mul_f32 v90, s56, v90
    v_mul_f32 v91, s56, v91
    v_mfma_f32_16x16x32_bf16 v[168:171], a[168:171], a[252:255], v[168:171]
    v_mul_f32 v92, s56, v92
    v_mul_f32 v93, s56, v93
    v_mfma_f32_16x16x32_bf16 v[172:175], a[172:175], a[252:255], v[172:175]
    v_mul_f32 v94, s56, v94
    v_mul_f32 v95, s56, v95
    v_mfma_f32_16x16x32_bf16 v[176:179], a[176:179], a[252:255], v[176:179]
    v_cvt_pk_bf16_f32 v204, v88, v89
    v_cvt_pk_bf16_f32 v205, v90, v91
    v_mfma_f32_16x16x32_bf16 v[180:183], a[180:183], a[252:255], v[180:183]
    v_cvt_pk_bf16_f32 v206, v92, v93
    v_cvt_pk_bf16_f32 v207, v94, v95
    v_mfma_f32_16x16x32_bf16 v[184:187], a[184:187], a[252:255], v[184:187]
    v_mfma_f32_16x16x32_bf16 v[188:191], a[188:191], a[252:255], v[188:191]
    s_nop 0
    s_nop 0
    s_nop 0
    s_nop 0
    s_nop 0
    s_nop 0
    s_nop 0
    s_nop 0
    v_pk_mul_f32 v[96:97], v[96:97], s[56:57]
    v_pk_mul_f32 v[98:99], v[98:99], s[56:57]
    v_pk_mul_f32 v[100:101], v[100:101], s[56:57]
    v_pk_mul_f32 v[102:103], v[102:103], s[56:57]
    v_pk_mul_f32 v[104:105], v[104:105], s[56:57]
    v_pk_mul_f32 v[106:107], v[106:107], s[56:57]
    v_pk_mul_f32 v[108:109], v[108:109], s[56:57]
    v_pk_mul_f32 v[110:111], v[110:111], s[56:57]
    v_pk_mul_f32 v[112:113], v[112:113], s[56:57]
    v_pk_mul_f32 v[114:115], v[114:115], s[56:57]
    v_pk_mul_f32 v[116:117], v[116:117], s[56:57]
    v_pk_mul_f32 v[118:119], v[118:119], s[56:57]
    v_pk_mul_f32 v[120:121], v[120:121], s[56:57]
    v_pk_mul_f32 v[122:123], v[122:123], s[56:57]
    v_pk_mul_f32 v[124:125], v[124:125], s[56:57]
    v_pk_mul_f32 v[126:127], v[126:127], s[56:57]
    s_waitcnt lgkmcnt(0)
    ds_read_b128 a[160:163], v2 offset:8192
    v_cvt_pk_bf16_f32 v208, v96, v97
    v_mfma_f32_16x16x32_bf16 v[64:67], a[128:131], v[192:195], 0
    ds_read_b128 a[164:167], v3 offset:8192
    v_cvt_pk_bf16_f32 v209, v98, v99
    v_mfma_f32_16x16x32_bf16 v[64:67], a[132:135], v[196:199], v[64:67]
    ds_read_b128 a[168:171], v4 offset:8192
    v_cvt_pk_bf16_f32 v210, v100, v101
    v_mfma_f32_16x16x32_bf16 v[64:67], a[136:139], v[200:203], v[64:67]
    ds_read_b128 a[172:175], v5 offset:8192
    v_cvt_pk_bf16_f32 v211, v102, v103
    v_mfma_f32_16x16x32_bf16 v[64:67], a[140:143], v[204:207], v[64:67]
    ds_read_b128 a[176:179], v2 offset:12288
    v_cvt_pk_bf16_f32 v212, v104, v105
    v_mfma_f32_16x16x32_bf16 v[68:71], a[144:147], v[192:195], 0
    ds_read_b128 a[180:183], v3 offset:12288
    v_cvt_pk_bf16_f32 v213, v106, v107
    v_mfma_f32_16x16x32_bf16 v[68:71], a[148:151], v[196:199], v[68:71]
    ds_read_b128 a[184:187], v4 offset:12288
    v_cvt_pk_bf16_f32 v214, v108, v109
    v_mfma_f32_16x16x32_bf16 v[68:71], a[152:155], v[200:203], v[68:71]
    ds_read_b128 a[188:191], v5 offset:12288
    v_cvt_pk_bf16_f32 v215, v110, v111
    v_mfma_f32_16x16x32_bf16 v[68:71], a[156:159], v[204:207], v[68:71]
    v_cvt_pk_bf16_f32 v216, v112, v113
    v_cvt_pk_bf16_f32 v217, v114, v115
    v_cvt_pk_bf16_f32 v218, v116, v117
    v_cvt_pk_bf16_f32 v219, v118, v119
    v_cvt_pk_bf16_f32 v220, v120, v121
    v_cvt_pk_bf16_f32 v221, v122, v123
    v_cvt_pk_bf16_f32 v222, v124, v125
    v_cvt_pk_bf16_f32 v223, v126, v127
    v_max3_f32 v24, v64, v65, v66
    v_max3_f32 v28, v67, v68, v69
    v_max3_f32 v24, v24, v70, v71
    v_max_f32 v24, v24, v28
    v_mov_b32 v28, v24
    s_nop 0
    s_nop 0
    v_permlane32_swap_b32 v28, v24
    v_max_f32 v24, v24, v28
    v_mov_b32 v28, v24
    s_nop 0
    s_nop 0
    v_permlane16_swap_b32 v28, v24
    v_max_f32 v24, v24, v28
    v_sub_f32 v64, v64, v24
    v_sub_f32 v65, v65, v24
    v_sub_f32 v66, v66, v24
    v_sub_f32 v67, v67, v24
    v_sub_f32 v68, v68, v24
    v_sub_f32 v69, v69, v24
    v_sub_f32 v70, v70, v24
    v_sub_f32 v71, v71, v24
    v_pk_mul_f32 v[128:129], v[128:129], s[56:57]
    v_pk_mul_f32 v[130:131], v[130:131], s[56:57]
    v_pk_mul_f32 v[132:133], v[132:133], s[56:57]
    v_pk_mul_f32 v[134:135], v[134:135], s[56:57]
    v_pk_mul_f32 v[136:137], v[136:137], s[56:57]
    v_pk_mul_f32 v[138:139], v[138:139], s[56:57]
    v_pk_mul_f32 v[140:141], v[140:141], s[56:57]
    v_pk_mul_f32 v[142:143], v[142:143], s[56:57]
    v_pk_mul_f32 v[144:145], v[144:145], s[56:57]
    v_pk_mul_f32 v[146:147], v[146:147], s[56:57]
    v_pk_mul_f32 v[148:149], v[148:149], s[56:57]
    v_pk_mul_f32 v[150:151], v[150:151], s[56:57]
    v_pk_mul_f32 v[152:153], v[152:153], s[56:57]
    v_pk_mul_f32 v[154:155], v[154:155], s[56:57]
    v_pk_mul_f32 v[156:157], v[156:157], s[56:57]
    v_pk_mul_f32 v[158:159], v[158:159], s[56:57]
    v_cvt_pk_bf16_f32 v224, v128, v129
    v_mfma_f32_16x16x32_bf16 v[72:75], a[128:131], v[208:211], 0
    v_cvt_pk_bf16_f32 v225, v130, v131
    v_cvt_pk_bf16_f32 v226, v132, v133
    v_mfma_f32_16x16x32_bf16 v[72:75], a[132:135], v[212:215], v[72:75]
    v_cvt_pk_bf16_f32 v227, v134, v135
    v_cvt_pk_bf16_f32 v228, v136, v137
    v_mfma_f32_16x16x32_bf16 v[72:75], a[136:139], v[216:219], v[72:75]
    v_cvt_pk_bf16_f32 v229, v138, v139
    v_cvt_pk_bf16_f32 v230, v140, v141
    v_mfma_f32_16x16x32_bf16 v[72:75], a[140:143], v[220:223], v[72:75]
    v_cvt_pk_bf16_f32 v231, v142, v143
    v_cvt_pk_bf16_f32 v232, v144, v145
    v_mfma_f32_16x16x32_bf16 v[76:79], a[144:147], v[208:211], 0
    v_cvt_pk_bf16_f32 v233, v146, v147
    v_cvt_pk_bf16_f32 v234, v148, v149
    v_mfma_f32_16x16x32_bf16 v[76:79], a[148:151], v[212:215], v[76:79]
    v_cvt_pk_bf16_f32 v235, v150, v151
    v_cvt_pk_bf16_f32 v236, v152, v153
    v_mfma_f32_16x16x32_bf16 v[76:79], a[152:155], v[216:219], v[76:79]
    v_cvt_pk_bf16_f32 v237, v154, v155
    v_cvt_pk_bf16_f32 v238, v156, v157
    v_mfma_f32_16x16x32_bf16 v[76:79], a[156:159], v[220:223], v[76:79]
    v_cvt_pk_bf16_f32 v239, v158, v159
    s_nop 0
    s_nop 0
    s_nop 0
    s_nop 0
    s_nop 0
    s_nop 0
    s_nop 0
    v_max3_f32 v25, v72, v73, v74
    v_max3_f32 v28, v75, v76, v77
    v_max3_f32 v25, v25, v78, v79
    v_max_f32 v25, v25, v28
    v_mov_b32 v28, v25
    s_nop 0
    s_nop 0
    v_permlane32_swap_b32 v28, v25
    v_max_f32 v25, v25, v28
    v_mov_b32 v28, v25
    s_nop 0
    s_nop 0
    v_permlane16_swap_b32 v28, v25
    v_max_f32 v25, v25, v28
    v_sub_f32 v72, v72, v25
    v_sub_f32 v73, v73, v25
    v_sub_f32 v74, v74, v25
    v_sub_f32 v75, v75, v25
    v_sub_f32 v76, v76, v25
    v_sub_f32 v77, v77, v25
    v_sub_f32 v78, v78, v25
    v_sub_f32 v79, v79, v25
    v_pk_mul_f32 v[160:161], v[160:161], s[56:57]
    v_pk_mul_f32 v[162:163], v[162:163], s[56:57]
    v_pk_mul_f32 v[164:165], v[164:165], s[56:57]
    v_pk_mul_f32 v[166:167], v[166:167], s[56:57]
    v_pk_mul_f32 v[168:169], v[168:169], s[56:57]
    v_pk_mul_f32 v[170:171], v[170:171], s[56:57]
    v_pk_mul_f32 v[172:173], v[172:173], s[56:57]
    v_pk_mul_f32 v[174:175], v[174:175], s[56:57]
    v_pk_mul_f32 v[176:177], v[176:177], s[56:57]
    v_pk_mul_f32 v[178:179], v[178:179], s[56:57]
    v_pk_mul_f32 v[180:181], v[180:181], s[56:57]
    v_pk_mul_f32 v[182:183], v[182:183], s[56:57]
    v_pk_mul_f32 v[184:185], v[184:185], s[56:57]
    v_pk_mul_f32 v[186:187], v[186:187], s[56:57]
    v_pk_mul_f32 v[188:189], v[188:189], s[56:57]
    v_pk_mul_f32 v[190:191], v[190:191], s[56:57]
    v_cvt_pk_bf16_f32 v240, v160, v161
    v_mfma_f32_16x16x32_bf16 v[80:83], a[128:131], v[224:227], 0
    v_cvt_pk_bf16_f32 v241, v162, v163
    v_cvt_pk_bf16_f32 v242, v164, v165
    v_mfma_f32_16x16x32_bf16 v[80:83], a[132:135], v[228:231], v[80:83]
    v_cvt_pk_bf16_f32 v243, v166, v167
    v_cvt_pk_bf16_f32 v244, v168, v169
    v_mfma_f32_16x16x32_bf16 v[80:83], a[136:139], v[232:235], v[80:83]
    v_cvt_pk_bf16_f32 v245, v170, v171
    v_cvt_pk_bf16_f32 v246, v172, v173
    v_mfma_f32_16x16x32_bf16 v[80:83], a[140:143], v[236:239], v[80:83]
    v_cvt_pk_bf16_f32 v247, v174, v175
    v_cvt_pk_bf16_f32 v248, v176, v177
    v_mfma_f32_16x16x32_bf16 v[84:87], a[144:147], v[224:227], 0
    v_cvt_pk_bf16_f32 v249, v178, v179
    v_cvt_pk_bf16_f32 v250, v180, v181
    v_mfma_f32_16x16x32_bf16 v[84:87], a[148:151], v[228:231], v[84:87]
    v_cvt_pk_bf16_f32 v251, v182, v183
    v_cvt_pk_bf16_f32 v252, v184, v185
    v_mfma_f32_16x16x32_bf16 v[84:87], a[152:155], v[232:235], v[84:87]
    v_cvt_pk_bf16_f32 v253, v186, v187
    v_cvt_pk_bf16_f32 v254, v188, v189
    v_mfma_f32_16x16x32_bf16 v[84:87], a[156:159], v[236:239], v[84:87]
    v_cvt_pk_bf16_f32 v255, v190, v191
    s_waitcnt lgkmcnt(0)
    s_cmp_eq_u32 s48, 65536
    s_cselect_b32 s49, s50, 16384
    s_add_u32 s48, s48, s49
    v_mfma_f32_16x16x32_bf16 v[88:91], a[128:131], v[240:243], 0
    v_mfma_f32_16x16x32_bf16 v[88:91], a[132:135], v[244:247], v[88:91]
    v_mfma_f32_16x16x32_bf16 v[88:91], a[136:139], v[248:251], v[88:91]
    v_max3_f32 v26, v80, v81, v82
    v_max3_f32 v28, v83, v84, v85
    v_mfma_f32_16x16x32_bf16 v[88:91], a[140:143], v[252:255], v[88:91]
    v_max3_f32 v26, v26, v86, v87
    v_max_f32 v26, v26, v28
    v_mfma_f32_16x16x32_bf16 v[92:95], a[144:147], v[240:243], 0
    v_mov_b32 v28, v26
    v_mfma_f32_16x16x32_bf16 v[92:95], a[148:151], v[244:247], v[92:95]
    v_mfma_f32_16x16x32_bf16 v[92:95], a[152:155], v[248:251], v[92:95]
    v_permlane32_swap_b32 v28, v26
    v_mfma_f32_16x16x32_bf16 v[92:95], a[156:159], v[252:255], v[92:95]
    v_max_f32 v26, v26, v28
    v_mov_b32 v28, v26
    s_nop 0
    s_nop 0
    v_permlane16_swap_b32 v28, v26
    v_max_f32 v26, v26, v28
    v_sub_f32 v80, v80, v26
    v_sub_f32 v81, v81, v26
    v_sub_f32 v82, v82, v26
    v_sub_f32 v83, v83, v26
    v_sub_f32 v84, v84, v26
    v_sub_f32 v85, v85, v26
    v_sub_f32 v86, v86, v26
    v_sub_f32 v87, v87, v26
    v_sub_f32 v160, 0, v24
    v_sub_f32 v161, 0, v24
    v_sub_f32 v162, 0, v24
    v_sub_f32 v163, 0, v24
    v_sub_f32 v164, 0, v25
    v_sub_f32 v165, 0, v25
    v_sub_f32 v166, 0, v25
    v_mfma_f32_16x16x32_bf16 v[96:99], a[160:163], v[192:195], v[160:163]
    v_sub_f32 v167, 0, v25
    v_sub_f32 v168, 0, v26
    v_mfma_f32_16x16x32_bf16 v[96:99], a[164:167], v[196:199], v[96:99]
    v_sub_f32 v169, 0, v26
    v_sub_f32 v170, 0, v26
    v_mfma_f32_16x16x32_bf16 v[96:99], a[168:171], v[200:203], v[96:99]
    v_sub_f32 v171, 0, v26
    v_exp_f32 v64, v64
    v_mfma_f32_16x16x32_bf16 v[96:99], a[172:175], v[204:207], v[96:99]
    v_exp_f32 v65, v65
    v_mfma_f32_16x16x32_bf16 v[100:103], a[176:179], v[192:195], v[160:163]
    v_exp_f32 v66, v66
    v_mfma_f32_16x16x32_bf16 v[100:103], a[180:183], v[196:199], v[100:103]
    v_cvt_pk_bf16_f32 v128, v64, v65
    v_exp_f32 v67, v67
    v_mfma_f32_16x16x32_bf16 v[100:103], a[184:187], v[200:203], v[100:103]
    v_exp_f32 v68, v68
    v_mfma_f32_16x16x32_bf16 v[100:103], a[188:191], v[204:207], v[100:103]
    v_cvt_pk_bf16_f32 v129, v66, v67
    v_exp_f32 v69, v69
    v_mfma_f32_16x16x32_bf16 v[104:107], a[160:163], v[208:211], v[164:167]
    v_exp_f32 v70, v70
    v_mfma_f32_16x16x32_bf16 v[104:107], a[164:167], v[212:215], v[104:107]
    v_cvt_pk_bf16_f32 v130, v68, v69
    v_exp_f32 v71, v71
    v_mfma_f32_16x16x32_bf16 v[104:107], a[168:171], v[216:219], v[104:107]
    v_exp_f32 v72, v72
    v_mfma_f32_16x16x32_bf16 v[104:107], a[172:175], v[220:223], v[104:107]
    v_max3_f32 v27, v88, v89, v90
    v_max3_f32 v28, v91, v92, v93
    v_mfma_f32_16x16x32_bf16 v[108:111], a[176:179], v[208:211], v[164:167]
    v_max3_f32 v27, v27, v94, v95
    v_max_f32 v27, v27, v28
    v_mfma_f32_16x16x32_bf16 v[108:111], a[180:183], v[212:215], v[108:111]
    v_mov_b32 v28, v27
    v_mfma_f32_16x16x32_bf16 v[108:111], a[184:187], v[216:219], v[108:111]
    v_mfma_f32_16x16x32_bf16 v[108:111], a[188:191], v[220:223], v[108:111]
    v_permlane32_swap_b32 v28, v27
    v_mfma_f32_16x16x32_bf16 v[112:115], a[160:163], v[224:227], v[168:171]
    v_max_f32 v27, v27, v28
    v_mov_b32 v28, v27
    v_mfma_f32_16x16x32_bf16 v[112:115], a[164:167], v[228:231], v[112:115]
    v_mfma_f32_16x16x32_bf16 v[112:115], a[168:171], v[232:235], v[112:115]
    v_permlane16_swap_b32 v28, v27
    v_mfma_f32_16x16x32_bf16 v[112:115], a[172:175], v[236:239], v[112:115]
    v_max_f32 v27, v27, v28
    v_sub_f32 v88, v88, v27
    v_mfma_f32_16x16x32_bf16 v[116:119], a[176:179], v[224:227], v[168:171]
    v_sub_f32 v89, v89, v27
    v_sub_f32 v90, v90, v27
    v_mfma_f32_16x16x32_bf16 v[116:119], a[180:183], v[228:231], v[116:119]
    v_sub_f32 v91, v91, v27
    v_sub_f32 v92, v92, v27
    v_mfma_f32_16x16x32_bf16 v[116:119], a[184:187], v[232:235], v[116:119]
    v_sub_f32 v93, v93, v27
    v_sub_f32 v94, v94, v27
    v_mfma_f32_16x16x32_bf16 v[116:119], a[188:191], v[236:239], v[116:119]
    v_sub_f32 v95, v95, v27
    v_sub_f32 v172, 0, v27
    v_sub_f32 v173, 0, v27
    v_sub_f32 v174, 0, v27
    v_sub_f32 v175, 0, v27
    v_add_u32 v2, s49, v2
    v_add_u32 v3, s49, v3
    v_add_u32 v4, s49, v4
    v_mfma_f32_16x16x32_bf16 v[120:123], a[160:163], v[240:243], v[172:175]
    v_add_u32 v5, s49, v5
    v_add_u32 v6, s49, v6
    v_mfma_f32_16x16x32_bf16 v[120:123], a[164:167], v[244:247], v[120:123]
    s_barrier
    v_add_u32 v7, s49, v7
    v_mfma_f32_16x16x32_bf16 v[120:123], a[168:171], v[248:251], v[120:123]
    ds_read_b128 a[128:131], v2 offset:0
    v_add_u32 v8, s49, v8
    v_mfma_f32_16x16x32_bf16 v[120:123], a[172:175], v[252:255], v[120:123]
    ds_read_b128 a[132:135], v3 offset:0
    v_add_u32 v9, s49, v9
    v_mfma_f32_16x16x32_bf16 v[124:127], a[176:179], v[240:243], v[172:175]
    ds_read_b128 a[136:139], v4 offset:0
    v_add_u32 v10, s49, v10
    v_mfma_f32_16x16x32_bf16 v[124:127], a[180:183], v[244:247], v[124:127]
    ds_read_b128 a[140:143], v5 offset:0
    v_add_u32 v11, s49, v11
    v_mfma_f32_16x16x32_bf16 v[124:127], a[184:187], v[248:251], v[124:127]
    ds_read_b128 a[144:147], v2 offset:4096
    v_add_u32 v12, s49, v12
    v_mfma_f32_16x16x32_bf16 v[124:127], a[188:191], v[252:255], v[124:127]
    ds_read_b128 a[148:151], v3 offset:4096
    v_add_u32 v13, s49, v13
    ds_read_b128 a[152:155], v4 offset:4096
    v_cvt_pk_bf16_f32 v131, v70, v71
    ds_read_b128 a[156:159], v5 offset:4096
    v_exp_f32 v73, v73
    ds_read_b64_tr_b16 a[160:161], v6 offset:0
    v_exp_f32 v74, v74
    ds_read_b64_tr_b16 a[162:163], v6 offset:4096
    v_cvt_pk_bf16_f32 v132, v72, v73
    ds_read_b64_tr_b16 a[164:165], v7 offset:0
    v_exp_f32 v75, v75
    ds_read_b64_tr_b16 a[166:167], v7 offset:4096
    v_exp_f32 v76, v76
    ds_read_b64_tr_b16 a[168:169], v8 offset:0
    v_cvt_pk_bf16_f32 v133, v74, v75
    ds_read_b64_tr_b16 a[170:171], v8 offset:4096
    v_exp_f32 v77, v77
    v_exp_f32 v78, v78
    v_cvt_pk_bf16_f32 v134, v76, v77
    v_exp_f32 v79, v79
    v_exp_f32 v80, v80
    v_cvt_pk_bf16_f32 v135, v78, v79
    v_exp_f32 v81, v81
    v_exp_f32 v82, v82
    v_cvt_pk_bf16_f32 v136, v80, v81
    v_exp_f32 v83, v83
    v_exp_f32 v84, v84
    v_cvt_pk_bf16_f32 v137, v82, v83
    v_exp_f32 v85, v85
    v_exp_f32 v86, v86
    v_cvt_pk_bf16_f32 v138, v84, v85
    v_exp_f32 v87, v87
    v_exp_f32 v88, v88
    v_cvt_pk_bf16_f32 v139, v86, v87
    v_exp_f32 v89, v89
    v_exp_f32 v90, v90
    v_cvt_pk_bf16_f32 v140, v88, v89
    v_exp_f32 v91, v91
    v_exp_f32 v92, v92
    v_cvt_pk_bf16_f32 v141, v90, v91
    v_exp_f32 v93, v93
    v_exp_f32 v94, v94
    v_cvt_pk_bf16_f32 v142, v92, v93
    v_exp_f32 v95, v95
    v_exp_f32 v96, v96
    v_cvt_pk_bf16_f32 v143, v94, v95
    v_exp_f32 v97, v97
    s_waitcnt lgkmcnt(6)
    v_cvt_pk_bf16_f32 v144, v96, v97
    s_waitcnt vmcnt(0)
    v_mov_b32 v24, 0
    v_mov_b32 v25, 0
    buffer_store_dwordx2 v[24:25], v17, s[24:27], s84 offen sc1
    buffer_store_dwordx2 v[24:25], v17, s[24:27], s85 offen sc1
    s_add_u32 s43, s63, 1
    s_and_b32 s43, s43, 3
    s_sub_u32 s43, s43, s63
    s_lshl1_add_u32 s43, s43, s2
    s_lshl2_add_u32 s43, s43, s40
    s_lshl_b32 s43, s43, 9
    s_add_u32 s43, s43, 17301504
    buffer_store_dwordx2 v[24:25], v17, s[24:27], s43 offen sc1
    s_add_u32 s43, s63, 2
    s_and_b32 s43, s43, 3
    s_sub_u32 s43, s43, s63
    s_lshl1_add_u32 s43, s43, s2
    s_lshl2_add_u32 s43, s43, s40
    s_lshl_b32 s43, s43, 9
    s_add_u32 s43, s43, 17301632
    buffer_store_dwordx2 v[24:25], v17, s[24:27], s43 offen sc1
    s_add_u32 s43, s63, 3
    s_and_b32 s43, s43, 3
    s_sub_u32 s43, s43, s63
    s_lshl1_add_u32 s43, s43, s2
    s_lshl2_add_u32 s43, s43, s40
    s_lshl_b32 s43, s43, 9
    s_add_u32 s43, s43, 17301760
    buffer_store_dwordx2 v[24:25], v17, s[24:27], s43 offen sc1
    v_cmp_eq_u64 vcc, 0, v[56:57]
    s_nop 4
    s_cbranch_vccnz L_non4_spin
L_non4_ok:
L_steady_q4:
    s_mov_b32 s53, 15
.p2align 6
L_loop_q4:
    v_mfma_f32_16x16x32_bf16 v[64:67], a[128:131], v[192:195], v[160:163]
    v_exp_f32 v98, v98
    v_mfma_f32_16x16x32_bf16 v[64:67], a[132:135], v[196:199], v[64:67]
    ds_read_b64_tr_b16 a[172:173], v9 offset:0
    v_mfma_f32_16x16x32_bf16 v[64:67], a[136:139], v[200:203], v[64:67]
    v_exp_f32 v99, v99
    v_mfma_f32_16x16x32_bf16 v[64:67], a[140:143], v[204:207], v[64:67]
    ds_read_b64_tr_b16 a[174:175], v9 offset:4096
    v_cvt_pk_bf16_f32 v145, v98, v99
    v_mfma_f32_16x16x32_bf16 v[68:71], a[144:147], v[192:195], v[160:163]
    v_exp_f32 v100, v100
    v_mfma_f32_16x16x32_bf16 v[68:71], a[148:151], v[196:199], v[68:71]
    ds_read_b64_tr_b16 a[176:177], v10 offset:0
    v_mfma_f32_16x16x32_bf16 v[68:71], a[152:155], v[200:203], v[68:71]
    v_exp_f32 v101, v101
    v_mfma_f32_16x16x32_bf16 v[68:71], a[156:159], v[204:207], v[68:71]
    ds_read_b64_tr_b16 a[178:179], v10 offset:4096
    v_cvt_pk_bf16_f32 v146, v100, v101
    v_mfma_f32_16x16x32_bf16 v[72:75], a[128:131], v[208:211], v[164:167]
    v_exp_f32 v102, v102
    v_mfma_f32_16x16x32_bf16 v[72:75], a[132:135], v[212:215], v[72:75]
    ds_read_b64_tr_b16 a[180:181], v11 offset:0
    v_mfma_f32_16x16x32_bf16 v[72:75], a[136:139], v[216:219], v[72:75]
    v_exp_f32 v103, v103
    v_mfma_f32_16x16x32_bf16 v[72:75], a[140:143], v[220:223], v[72:75]
    ds_read_b64_tr_b16 a[182:183], v11 offset:4096
    v_cvt_pk_bf16_f32 v147, v102, v103
    v_mfma_f32_16x16x32_bf16 v[76:79], a[144:147], v[208:211], v[164:167]
    v_exp_f32 v104, v104
    v_mfma_f32_16x16x32_bf16 v[76:79], a[148:151], v[212:215], v[76:79]
    ds_read_b64_tr_b16 a[184:185], v12 offset:0
    v_mfma_f32_16x16x32_bf16 v[76:79], a[152:155], v[216:219], v[76:79]
    v_exp_f32 v105, v105
    v_mfma_f32_16x16x32_bf16 v[76:79], a[156:159], v[220:223], v[76:79]
    ds_read_b64_tr_b16 a[186:187], v12 offset:4096
    v_cvt_pk_bf16_f32 v148, v104, v105
    v_mfma_f32_16x16x32_bf16 v[80:83], a[128:131], v[224:227], v[168:171]
    v_exp_f32 v106, v106
    v_mfma_f32_16x16x32_bf16 v[80:83], a[132:135], v[228:231], v[80:83]
    ds_read_b64_tr_b16 a[188:189], v13 offset:0
    v_mfma_f32_16x16x32_bf16 v[80:83], a[136:139], v[232:235], v[80:83]
    v_exp_f32 v107, v107
    v_mfma_f32_16x16x32_bf16 v[80:83], a[140:143], v[236:239], v[80:83]
    ds_read_b64_tr_b16 a[190:191], v13 offset:4096
    v_cvt_pk_bf16_f32 v149, v106, v107
    v_mfma_f32_16x16x32_bf16 v[84:87], a[144:147], v[224:227], v[168:171]
    v_exp_f32 v108, v108
    v_mfma_f32_16x16x32_bf16 v[84:87], a[148:151], v[228:231], v[84:87]
    v_mfma_f32_16x16x32_bf16 v[84:87], a[152:155], v[232:235], v[84:87]
    v_exp_f32 v109, v109
    v_mfma_f32_16x16x32_bf16 v[84:87], a[156:159], v[236:239], v[84:87]
    v_cvt_pk_bf16_f32 v150, v108, v109
    v_mfma_f32_16x16x32_bf16 v[88:91], a[128:131], v[240:243], v[172:175]
    v_exp_f32 v110, v110
    v_mfma_f32_16x16x32_bf16 v[88:91], a[132:135], v[244:247], v[88:91]
    v_mfma_f32_16x16x32_bf16 v[88:91], a[136:139], v[248:251], v[88:91]
    v_exp_f32 v111, v111
    v_mfma_f32_16x16x32_bf16 v[88:91], a[140:143], v[252:255], v[88:91]
    v_cvt_pk_bf16_f32 v151, v110, v111
    v_mfma_f32_16x16x32_bf16 v[92:95], a[144:147], v[240:243], v[172:175]
    v_exp_f32 v112, v112
    v_mfma_f32_16x16x32_bf16 v[92:95], a[148:151], v[244:247], v[92:95]
    v_mfma_f32_16x16x32_bf16 v[92:95], a[152:155], v[248:251], v[92:95]
    s_waitcnt lgkmcnt(0)
    v_exp_f32 v113, v113
    v_mfma_f32_16x16x32_bf16 v[92:95], a[156:159], v[252:255], v[92:95]
    ds_read_b128 a[128:131], v2 offset:8192
    v_cvt_pk_bf16_f32 v152, v112, v113
    v_mfma_f32_16x16x32_bf16 a[0:3], a[160:163], v[128:131], a[0:3]
    v_exp_f32 v114, v114
    v_smfmac_f32_16x16x64_bf16 a[192:195], v[20:23], v[128:135], v59
    ds_read_b128 a[132:135], v3 offset:8192
    v_mfma_f32_16x16x32_bf16 a[32:35], a[160:163], v[132:135], a[32:35]
    v_exp_f32 v115, v115
    v_smfmac_f32_16x16x64_bf16 a[196:199], v[20:23], v[136:143], v59
    ds_read_b128 a[136:139], v4 offset:8192
    v_cvt_pk_bf16_f32 v153, v114, v115
    v_mfma_f32_16x16x32_bf16 a[64:67], a[160:163], v[136:139], a[64:67]
    v_exp_f32 v116, v116
    v_mfma_f32_16x16x32_bf16 a[96:99], a[160:163], v[140:143], a[96:99]
    ds_read_b128 a[140:143], v5 offset:8192
    v_mfma_f32_16x16x32_bf16 a[4:7], a[164:167], v[128:131], a[4:7]
    v_exp_f32 v117, v117
    v_mfma_f32_16x16x32_bf16 a[36:39], a[164:167], v[132:135], a[36:39]
    ds_read_b128 a[144:147], v2 offset:12288
    v_cvt_pk_bf16_f32 v154, v116, v117
    v_mfma_f32_16x16x32_bf16 a[68:71], a[164:167], v[136:139], a[68:71]
    v_exp_f32 v118, v118
    v_mfma_f32_16x16x32_bf16 a[100:103], a[164:167], v[140:143], a[100:103]
    ds_read_b128 a[148:151], v3 offset:12288
    v_mfma_f32_16x16x32_bf16 a[8:11], a[168:171], v[128:131], a[8:11]
    v_exp_f32 v119, v119
    v_mfma_f32_16x16x32_bf16 a[40:43], a[168:171], v[132:135], a[40:43]
    ds_read_b128 a[152:155], v4 offset:12288
    v_cvt_pk_bf16_f32 v155, v118, v119
    v_mfma_f32_16x16x32_bf16 a[72:75], a[168:171], v[136:139], a[72:75]
    v_exp_f32 v120, v120
    v_mfma_f32_16x16x32_bf16 a[104:107], a[168:171], v[140:143], a[104:107]
    ds_read_b128 a[156:159], v5 offset:12288
    v_mfma_f32_16x16x32_bf16 a[12:15], a[172:175], v[128:131], a[12:15]
    v_exp_f32 v121, v121
    v_mfma_f32_16x16x32_bf16 a[44:47], a[172:175], v[132:135], a[44:47]
    v_cvt_pk_bf16_f32 v156, v120, v121
    v_mfma_f32_16x16x32_bf16 a[76:79], a[172:175], v[136:139], a[76:79]
    v_exp_f32 v122, v122
    v_mfma_f32_16x16x32_bf16 a[108:111], a[172:175], v[140:143], a[108:111]
    v_mfma_f32_16x16x32_bf16 a[16:19], a[176:179], v[128:131], a[16:19]
    v_exp_f32 v123, v123
    v_mfma_f32_16x16x32_bf16 a[48:51], a[176:179], v[132:135], a[48:51]
    v_cvt_pk_bf16_f32 v157, v122, v123
    v_mfma_f32_16x16x32_bf16 a[80:83], a[176:179], v[136:139], a[80:83]
    v_exp_f32 v124, v124
    v_mfma_f32_16x16x32_bf16 a[112:115], a[176:179], v[140:143], a[112:115]
    v_mfma_f32_16x16x32_bf16 a[20:23], a[180:183], v[128:131], a[20:23]
    v_exp_f32 v125, v125
    v_mfma_f32_16x16x32_bf16 a[52:55], a[180:183], v[132:135], a[52:55]
    ds_read_b64_tr_b16 a[160:161], v6 offset:8192
    v_cvt_pk_bf16_f32 v158, v124, v125
    v_mfma_f32_16x16x32_bf16 a[84:87], a[180:183], v[136:139], a[84:87]
    v_exp_f32 v126, v126
    v_mfma_f32_16x16x32_bf16 a[116:119], a[180:183], v[140:143], a[116:119]
    ds_read_b64_tr_b16 a[162:163], v6 offset:12288
    v_mfma_f32_16x16x32_bf16 a[24:27], a[184:187], v[128:131], a[24:27]
    v_exp_f32 v127, v127
    v_mfma_f32_16x16x32_bf16 a[56:59], a[184:187], v[132:135], a[56:59]
    ds_read_b64_tr_b16 a[164:165], v7 offset:8192
    v_cvt_pk_bf16_f32 v159, v126, v127
    v_mfma_f32_16x16x32_bf16 a[88:91], a[184:187], v[136:139], a[88:91]
    v_mfma_f32_16x16x32_bf16 a[120:123], a[184:187], v[140:143], a[120:123]
    ds_read_b64_tr_b16 a[166:167], v7 offset:12288
    v_mfma_f32_16x16x32_bf16 a[28:31], a[188:191], v[128:131], a[28:31]
    v_exp_f32 v64, v64
    v_mfma_f32_16x16x32_bf16 a[60:63], a[188:191], v[132:135], a[60:63]
    ds_read_b64_tr_b16 a[168:169], v8 offset:8192
    v_mfma_f32_16x16x32_bf16 a[92:95], a[188:191], v[136:139], a[92:95]
    v_exp_f32 v65, v65
    v_mfma_f32_16x16x32_bf16 a[124:127], a[188:191], v[140:143], a[124:127]
    s_waitcnt lgkmcnt(5)
    ds_read_b64_tr_b16 a[170:171], v8 offset:12288
    v_cvt_pk_bf16_f32 v128, v64, v65
    v_mfma_f32_16x16x32_bf16 v[96:99], a[128:131], v[192:195], v[160:163]
    s_cmp_eq_u32 s48, 65536
    s_cselect_b32 s49, s50, 16384
    v_exp_f32 v66, v66
    v_mfma_f32_16x16x32_bf16 v[96:99], a[132:135], v[196:199], v[96:99]
    s_add_u32 s48, s48, s49
    ds_read_b64_tr_b16 a[172:173], v9 offset:8192
    v_mfma_f32_16x16x32_bf16 v[96:99], a[136:139], v[200:203], v[96:99]
    v_exp_f32 v67, v67
    v_mfma_f32_16x16x32_bf16 v[96:99], a[140:143], v[204:207], v[96:99]
    ds_read_b64_tr_b16 a[174:175], v9 offset:12288
    v_cvt_pk_bf16_f32 v129, v66, v67
    v_mfma_f32_16x16x32_bf16 v[100:103], a[144:147], v[192:195], v[160:163]
    v_exp_f32 v68, v68
    v_mfma_f32_16x16x32_bf16 v[100:103], a[148:151], v[196:199], v[100:103]
    ds_read_b64_tr_b16 a[176:177], v10 offset:8192
    v_add_u32 v2, s49, v2
    v_mfma_f32_16x16x32_bf16 v[100:103], a[152:155], v[200:203], v[100:103]
    v_exp_f32 v69, v69
    v_mfma_f32_16x16x32_bf16 v[100:103], a[156:159], v[204:207], v[100:103]
    ds_read_b64_tr_b16 a[178:179], v10 offset:12288
    v_cvt_pk_bf16_f32 v130, v68, v69
    v_mfma_f32_16x16x32_bf16 v[104:107], a[128:131], v[208:211], v[164:167]
    v_exp_f32 v70, v70
    v_mfma_f32_16x16x32_bf16 v[104:107], a[132:135], v[212:215], v[104:107]
    ds_read_b64_tr_b16 a[180:181], v11 offset:8192
    v_add_u32 v3, s49, v3
    v_mfma_f32_16x16x32_bf16 v[104:107], a[136:139], v[216:219], v[104:107]
    v_exp_f32 v71, v71
    v_mfma_f32_16x16x32_bf16 v[104:107], a[140:143], v[220:223], v[104:107]
    ds_read_b64_tr_b16 a[182:183], v11 offset:12288
    v_cvt_pk_bf16_f32 v131, v70, v71
    v_mfma_f32_16x16x32_bf16 v[108:111], a[144:147], v[208:211], v[164:167]
    v_exp_f32 v72, v72
    v_mfma_f32_16x16x32_bf16 v[108:111], a[148:151], v[212:215], v[108:111]
    ds_read_b64_tr_b16 a[184:185], v12 offset:8192
    v_add_u32 v4, s49, v4
    v_mfma_f32_16x16x32_bf16 v[108:111], a[152:155], v[216:219], v[108:111]
    v_exp_f32 v73, v73
    v_mfma_f32_16x16x32_bf16 v[108:111], a[156:159], v[220:223], v[108:111]
    ds_read_b64_tr_b16 a[186:187], v12 offset:12288
    v_cvt_pk_bf16_f32 v132, v72, v73
    v_mfma_f32_16x16x32_bf16 v[112:115], a[128:131], v[224:227], v[168:171]
    v_exp_f32 v74, v74
    v_mfma_f32_16x16x32_bf16 v[112:115], a[132:135], v[228:231], v[112:115]
    ds_read_b64_tr_b16 a[188:189], v13 offset:8192
    v_add_u32 v5, s49, v5
    v_mfma_f32_16x16x32_bf16 v[112:115], a[136:139], v[232:235], v[112:115]
    v_exp_f32 v75, v75
    v_mfma_f32_16x16x32_bf16 v[112:115], a[140:143], v[236:239], v[112:115]
    ds_read_b64_tr_b16 a[190:191], v13 offset:12288
    v_cvt_pk_bf16_f32 v133, v74, v75
    v_mfma_f32_16x16x32_bf16 v[116:119], a[144:147], v[224:227], v[168:171]
    v_exp_f32 v76, v76
    v_mfma_f32_16x16x32_bf16 v[116:119], a[148:151], v[228:231], v[116:119]
    v_add_u32 v6, s49, v6
    v_mfma_f32_16x16x32_bf16 v[116:119], a[152:155], v[232:235], v[116:119]
    v_exp_f32 v77, v77
    v_mfma_f32_16x16x32_bf16 v[116:119], a[156:159], v[236:239], v[116:119]
    v_cvt_pk_bf16_f32 v134, v76, v77
    v_mfma_f32_16x16x32_bf16 v[120:123], a[128:131], v[240:243], v[172:175]
    v_exp_f32 v78, v78
    v_mfma_f32_16x16x32_bf16 v[120:123], a[132:135], v[244:247], v[120:123]
    v_add_u32 v7, s49, v7
    v_mfma_f32_16x16x32_bf16 v[120:123], a[136:139], v[248:251], v[120:123]
    v_exp_f32 v79, v79
    v_mfma_f32_16x16x32_bf16 v[120:123], a[140:143], v[252:255], v[120:123]
    v_cvt_pk_bf16_f32 v135, v78, v79
    v_mfma_f32_16x16x32_bf16 v[124:127], a[144:147], v[240:243], v[172:175]
    v_exp_f32 v80, v80
    v_mfma_f32_16x16x32_bf16 v[124:127], a[148:151], v[244:247], v[124:127]
    v_add_u32 v8, s49, v8
    v_mfma_f32_16x16x32_bf16 v[124:127], a[152:155], v[248:251], v[124:127]
    s_waitcnt lgkmcnt(0)
    s_barrier
    v_exp_f32 v81, v81
    v_mfma_f32_16x16x32_bf16 v[124:127], a[156:159], v[252:255], v[124:127]
    ds_read_b128 a[128:131], v2 offset:0
    v_cvt_pk_bf16_f32 v136, v80, v81
    v_mfma_f32_16x16x32_bf16 a[0:3], a[160:163], v[144:147], a[0:3]
    v_exp_f32 v82, v82
    v_smfmac_f32_16x16x64_bf16 a[192:195], v[20:23], v[144:151], v59
    ds_read_b128 a[132:135], v3 offset:0
    v_add_u32 v9, s49, v9
    v_mfma_f32_16x16x32_bf16 a[32:35], a[160:163], v[148:151], a[32:35]
    v_exp_f32 v83, v83
    v_smfmac_f32_16x16x64_bf16 a[196:199], v[20:23], v[152:159], v59
    ds_read_b128 a[136:139], v4 offset:0
    v_cvt_pk_bf16_f32 v137, v82, v83
    v_mfma_f32_16x16x32_bf16 a[64:67], a[160:163], v[152:155], a[64:67]
    v_exp_f32 v84, v84
    v_mfma_f32_16x16x32_bf16 a[96:99], a[160:163], v[156:159], a[96:99]
    ds_read_b128 a[140:143], v5 offset:0
    v_add_u32 v10, s49, v10
    v_mfma_f32_16x16x32_bf16 a[4:7], a[164:167], v[144:147], a[4:7]
    v_exp_f32 v85, v85
    v_mfma_f32_16x16x32_bf16 a[36:39], a[164:167], v[148:151], a[36:39]
    ds_read_b128 a[144:147], v2 offset:4096
    v_cvt_pk_bf16_f32 v138, v84, v85
    v_mfma_f32_16x16x32_bf16 a[68:71], a[164:167], v[152:155], a[68:71]
    v_exp_f32 v86, v86
    v_mfma_f32_16x16x32_bf16 a[100:103], a[164:167], v[156:159], a[100:103]
    ds_read_b128 a[148:151], v3 offset:4096
    v_add_u32 v11, s49, v11
    v_mfma_f32_16x16x32_bf16 a[8:11], a[168:171], v[144:147], a[8:11]
    v_exp_f32 v87, v87
    v_mfma_f32_16x16x32_bf16 a[40:43], a[168:171], v[148:151], a[40:43]
    ds_read_b128 a[152:155], v4 offset:4096
    v_cvt_pk_bf16_f32 v139, v86, v87
    v_mfma_f32_16x16x32_bf16 a[72:75], a[168:171], v[152:155], a[72:75]
    v_exp_f32 v88, v88
    v_mfma_f32_16x16x32_bf16 a[104:107], a[168:171], v[156:159], a[104:107]
    ds_read_b128 a[156:159], v5 offset:4096
    v_add_u32 v12, s49, v12
    v_mfma_f32_16x16x32_bf16 a[12:15], a[172:175], v[144:147], a[12:15]
    v_exp_f32 v89, v89
    v_mfma_f32_16x16x32_bf16 a[44:47], a[172:175], v[148:151], a[44:47]
    v_cvt_pk_bf16_f32 v140, v88, v89
    v_mfma_f32_16x16x32_bf16 a[76:79], a[172:175], v[152:155], a[76:79]
    v_exp_f32 v90, v90
    v_mfma_f32_16x16x32_bf16 a[108:111], a[172:175], v[156:159], a[108:111]
    v_add_u32 v13, s49, v13
    v_mfma_f32_16x16x32_bf16 a[16:19], a[176:179], v[144:147], a[16:19]
    v_exp_f32 v91, v91
    v_mfma_f32_16x16x32_bf16 a[48:51], a[176:179], v[148:151], a[48:51]
    v_cvt_pk_bf16_f32 v141, v90, v91
    v_mfma_f32_16x16x32_bf16 a[80:83], a[176:179], v[152:155], a[80:83]
    v_exp_f32 v92, v92
    v_mfma_f32_16x16x32_bf16 a[112:115], a[176:179], v[156:159], a[112:115]
    v_mfma_f32_16x16x32_bf16 a[20:23], a[180:183], v[144:147], a[20:23]
    v_exp_f32 v93, v93
    v_mfma_f32_16x16x32_bf16 a[52:55], a[180:183], v[148:151], a[52:55]
    ds_read_b64_tr_b16 a[160:161], v6 offset:0
    v_cvt_pk_bf16_f32 v142, v92, v93
    v_mfma_f32_16x16x32_bf16 a[84:87], a[180:183], v[152:155], a[84:87]
    v_exp_f32 v94, v94
    v_mfma_f32_16x16x32_bf16 a[116:119], a[180:183], v[156:159], a[116:119]
    ds_read_b64_tr_b16 a[162:163], v6 offset:4096
    v_mfma_f32_16x16x32_bf16 a[24:27], a[184:187], v[144:147], a[24:27]
    v_exp_f32 v95, v95
    v_mfma_f32_16x16x32_bf16 a[56:59], a[184:187], v[148:151], a[56:59]
    ds_read_b64_tr_b16 a[164:165], v7 offset:0
    v_cvt_pk_bf16_f32 v143, v94, v95
    v_mfma_f32_16x16x32_bf16 a[88:91], a[184:187], v[152:155], a[88:91]
    v_mfma_f32_16x16x32_bf16 a[120:123], a[184:187], v[156:159], a[120:123]
    ds_read_b64_tr_b16 a[166:167], v7 offset:4096
    v_mfma_f32_16x16x32_bf16 a[28:31], a[188:191], v[144:147], a[28:31]
    v_exp_f32 v96, v96
    v_mfma_f32_16x16x32_bf16 a[60:63], a[188:191], v[148:151], a[60:63]
    s_sub_u32 s53, s53, 1
    ds_read_b64_tr_b16 a[168:169], v8 offset:0
    v_mfma_f32_16x16x32_bf16 a[92:95], a[188:191], v[152:155], a[92:95]
    s_cmp_lg_u32 s53, 0
    v_exp_f32 v97, v97
    v_mfma_f32_16x16x32_bf16 a[124:127], a[188:191], v[156:159], a[124:127]
    s_waitcnt lgkmcnt(5)
    ds_read_b64_tr_b16 a[170:171], v8 offset:4096
    v_cvt_pk_bf16_f32 v144, v96, v97
    s_cbranch_scc1 L_loop_q4
    s_mov_b64 s[86:87], 0
    ds_read_b64_tr_b16 a[172:173], v9 offset:0
    ds_read_b64_tr_b16 a[174:175], v9 offset:4096
    ds_read_b64_tr_b16 a[176:177], v10 offset:0
    ds_read_b64_tr_b16 a[178:179], v10 offset:4096
    ds_read_b64_tr_b16 a[180:181], v11 offset:0
    ds_read_b64_tr_b16 a[182:183], v11 offset:4096
    ds_read_b64_tr_b16 a[184:185], v12 offset:0
    ds_read_b64_tr_b16 a[186:187], v12 offset:4096
    ds_read_b64_tr_b16 a[188:189], v13 offset:0
    ds_read_b64_tr_b16 a[190:191], v13 offset:4096
    ds_read_b64_tr_b16 a[128:129], v6 offset:8192
    ds_read_b64_tr_b16 a[130:131], v6 offset:12288
    ds_read_b64_tr_b16 a[132:133], v7 offset:8192
    ds_read_b64_tr_b16 a[134:135], v7 offset:12288
    ds_read_b64_tr_b16 a[136:137], v8 offset:8192
    ds_read_b64_tr_b16 a[138:139], v8 offset:12288
    ds_read_b64_tr_b16 a[140:141], v9 offset:8192
    ds_read_b64_tr_b16 a[142:143], v9 offset:12288
    v_mov_b32 v28, 0
    v_exp_f32 v98, v98
    v_exp_f32 v99, v99
    v_exp_f32 v100, v100
    v_exp_f32 v101, v101
    s_waitcnt lgkmcnt(8)
    ds_read_b64_tr_b16 a[144:145], v10 offset:8192
    v_exp_f32 v102, v102
    v_mfma_f32_16x16x32_bf16 a[0:3], a[160:163], v[128:131], a[0:3]
    ds_read_b64_tr_b16 a[146:147], v10 offset:12288
    v_exp_f32 v103, v103
    v_smfmac_f32_16x16x64_bf16 a[192:195], v[20:23], v[128:135], v59
    ds_read_b64_tr_b16 a[148:149], v11 offset:8192
    v_cvt_pk_bf16_f32 v145, v98, v99
    v_mfma_f32_16x16x32_bf16 a[4:7], a[164:167], v[128:131], a[4:7]
    ds_read_b64_tr_b16 a[150:151], v11 offset:12288
    v_cvt_pk_bf16_f32 v146, v100, v101
    v_mfma_f32_16x16x32_bf16 a[8:11], a[168:171], v[128:131], a[8:11]
    ds_read_b64_tr_b16 a[152:153], v12 offset:8192
    v_cvt_pk_bf16_f32 v147, v102, v103
    v_mfma_f32_16x16x32_bf16 a[12:15], a[172:175], v[128:131], a[12:15]
    ds_read_b64_tr_b16 a[154:155], v12 offset:12288
    v_exp_f32 v104, v104
    v_mfma_f32_16x16x32_bf16 a[16:19], a[176:179], v[128:131], a[16:19]
    ds_read_b64_tr_b16 a[156:157], v13 offset:8192
    v_exp_f32 v105, v105
    v_mfma_f32_16x16x32_bf16 a[20:23], a[180:183], v[128:131], a[20:23]
    ds_read_b64_tr_b16 a[158:159], v13 offset:12288
    v_exp_f32 v106, v106
    v_mfma_f32_16x16x32_bf16 a[24:27], a[184:187], v[128:131], a[24:27]
    v_exp_f32 v107, v107
    v_mfma_f32_16x16x32_bf16 a[28:31], a[188:191], v[128:131], a[28:31]
    s_waitcnt lgkmcnt(0)
    s_mov_b32 s43, 0x4b800000
    v_exp_f32 v108, v108
    v_mfma_f32_16x16x32_bf16 a[0:3], a[128:131], v[144:147], a[0:3]
    v_exp_f32 v109, v109
    v_mfma_f32_16x16x32_bf16 a[4:7], a[132:135], v[144:147], a[4:7]
    v_exp_f32 v110, v110
    v_mfma_f32_16x16x32_bf16 a[8:11], a[136:139], v[144:147], a[8:11]
    v_exp_f32 v111, v111
    v_mfma_f32_16x16x32_bf16 a[12:15], a[140:143], v[144:147], a[12:15]
    v_cvt_pk_bf16_f32 v148, v104, v105
    v_cvt_pk_bf16_f32 v149, v106, v107
    v_cvt_pk_bf16_f32 v150, v108, v109
    v_cvt_pk_bf16_f32 v151, v110, v111
    s_nop 0
    s_nop 0
    v_smfmac_f32_16x16x64_bf16 a[192:195], v[20:23], v[144:151], v59
    v_mfma_f32_16x16x32_bf16 a[16:19], a[144:147], v[144:147], a[16:19]
    v_mfma_f32_16x16x32_bf16 a[20:23], a[148:151], v[144:147], a[20:23]
    v_mfma_f32_16x16x32_bf16 a[24:27], a[152:155], v[144:147], a[24:27]
    v_mfma_f32_16x16x32_bf16 a[28:31], a[156:159], v[144:147], a[28:31]
    v_mfma_f32_16x16x32_bf16 a[32:35], a[160:163], v[132:135], a[32:35]
    v_mfma_f32_16x16x32_bf16 a[36:39], a[164:167], v[132:135], a[36:39]
    v_mfma_f32_16x16x32_bf16 a[40:43], a[168:171], v[132:135], a[40:43]
    v_mfma_f32_16x16x32_bf16 a[44:47], a[172:175], v[132:135], a[44:47]
    v_accvgpr_read_b32 v24, a192
    v_accvgpr_read_b32 v25, a193
    v_mfma_f32_16x16x32_bf16 a[48:51], a[176:179], v[132:135], a[48:51]
    v_add_f32 v24, v24, v25
    v_cmp_ngt_f32 vcc, s43, v24
    v_mfma_f32_16x16x32_bf16 a[52:55], a[180:183], v[132:135], a[52:55]
    v_rcp_f32 v24, v24
    v_mfma_f32_16x16x32_bf16 a[56:59], a[184:187], v[132:135], a[56:59]
    v_accvgpr_read_b32 v64, a0
    v_accvgpr_read_b32 v65, a1
    v_mfma_f32_16x16x32_bf16 a[60:63], a[188:191], v[132:135], a[60:63]
    v_accvgpr_read_b32 v66, a2
    v_accvgpr_read_b32 v67, a3
    v_mfma_f32_16x16x32_bf16 a[32:35], a[128:131], v[148:151], a[32:35]
    v_accvgpr_read_b32 v68, a4
    v_accvgpr_read_b32 v69, a5
    v_mfma_f32_16x16x32_bf16 a[36:39], a[132:135], v[148:151], a[36:39]
    v_accvgpr_read_b32 v70, a6
    v_accvgpr_read_b32 v71, a7
    v_mfma_f32_16x16x32_bf16 a[40:43], a[136:139], v[148:151], a[40:43]
    s_or_b64 s[86:87], s[86:87], vcc
    v_addc_co_u32 v28, vcc, 0, v28, vcc
    v_mfma_f32_16x16x32_bf16 a[44:47], a[140:143], v[148:151], a[44:47]
    v_mul_f32 v64, v64, v24
    v_mul_f32 v65, v65, v24
    v_mfma_f32_16x16x32_bf16 a[48:51], a[144:147], v[148:151], a[48:51]
    v_mul_f32 v66, v66, v24
    v_mul_f32 v67, v67, v24
    v_mfma_f32_16x16x32_bf16 a[52:55], a[148:151], v[148:151], a[52:55]
    v_mul_f32 v68, v68, v24
    v_mul_f32 v69, v69, v24
    v_mfma_f32_16x16x32_bf16 a[56:59], a[152:155], v[148:151], a[56:59]
    v_mul_f32 v70, v70, v24
    v_mul_f32 v71, v71, v24
    v_mfma_f32_16x16x32_bf16 a[60:63], a[156:159], v[148:151], a[60:63]
    v_cvt_pk_bf16_f32 v160, v64, v65
    v_cvt_pk_bf16_f32 v161, v66, v67
    v_mfma_f32_16x16x32_bf16 a[64:67], a[160:163], v[136:139], a[64:67]
    v_cvt_pk_bf16_f32 v162, v68, v69
    v_cvt_pk_bf16_f32 v163, v70, v71
    v_smfmac_f32_16x16x64_bf16 a[196:199], v[20:23], v[136:143], v59
    buffer_store_dwordx4 v[160:163], v16, s[24:27], s80 offen offset:0 sc1
    v_mfma_f32_16x16x32_bf16 a[68:71], a[164:167], v[136:139], a[68:71]
    v_accvgpr_read_b32 v72, a8
    v_accvgpr_read_b32 v73, a9
    v_mfma_f32_16x16x32_bf16 a[72:75], a[168:171], v[136:139], a[72:75]
    v_accvgpr_read_b32 v74, a10
    v_accvgpr_read_b32 v75, a11
    v_mfma_f32_16x16x32_bf16 a[76:79], a[172:175], v[136:139], a[76:79]
    v_accvgpr_read_b32 v76, a12
    v_accvgpr_read_b32 v77, a13
    v_mfma_f32_16x16x32_bf16 a[80:83], a[176:179], v[136:139], a[80:83]
    v_accvgpr_read_b32 v78, a14
    v_accvgpr_read_b32 v79, a15
    v_mfma_f32_16x16x32_bf16 a[84:87], a[180:183], v[136:139], a[84:87]
    v_mul_f32 v72, v72, v24
    v_mul_f32 v73, v73, v24
    v_mfma_f32_16x16x32_bf16 a[88:91], a[184:187], v[136:139], a[88:91]
    v_mul_f32 v74, v74, v24
    v_mul_f32 v75, v75, v24
    v_mfma_f32_16x16x32_bf16 a[92:95], a[188:191], v[136:139], a[92:95]
    v_mul_f32 v76, v76, v24
    v_mul_f32 v77, v77, v24
    v_mfma_f32_16x16x32_bf16 a[96:99], a[160:163], v[140:143], a[96:99]
    v_mul_f32 v78, v78, v24
    v_mul_f32 v79, v79, v24
    v_mfma_f32_16x16x32_bf16 a[100:103], a[164:167], v[140:143], a[100:103]
    v_cvt_pk_bf16_f32 v164, v72, v73
    v_cvt_pk_bf16_f32 v165, v74, v75
    v_mfma_f32_16x16x32_bf16 a[104:107], a[168:171], v[140:143], a[104:107]
    v_cvt_pk_bf16_f32 v166, v76, v77
    v_cvt_pk_bf16_f32 v167, v78, v79
    v_mfma_f32_16x16x32_bf16 a[108:111], a[172:175], v[140:143], a[108:111]
    buffer_store_dwordx4 v[164:167], v16, s[24:27], s80 offen offset:1024 sc1
    v_mfma_f32_16x16x32_bf16 a[112:115], a[176:179], v[140:143], a[112:115]
    v_accvgpr_read_b32 v80, a16
    v_accvgpr_read_b32 v81, a17
    v_mfma_f32_16x16x32_bf16 a[116:119], a[180:183], v[140:143], a[116:119]
    v_accvgpr_read_b32 v82, a18
    v_accvgpr_read_b32 v83, a19
    v_mfma_f32_16x16x32_bf16 a[120:123], a[184:187], v[140:143], a[120:123]
    v_accvgpr_read_b32 v84, a20
    v_accvgpr_read_b32 v85, a21
    v_mfma_f32_16x16x32_bf16 a[124:127], a[188:191], v[140:143], a[124:127]
    v_accvgpr_read_b32 v86, a22
    v_accvgpr_read_b32 v87, a23
    v_mul_f32 v80, v80, v24
    v_mul_f32 v81, v81, v24
    v_mul_f32 v82, v82, v24
    v_mul_f32 v83, v83, v24
    v_mul_f32 v84, v84, v24
    v_mul_f32 v85, v85, v24
    v_mul_f32 v86, v86, v24
    v_mul_f32 v87, v87, v24
    v_cvt_pk_bf16_f32 v168, v80, v81
    v_cvt_pk_bf16_f32 v169, v82, v83
    v_cvt_pk_bf16_f32 v170, v84, v85
    v_cvt_pk_bf16_f32 v171, v86, v87
    buffer_store_dwordx4 v[168:171], v16, s[24:27], s80 offen offset:2048 sc1
    v_accvgpr_read_b32 v88, a24
    v_accvgpr_read_b32 v89, a25
    v_accvgpr_read_b32 v90, a26
    v_accvgpr_read_b32 v91, a27
    v_accvgpr_read_b32 v92, a28
    v_accvgpr_read_b32 v93, a29
    v_accvgpr_read_b32 v94, a30
    v_accvgpr_read_b32 v95, a31
    v_mul_f32 v88, v88, v24
    v_mul_f32 v89, v89, v24
    v_mul_f32 v90, v90, v24
    v_mul_f32 v91, v91, v24
    v_mul_f32 v92, v92, v24
    v_mul_f32 v93, v93, v24
    v_mul_f32 v94, v94, v24
    v_mul_f32 v95, v95, v24
    v_cvt_pk_bf16_f32 v172, v88, v89
    v_cvt_pk_bf16_f32 v173, v90, v91
    v_cvt_pk_bf16_f32 v174, v92, v93
    v_cvt_pk_bf16_f32 v175, v94, v95
    buffer_store_dwordx4 v[172:175], v16, s[24:27], s80 offen offset:3072 sc1
    v_exp_f32 v112, v112
    v_exp_f32 v113, v113
    v_exp_f32 v114, v114
    v_exp_f32 v115, v115
    v_exp_f32 v116, v116
    v_exp_f32 v117, v117
    v_exp_f32 v118, v118
    v_exp_f32 v119, v119
    v_cvt_pk_bf16_f32 v152, v112, v113
    v_cvt_pk_bf16_f32 v153, v114, v115
    v_cvt_pk_bf16_f32 v154, v116, v117
    v_cvt_pk_bf16_f32 v155, v118, v119
    v_exp_f32 v120, v120
    v_exp_f32 v121, v121
    v_mfma_f32_16x16x32_bf16 a[64:67], a[128:131], v[152:155], a[64:67]
    v_exp_f32 v122, v122
    v_mfma_f32_16x16x32_bf16 a[68:71], a[132:135], v[152:155], a[68:71]
    v_exp_f32 v123, v123
    v_mfma_f32_16x16x32_bf16 a[72:75], a[136:139], v[152:155], a[72:75]
    v_exp_f32 v124, v124
    v_mfma_f32_16x16x32_bf16 a[76:79], a[140:143], v[152:155], a[76:79]
    v_exp_f32 v125, v125
    v_exp_f32 v126, v126
    v_exp_f32 v127, v127
    v_cvt_pk_bf16_f32 v156, v120, v121
    v_cvt_pk_bf16_f32 v157, v122, v123
    v_cvt_pk_bf16_f32 v158, v124, v125
    v_cvt_pk_bf16_f32 v159, v126, v127
    v_accvgpr_read_b32 v26, a194
    v_accvgpr_read_b32 v27, a195
    v_smfmac_f32_16x16x64_bf16 a[196:199], v[20:23], v[152:159], v59
    v_add_f32 v26, v26, v27
    v_cmp_ngt_f32 vcc, s43, v26
    v_mfma_f32_16x16x32_bf16 a[80:83], a[144:147], v[152:155], a[80:83]
    v_rcp_f32 v26, v26
    v_mfma_f32_16x16x32_bf16 a[84:87], a[148:151], v[152:155], a[84:87]
    v_accvgpr_read_b32 v64, a32
    v_accvgpr_read_b32 v65, a33
    v_mfma_f32_16x16x32_bf16 a[88:91], a[152:155], v[152:155], a[88:91]
    v_accvgpr_read_b32 v66, a34
    v_accvgpr_read_b32 v67, a35
    v_mfma_f32_16x16x32_bf16 a[92:95], a[156:159], v[152:155], a[92:95]
    v_accvgpr_read_b32 v68, a36
    v_accvgpr_read_b32 v69, a37
    v_mfma_f32_16x16x32_bf16 a[96:99], a[128:131], v[156:159], a[96:99]
    v_accvgpr_read_b32 v70, a38
    v_accvgpr_read_b32 v71, a39
    v_mfma_f32_16x16x32_bf16 a[100:103], a[132:135], v[156:159], a[100:103]
    s_or_b64 s[86:87], s[86:87], vcc
    v_addc_co_u32 v28, vcc, 0, v28, vcc
    v_mfma_f32_16x16x32_bf16 a[104:107], a[136:139], v[156:159], a[104:107]
    v_mul_f32 v64, v64, v26
    v_mul_f32 v65, v65, v26
    v_mfma_f32_16x16x32_bf16 a[108:111], a[140:143], v[156:159], a[108:111]
    v_mul_f32 v66, v66, v26
    v_mul_f32 v67, v67, v26
    v_mfma_f32_16x16x32_bf16 a[112:115], a[144:147], v[156:159], a[112:115]
    v_mul_f32 v68, v68, v26
    v_mul_f32 v69, v69, v26
    v_mfma_f32_16x16x32_bf16 a[116:119], a[148:151], v[156:159], a[116:119]
    v_mul_f32 v70, v70, v26
    v_mul_f32 v71, v71, v26
    v_mfma_f32_16x16x32_bf16 a[120:123], a[152:155], v[156:159], a[120:123]
    v_cvt_pk_bf16_f32 v176, v64, v65
    v_cvt_pk_bf16_f32 v177, v66, v67
    v_mfma_f32_16x16x32_bf16 a[124:127], a[156:159], v[156:159], a[124:127]
    v_cvt_pk_bf16_f32 v178, v68, v69
    v_cvt_pk_bf16_f32 v179, v70, v71
    buffer_store_dwordx4 v[176:179], v16, s[24:27], s81 offen offset:0 sc1
    v_accvgpr_read_b32 v72, a40
    v_accvgpr_read_b32 v73, a41
    v_accvgpr_read_b32 v74, a42
    v_accvgpr_read_b32 v75, a43
    v_accvgpr_read_b32 v76, a44
    v_accvgpr_read_b32 v77, a45
    v_accvgpr_read_b32 v78, a46
    v_accvgpr_read_b32 v79, a47
    v_mul_f32 v72, v72, v26
    v_mul_f32 v73, v73, v26
    v_mul_f32 v74, v74, v26
    v_mul_f32 v75, v75, v26
    v_mul_f32 v76, v76, v26
    v_mul_f32 v77, v77, v26
    v_mul_f32 v78, v78, v26
    v_mul_f32 v79, v79, v26
    v_cvt_pk_bf16_f32 v180, v72, v73
    v_cvt_pk_bf16_f32 v181, v74, v75
    v_cvt_pk_bf16_f32 v182, v76, v77
    v_cvt_pk_bf16_f32 v183, v78, v79
    buffer_store_dwordx4 v[180:183], v16, s[24:27], s81 offen offset:1024 sc1
    v_accvgpr_read_b32 v80, a48
    v_accvgpr_read_b32 v81, a49
    v_accvgpr_read_b32 v82, a50
    v_accvgpr_read_b32 v83, a51
    v_accvgpr_read_b32 v84, a52
    v_accvgpr_read_b32 v85, a53
    v_accvgpr_read_b32 v86, a54
    v_accvgpr_read_b32 v87, a55
    v_pk_mul_f32 v[80:81], v[80:81], v[26:27] op_sel_hi:[1,0]
    v_pk_mul_f32 v[82:83], v[82:83], v[26:27] op_sel_hi:[1,0]
    v_pk_mul_f32 v[84:85], v[84:85], v[26:27] op_sel_hi:[1,0]
    v_pk_mul_f32 v[86:87], v[86:87], v[26:27] op_sel_hi:[1,0]
    v_cvt_pk_bf16_f32 v184, v80, v81
    v_cvt_pk_bf16_f32 v185, v82, v83
    v_cvt_pk_bf16_f32 v186, v84, v85
    v_cvt_pk_bf16_f32 v187, v86, v87
    buffer_store_dwordx4 v[184:187], v16, s[24:27], s81 offen offset:2048 sc1
    v_accvgpr_read_b32 v88, a56
    v_accvgpr_read_b32 v89, a57
    v_accvgpr_read_b32 v90, a58
    v_accvgpr_read_b32 v91, a59
    v_accvgpr_read_b32 v92, a60
    v_accvgpr_read_b32 v93, a61
    v_accvgpr_read_b32 v94, a62
    v_accvgpr_read_b32 v95, a63
    v_pk_mul_f32 v[88:89], v[88:89], v[26:27] op_sel_hi:[1,0]
    v_pk_mul_f32 v[90:91], v[90:91], v[26:27] op_sel_hi:[1,0]
    v_pk_mul_f32 v[92:93], v[92:93], v[26:27] op_sel_hi:[1,0]
    v_pk_mul_f32 v[94:95], v[94:95], v[26:27] op_sel_hi:[1,0]
    v_cvt_pk_bf16_f32 v188, v88, v89
    v_cvt_pk_bf16_f32 v189, v90, v91
    v_cvt_pk_bf16_f32 v190, v92, v93
    v_cvt_pk_bf16_f32 v191, v94, v95
    buffer_store_dwordx4 v[188:191], v16, s[24:27], s81 offen offset:3072 sc1
    v_accvgpr_read_b32 v24, a196
    v_accvgpr_read_b32 v25, a197
    v_add_f32 v24, v24, v25
    v_cmp_ngt_f32 vcc, s43, v24
    v_rcp_f32 v24, v24
    v_accvgpr_read_b32 v64, a64
    v_accvgpr_read_b32 v65, a65
    v_accvgpr_read_b32 v66, a66
    v_accvgpr_read_b32 v67, a67
    v_accvgpr_read_b32 v68, a68
    v_accvgpr_read_b32 v69, a69
    v_accvgpr_read_b32 v70, a70
    v_accvgpr_read_b32 v71, a71
    v_addc_co_u32 v28, vcc, 0, v28, vcc
    v_pk_mul_f32 v[64:65], v[64:65], v[24:25] op_sel_hi:[1,0]
    v_pk_mul_f32 v[66:67], v[66:67], v[24:25] op_sel_hi:[1,0]
    v_pk_mul_f32 v[68:69], v[68:69], v[24:25] op_sel_hi:[1,0]
    v_pk_mul_f32 v[70:71], v[70:71], v[24:25] op_sel_hi:[1,0]
    v_cvt_pk_bf16_f32 v160, v64, v65
    v_cvt_pk_bf16_f32 v161, v66, v67
    v_cvt_pk_bf16_f32 v162, v68, v69
    v_cvt_pk_bf16_f32 v163, v70, v71
    v_accvgpr_read_b32 v72, a72
    buffer_store_dwordx4 v[160:163], v16, s[24:27], s82 offen offset:0 sc1
    v_accvgpr_read_b32 v73, a73
    v_accvgpr_read_b32 v74, a74
    v_accvgpr_read_b32 v75, a75
    v_accvgpr_read_b32 v76, a76
    v_accvgpr_read_b32 v77, a77
    v_accvgpr_read_b32 v78, a78
    v_accvgpr_read_b32 v79, a79
    v_pk_mul_f32 v[72:73], v[72:73], v[24:25] op_sel_hi:[1,0]
    v_pk_mul_f32 v[74:75], v[74:75], v[24:25] op_sel_hi:[1,0]
    v_pk_mul_f32 v[76:77], v[76:77], v[24:25] op_sel_hi:[1,0]
    v_pk_mul_f32 v[78:79], v[78:79], v[24:25] op_sel_hi:[1,0]
    v_cvt_pk_bf16_f32 v164, v72, v73
    v_cvt_pk_bf16_f32 v165, v74, v75
    v_cvt_pk_bf16_f32 v166, v76, v77
    v_cvt_pk_bf16_f32 v167, v78, v79
    v_accvgpr_read_b32 v80, a80
    buffer_store_dwordx4 v[164:167], v16, s[24:27], s82 offen offset:1024 sc1
    v_accvgpr_read_b32 v81, a81
    v_accvgpr_read_b32 v82, a82
    v_accvgpr_read_b32 v83, a83
    v_accvgpr_read_b32 v84, a84
    v_accvgpr_read_b32 v85, a85
    v_accvgpr_read_b32 v86, a86
    v_accvgpr_read_b32 v87, a87
    v_pk_mul_f32 v[80:81], v[80:81], v[24:25] op_sel_hi:[1,0]
    v_pk_mul_f32 v[82:83], v[82:83], v[24:25] op_sel_hi:[1,0]
    v_pk_mul_f32 v[84:85], v[84:85], v[24:25] op_sel_hi:[1,0]
    v_pk_mul_f32 v[86:87], v[86:87], v[24:25] op_sel_hi:[1,0]
    v_cvt_pk_bf16_f32 v168, v80, v81
    v_cvt_pk_bf16_f32 v169, v82, v83
    v_cvt_pk_bf16_f32 v170, v84, v85
    v_cvt_pk_bf16_f32 v171, v86, v87
    v_accvgpr_read_b32 v88, a88
    buffer_store_dwordx4 v[168:171], v16, s[24:27], s82 offen offset:2048 sc1
    v_accvgpr_read_b32 v89, a89
    v_accvgpr_read_b32 v90, a90
    v_accvgpr_read_b32 v91, a91
    v_accvgpr_read_b32 v92, a92
    v_accvgpr_read_b32 v93, a93
    v_accvgpr_read_b32 v94, a94
    v_accvgpr_read_b32 v95, a95
    v_pk_mul_f32 v[88:89], v[88:89], v[24:25] op_sel_hi:[1,0]
    v_pk_mul_f32 v[90:91], v[90:91], v[24:25] op_sel_hi:[1,0]
    v_pk_mul_f32 v[92:93], v[92:93], v[24:25] op_sel_hi:[1,0]
    v_pk_mul_f32 v[94:95], v[94:95], v[24:25] op_sel_hi:[1,0]
    v_cvt_pk_bf16_f32 v172, v88, v89
    v_cvt_pk_bf16_f32 v173, v90, v91
    v_cvt_pk_bf16_f32 v174, v92, v93
    v_cvt_pk_bf16_f32 v175, v94, v95
    v_accvgpr_read_b32 v26, a198
    buffer_store_dwordx4 v[172:175], v16, s[24:27], s82 offen offset:3072 sc1
    v_accvgpr_read_b32 v27, a199
    v_add_f32 v26, v26, v27
    v_cmp_ngt_f32 vcc, s43, v26
    v_rcp_f32 v26, v26
    v_accvgpr_read_b32 v64, a96
    v_accvgpr_read_b32 v65, a97
    v_accvgpr_read_b32 v66, a98
    v_accvgpr_read_b32 v67, a99
    v_accvgpr_read_b32 v68, a100
    v_accvgpr_read_b32 v69, a101
    v_accvgpr_read_b32 v70, a102
    v_accvgpr_read_b32 v71, a103
    v_addc_co_u32 v28, vcc, 0, v28, vcc
    v_pk_mul_f32 v[64:65], v[64:65], v[26:27] op_sel_hi:[1,0]
    v_pk_mul_f32 v[66:67], v[66:67], v[26:27] op_sel_hi:[1,0]
    v_pk_mul_f32 v[68:69], v[68:69], v[26:27] op_sel_hi:[1,0]
    v_pk_mul_f32 v[70:71], v[70:71], v[26:27] op_sel_hi:[1,0]
    v_cvt_pk_bf16_f32 v176, v64, v65
    v_cvt_pk_bf16_f32 v177, v66, v67
    v_cvt_pk_bf16_f32 v178, v68, v69
    v_cvt_pk_bf16_f32 v179, v70, v71
    v_accvgpr_read_b32 v72, a104
    buffer_store_dwordx4 v[176:179], v16, s[24:27], s83 offen offset:0 sc1
    v_accvgpr_read_b32 v73, a105
    v_accvgpr_read_b32 v74, a106
    v_accvgpr_read_b32 v75, a107
    v_accvgpr_read_b32 v76, a108
    v_accvgpr_read_b32 v77, a109
    v_accvgpr_read_b32 v78, a110
    v_accvgpr_read_b32 v79, a111
    v_pk_mul_f32 v[72:73], v[72:73], v[26:27] op_sel_hi:[1,0]
    v_pk_mul_f32 v[74:75], v[74:75], v[26:27] op_sel_hi:[1,0]
    v_pk_mul_f32 v[76:77], v[76:77], v[26:27] op_sel_hi:[1,0]
    v_pk_mul_f32 v[78:79], v[78:79], v[26:27] op_sel_hi:[1,0]
    v_cvt_pk_bf16_f32 v180, v72, v73
    v_cvt_pk_bf16_f32 v181, v74, v75
    v_cvt_pk_bf16_f32 v182, v76, v77
    v_cvt_pk_bf16_f32 v183, v78, v79
    v_accvgpr_read_b32 v80, a112
    buffer_store_dwordx4 v[180:183], v16, s[24:27], s83 offen offset:1024 sc1
    v_accvgpr_read_b32 v81, a113
    v_accvgpr_read_b32 v82, a114
    v_accvgpr_read_b32 v83, a115
    v_accvgpr_read_b32 v84, a116
    v_accvgpr_read_b32 v85, a117
    v_accvgpr_read_b32 v86, a118
    v_accvgpr_read_b32 v87, a119
    v_pk_mul_f32 v[80:81], v[80:81], v[26:27] op_sel_hi:[1,0]
    v_pk_mul_f32 v[82:83], v[82:83], v[26:27] op_sel_hi:[1,0]
    v_pk_mul_f32 v[84:85], v[84:85], v[26:27] op_sel_hi:[1,0]
    v_pk_mul_f32 v[86:87], v[86:87], v[26:27] op_sel_hi:[1,0]
    v_cvt_pk_bf16_f32 v184, v80, v81
    v_cvt_pk_bf16_f32 v185, v82, v83
    v_cvt_pk_bf16_f32 v186, v84, v85
    v_cvt_pk_bf16_f32 v187, v86, v87
    v_accvgpr_read_b32 v88, a120
    buffer_store_dwordx4 v[184:187], v16, s[24:27], s83 offen offset:2048 sc1
    v_accvgpr_read_b32 v89, a121
    v_accvgpr_read_b32 v90, a122
    v_accvgpr_read_b32 v91, a123
    v_accvgpr_read_b32 v92, a124
    v_accvgpr_read_b32 v93, a125
    v_accvgpr_read_b32 v94, a126
    v_accvgpr_read_b32 v95, a127
    v_pk_mul_f32 v[88:89], v[88:89], v[26:27] op_sel_hi:[1,0]
    v_pk_mul_f32 v[90:91], v[90:91], v[26:27] op_sel_hi:[1,0]
    v_pk_mul_f32 v[92:93], v[92:93], v[26:27] op_sel_hi:[1,0]
    v_pk_mul_f32 v[94:95], v[94:95], v[26:27] op_sel_hi:[1,0]
    v_cvt_pk_bf16_f32 v188, v88, v89
    v_cvt_pk_bf16_f32 v189, v90, v91
    v_cvt_pk_bf16_f32 v190, v92, v93
    v_cvt_pk_bf16_f32 v191, v94, v95
    buffer_store_dwordx4 v[188:191], v16, s[24:27], s83 offen offset:3072 sc1
    s_cmp_lg_u32 s55, 0
    s_cselect_b64 s[86:87], 0, s[86:87]
    s_cmp_eq_u64 s[86:87], 0
    s_cselect_b32 s44, s84, 50331648
    s_waitcnt vmcnt(8)
    buffer_store_dwordx2 v[56:57], v17, s[24:27], s44 offen sc1
    s_cselect_b32 s84, 50331648, s84
    s_cselect_b32 s80, 50331648, s80
    s_cselect_b32 s81, 50331648, s81
    s_barrier
    v_lshlrev_b32 v29, 2, v0
    v_add_u32 v29, 147456, v29
    ds_write_b32 v29, v28
    ds_read_b64_tr_b16 a[0:1], v44 offset:0
    ds_read_b64_tr_b16 a[2:3], v44 offset:3072
    ds_read_b64_tr_b16 a[4:5], v45 offset:0
    ds_read_b64_tr_b16 a[6:7], v45 offset:3072
    ds_read_b64_tr_b16 a[8:9], v44 offset:64
    ds_read_b64_tr_b16 a[10:11], v44 offset:3136
    ds_read_b64_tr_b16 a[12:13], v45 offset:64
    ds_read_b64_tr_b16 a[14:15], v45 offset:3136
    ds_read_b64_tr_b16 a[16:17], v44 offset:128
    ds_read_b64_tr_b16 a[18:19], v44 offset:3200
    ds_read_b64_tr_b16 a[20:21], v45 offset:128
    ds_read_b64_tr_b16 a[22:23], v45 offset:3200
    ds_read_b64_tr_b16 a[24:25], v44 offset:6144
    ds_read_b64_tr_b16 a[26:27], v44 offset:9216
    ds_read_b64_tr_b16 a[28:29], v45 offset:6144
    ds_read_b64_tr_b16 a[30:31], v45 offset:9216
    ds_read_b64_tr_b16 a[32:33], v44 offset:6208
    ds_read_b64_tr_b16 a[34:35], v44 offset:9280
    ds_read_b64_tr_b16 a[36:37], v45 offset:6208
    ds_read_b64_tr_b16 a[38:39], v45 offset:9280
    ds_read_b64_tr_b16 a[40:41], v44 offset:6272
    ds_read_b64_tr_b16 a[42:43], v44 offset:9344
    ds_read_b64_tr_b16 a[44:45], v45 offset:6272
    ds_read_b64_tr_b16 a[46:47], v45 offset:9344
    ds_read_b64_tr_b16 a[48:49], v44 offset:12288
    ds_read_b64_tr_b16 a[50:51], v44 offset:15360
    ds_read_b64_tr_b16 a[52:53], v45 offset:12288
    ds_read_b64_tr_b16 a[54:55], v45 offset:15360
    ds_read_b64_tr_b16 a[56:57], v44 offset:12352
    ds_read_b64_tr_b16 a[58:59], v44 offset:15424
    ds_read_b64_tr_b16 a[60:61], v45 offset:12352
    ds_read_b64_tr_b16 a[62:63], v45 offset:15424
    ds_read_b64_tr_b16 a[64:65], v44 offset:12416
    ds_read_b64_tr_b16 a[66:67], v44 offset:15488
    ds_read_b64_tr_b16 a[68:69], v45 offset:12416
    ds_read_b64_tr_b16 a[70:71], v45 offset:15488
    ds_read_b64_tr_b16 a[72:73], v44 offset:18432
    ds_read_b64_tr_b16 a[74:75], v44 offset:21504
    ds_read_b64_tr_b16 a[76:77], v45 offset:18432
    ds_read_b64_tr_b16 a[78:79], v45 offset:21504
    ds_read_b64_tr_b16 a[80:81], v44 offset:18496
    ds_read_b64_tr_b16 a[82:83], v44 offset:21568
    ds_read_b64_tr_b16 a[84:85], v45 offset:18496
    ds_read_b64_tr_b16 a[86:87], v45 offset:21568
    ds_read_b64_tr_b16 a[88:89], v44 offset:18560
    ds_read_b64_tr_b16 a[90:91], v44 offset:21632
    ds_read_b64_tr_b16 a[92:93], v45 offset:18560
    ds_read_b64_tr_b16 a[94:95], v45 offset:21632
    s_waitcnt lgkmcnt(15)
    s_mul_i32 s45, s40, 294912
    s_add_u32 s46, s45, 221184
    s_add_u32 m0, s69, 0
    s_nop 0
    buffer_load_dwordx4 v41, s[28:31], s46 offen offset:0 lds
    buffer_load_dwordx4 v42, s[28:31], s46 offen offset:1024 lds
    buffer_load_dwordx4 v43, s[28:31], s46 offen offset:2048 lds
    s_add_u32 s46, s45, 239616
    s_add_u32 m0, s69, 3072
    s_nop 0
    buffer_load_dwordx4 v41, s[28:31], s46 offen offset:0 lds
    buffer_load_dwordx4 v42, s[28:31], s46 offen offset:1024 lds
    buffer_load_dwordx4 v43, s[28:31], s46 offen offset:2048 lds
    s_add_u32 s46, s45, 258048
    s_add_u32 m0, s69, 6144
    s_nop 0
    buffer_load_dwordx4 v41, s[28:31], s46 offen offset:0 lds
    buffer_load_dwordx4 v42, s[28:31], s46 offen offset:1024 lds
    buffer_load_dwordx4 v43, s[28:31], s46 offen offset:2048 lds
    s_add_u32 s46, s45, 276480
    s_add_u32 m0, s69, 9216
    s_nop 0
    buffer_load_dwordx4 v41, s[28:31], s46 offen offset:0 lds
    buffer_load_dwordx4 v42, s[28:31], s46 offen offset:1024 lds
    buffer_load_dwordx4 v43, s[28:31], s46 offen offset:2048 lds
    ds_read_b64_tr_b16 a[96:97], v44 offset:24576
    ds_read_b64_tr_b16 a[98:99], v44 offset:27648
    ds_read_b64_tr_b16 a[100:101], v45 offset:24576
    ds_read_b64_tr_b16 a[102:103], v45 offset:27648
    ds_read_b64_tr_b16 a[104:105], v44 offset:24640
    ds_read_b64_tr_b16 a[106:107], v44 offset:27712
    ds_read_b64_tr_b16 a[108:109], v45 offset:24640
    ds_read_b64_tr_b16 a[110:111], v45 offset:27712
    ds_read_b64_tr_b16 a[112:113], v44 offset:24704
    ds_read_b64_tr_b16 a[114:115], v44 offset:27776
    ds_read_b64_tr_b16 a[116:117], v45 offset:24704
    ds_read_b64_tr_b16 a[118:119], v45 offset:27776
    ds_read_b64_tr_b16 a[120:121], v44 offset:30720
    ds_read_b64_tr_b16 a[122:123], v44 offset:33792
    ds_read_b64_tr_b16 a[124:125], v45 offset:30720
    ds_read_b64_tr_b16 a[126:127], v45 offset:33792
    ds_read_b64_tr_b16 a[128:129], v44 offset:30784
    ds_read_b64_tr_b16 a[130:131], v44 offset:33856
    ds_read_b64_tr_b16 a[132:133], v45 offset:30784
    ds_read_b64_tr_b16 a[134:135], v45 offset:33856
    ds_read_b64_tr_b16 a[136:137], v44 offset:30848
    ds_read_b64_tr_b16 a[138:139], v44 offset:33920
    ds_read_b64_tr_b16 a[140:141], v45 offset:30848
    ds_read_b64_tr_b16 a[142:143], v45 offset:33920
    v_add_u32 v29, 147456, v16
    s_waitcnt lgkmcnt(0)
    s_barrier
    ds_read_b128 v[24:27], v29
    s_waitcnt lgkmcnt(0)
    v_or_b32 v24, v24, v25
    v_or3_b32 v24, v24, v26, v27
    v_cmp_ne_u32 vcc, 0, v24
    s_cmp_lg_u32 s55, 0
    s_cbranch_scc1 L_phase2
    s_nop 2
    s_cbranch_vccnz L_fallback_q4
    s_branch L_phase2
L_role_q3:
    s_waitcnt lgkmcnt(0)
    s_barrier
    ds_read_b128 a[224:227], v208 offset:32768
    ds_read_b64_tr_b16 a[128:129], v32 offset:0
    ds_read_b64_tr_b16 a[130:131], v32 offset:1024
    ds_read_b128 a[232:235], v210 offset:32768
    ds_read_b128 a[240:243], v212 offset:32768
    ds_read_b64_tr_b16 a[132:133], v33 offset:0
    ds_read_b64_tr_b16 a[134:135], v33 offset:1024
    ds_read_b64_tr_b16 a[136:137], v34 offset:0
    ds_read_b64_tr_b16 a[138:139], v34 offset:1024
    ds_read_b128 a[228:231], v209 offset:32768
    ds_read_b128 a[236:239], v211 offset:32768
    ds_read_b128 a[244:247], v213 offset:32768
    ds_read_b64_tr_b16 a[140:141], v35 offset:0
    ds_read_b64_tr_b16 a[142:143], v35 offset:1024
    s_waitcnt lgkmcnt(9)
    v_mfma_f32_16x16x32_bf16 v[64:67], a[128:131], a[224:227], 0
    ds_read_b64_tr_b16 a[144:145], v36 offset:0
    v_mfma_f32_16x16x32_bf16 v[96:99], a[128:131], a[232:235], 0
    ds_read_b64_tr_b16 a[146:147], v36 offset:1024
    v_mfma_f32_16x16x32_bf16 v[128:131], a[128:131], a[240:243], 0
    s_waitcnt lgkmcnt(9)
    ds_read_b64_tr_b16 a[148:149], v37 offset:0
    v_mfma_f32_16x16x32_bf16 v[68:71], a[132:135], a[224:227], 0
    ds_read_b64_tr_b16 a[150:151], v37 offset:1024
    v_mfma_f32_16x16x32_bf16 v[100:103], a[132:135], a[232:235], 0
    v_mfma_f32_16x16x32_bf16 v[132:135], a[132:135], a[240:243], 0
    s_waitcnt lgkmcnt(9)
    ds_read_b64_tr_b16 a[152:153], v38 offset:0
    v_mfma_f32_16x16x32_bf16 v[72:75], a[136:139], a[224:227], 0
    ds_read_b64_tr_b16 a[154:155], v38 offset:1024
    v_mfma_f32_16x16x32_bf16 v[104:107], a[136:139], a[232:235], 0
    ds_read_b64_tr_b16 a[156:157], v39 offset:0
    v_mfma_f32_16x16x32_bf16 v[136:139], a[136:139], a[240:243], 0
    s_waitcnt lgkmcnt(7)
    s_barrier
    ds_read_b64_tr_b16 a[158:159], v39 offset:1024
    v_mfma_f32_16x16x32_bf16 v[76:79], a[140:143], a[224:227], 0
    v_mfma_f32_16x16x32_bf16 v[108:111], a[140:143], a[232:235], 0
    ds_read_b64_tr_b16 a[160:161], v32 offset:8192
    v_mfma_f32_16x16x32_bf16 v[140:143], a[140:143], a[240:243], 0
    s_waitcnt lgkmcnt(7)
    ds_read_b64_tr_b16 a[162:163], v32 offset:9216
    v_mfma_f32_16x16x32_bf16 v[80:83], a[144:147], a[224:227], 0
    ds_read_b64_tr_b16 a[164:165], v33 offset:8192
    v_mfma_f32_16x16x32_bf16 v[112:115], a[144:147], a[232:235], 0
    ds_read_b64_tr_b16 a[166:167], v33 offset:9216
    v_mfma_f32_16x16x32_bf16 v[144:147], a[144:147], a[240:243], 0
    s_waitcnt lgkmcnt(8)
    v_mfma_f32_16x16x32_bf16 v[84:87], a[148:151], a[224:227], 0
    ds_read_b64_tr_b16 a[168:169], v34 offset:8192
    v_mfma_f32_16x16x32_bf16 v[116:119], a[148:151], a[232:235], 0
    ds_read_b64_tr_b16 a[170:171], v34 offset:9216
    v_mfma_f32_16x16x32_bf16 v[148:151], a[148:151], a[240:243], 0
    s_waitcnt lgkmcnt(8)
    ds_read_b64_tr_b16 a[172:173], v35 offset:8192
    v_mfma_f32_16x16x32_bf16 v[88:91], a[152:155], a[224:227], 0
    ds_read_b64_tr_b16 a[174:175], v35 offset:9216
    v_mfma_f32_16x16x32_bf16 v[120:123], a[152:155], a[232:235], 0
    v_mfma_f32_16x16x32_bf16 v[152:155], a[152:155], a[240:243], 0
    s_waitcnt lgkmcnt(8)
    ds_read_b64_tr_b16 a[176:177], v36 offset:8192
    v_mfma_f32_16x16x32_bf16 v[92:95], a[156:159], a[224:227], 0
    ds_read_b64_tr_b16 a[178:179], v36 offset:9216
    v_mfma_f32_16x16x32_bf16 v[124:127], a[156:159], a[232:235], 0
    ds_read_b64_tr_b16 a[180:181], v37 offset:8192
    v_mfma_f32_16x16x32_bf16 v[156:159], a[156:159], a[240:243], 0
    s_waitcnt lgkmcnt(9)
    ds_read_b64_tr_b16 a[182:183], v37 offset:9216
    v_mfma_f32_16x16x32_bf16 v[64:67], a[160:163], a[228:231], v[64:67]
    v_mfma_f32_16x16x32_bf16 v[96:99], a[160:163], a[236:239], v[96:99]
    ds_read_b64_tr_b16 a[184:185], v38 offset:8192
    v_mfma_f32_16x16x32_bf16 v[128:131], a[160:163], a[244:247], v[128:131]
    s_waitcnt lgkmcnt(9)
    ds_read_b64_tr_b16 a[186:187], v38 offset:9216
    v_mfma_f32_16x16x32_bf16 v[68:71], a[164:167], a[228:231], v[68:71]
    ds_read_b64_tr_b16 a[188:189], v39 offset:8192
    v_mfma_f32_16x16x32_bf16 v[100:103], a[164:167], a[236:239], v[100:103]
    ds_read_b64_tr_b16 a[190:191], v39 offset:9216
    v_mfma_f32_16x16x32_bf16 v[132:135], a[164:167], a[244:247], v[132:135]
    s_waitcnt lgkmcnt(10)
    v_mfma_f32_16x16x32_bf16 v[72:75], a[168:171], a[228:231], v[72:75]
    v_mfma_f32_16x16x32_bf16 v[104:107], a[168:171], a[236:239], v[104:107]
    v_mfma_f32_16x16x32_bf16 v[136:139], a[168:171], a[244:247], v[136:139]
    s_waitcnt lgkmcnt(8)
    v_mfma_f32_16x16x32_bf16 v[76:79], a[172:175], a[228:231], v[76:79]
    v_mfma_f32_16x16x32_bf16 v[108:111], a[172:175], a[236:239], v[108:111]
    v_mfma_f32_16x16x32_bf16 v[140:143], a[172:175], a[244:247], v[140:143]
    s_waitcnt lgkmcnt(6)
    v_mfma_f32_16x16x32_bf16 v[80:83], a[176:179], a[228:231], v[80:83]
    s_waitcnt lgkmcnt(0)
    s_barrier
    ds_read_b128 a[192:195], v208 offset:0
    ds_read_b64_tr_b16 a[128:129], v32 offset:16384
    v_mfma_f32_16x16x32_bf16 v[112:115], a[176:179], a[236:239], v[112:115]
    ds_read_b64_tr_b16 a[130:131], v32 offset:17408
    v_mfma_f32_16x16x32_bf16 v[144:147], a[176:179], a[244:247], v[144:147]
    ds_read_b128 a[200:203], v210 offset:0
    v_mfma_f32_16x16x32_bf16 v[84:87], a[180:183], a[228:231], v[84:87]
    ds_read_b128 a[208:211], v212 offset:0
    v_mfma_f32_16x16x32_bf16 v[116:119], a[180:183], a[236:239], v[116:119]
    ds_read_b64_tr_b16 a[132:133], v33 offset:16384
    v_mfma_f32_16x16x32_bf16 v[148:151], a[180:183], a[244:247], v[148:151]
    ds_read_b64_tr_b16 a[134:135], v33 offset:17408
    v_mfma_f32_16x16x32_bf16 v[88:91], a[184:187], a[228:231], v[88:91]
    ds_read_b64_tr_b16 a[136:137], v34 offset:16384
    ds_read_b64_tr_b16 a[138:139], v34 offset:17408
    v_mfma_f32_16x16x32_bf16 v[120:123], a[184:187], a[236:239], v[120:123]
    ds_read_b128 a[196:199], v209 offset:0
    v_mfma_f32_16x16x32_bf16 v[152:155], a[184:187], a[244:247], v[152:155]
    ds_read_b128 a[204:207], v211 offset:0
    v_mfma_f32_16x16x32_bf16 v[92:95], a[188:191], a[228:231], v[92:95]
    ds_read_b128 a[212:215], v213 offset:0
    v_mfma_f32_16x16x32_bf16 v[124:127], a[188:191], a[236:239], v[124:127]
    ds_read_b64_tr_b16 a[140:141], v35 offset:16384
    v_mfma_f32_16x16x32_bf16 v[156:159], a[188:191], a[244:247], v[156:159]
    ds_read_b64_tr_b16 a[142:143], v35 offset:17408
    s_waitcnt lgkmcnt(9)
    v_mfma_f32_16x16x32_bf16 v[64:67], a[128:131], a[192:195], v[64:67]
    ds_read_b64_tr_b16 a[144:145], v36 offset:16384
    v_mfma_f32_16x16x32_bf16 v[96:99], a[128:131], a[200:203], v[96:99]
    ds_read_b64_tr_b16 a[146:147], v36 offset:17408
    v_mfma_f32_16x16x32_bf16 v[128:131], a[128:131], a[208:211], v[128:131]
    s_waitcnt lgkmcnt(9)
    ds_read_b64_tr_b16 a[148:149], v37 offset:16384
    v_mfma_f32_16x16x32_bf16 v[68:71], a[132:135], a[192:195], v[68:71]
    ds_read_b64_tr_b16 a[150:151], v37 offset:17408
    v_mfma_f32_16x16x32_bf16 v[100:103], a[132:135], a[200:203], v[100:103]
    v_mfma_f32_16x16x32_bf16 v[132:135], a[132:135], a[208:211], v[132:135]
    s_waitcnt lgkmcnt(9)
    ds_read_b64_tr_b16 a[152:153], v38 offset:16384
    v_mfma_f32_16x16x32_bf16 v[72:75], a[136:139], a[192:195], v[72:75]
    ds_read_b64_tr_b16 a[154:155], v38 offset:17408
    v_mfma_f32_16x16x32_bf16 v[104:107], a[136:139], a[200:203], v[104:107]
    ds_read_b64_tr_b16 a[156:157], v39 offset:16384
    v_mfma_f32_16x16x32_bf16 v[136:139], a[136:139], a[208:211], v[136:139]
    s_waitcnt lgkmcnt(7)
    s_barrier
    ds_read_b64_tr_b16 a[158:159], v39 offset:17408
    v_mfma_f32_16x16x32_bf16 v[76:79], a[140:143], a[192:195], v[76:79]
    v_mfma_f32_16x16x32_bf16 v[108:111], a[140:143], a[200:203], v[108:111]
    ds_read_b64_tr_b16 a[160:161], v32 offset:24576
    v_mfma_f32_16x16x32_bf16 v[140:143], a[140:143], a[208:211], v[140:143]
    s_waitcnt lgkmcnt(7)
    ds_read_b64_tr_b16 a[162:163], v32 offset:25600
    v_mfma_f32_16x16x32_bf16 v[80:83], a[144:147], a[192:195], v[80:83]
    ds_read_b64_tr_b16 a[164:165], v33 offset:24576
    v_mfma_f32_16x16x32_bf16 v[112:115], a[144:147], a[200:203], v[112:115]
    ds_read_b64_tr_b16 a[166:167], v33 offset:25600
    v_mfma_f32_16x16x32_bf16 v[144:147], a[144:147], a[208:211], v[144:147]
    s_waitcnt lgkmcnt(8)
    v_mfma_f32_16x16x32_bf16 v[84:87], a[148:151], a[192:195], v[84:87]
    ds_read_b64_tr_b16 a[168:169], v34 offset:24576
    v_mfma_f32_16x16x32_bf16 v[116:119], a[148:151], a[200:203], v[116:119]
    ds_read_b64_tr_b16 a[170:171], v34 offset:25600
    v_mfma_f32_16x16x32_bf16 v[148:151], a[148:151], a[208:211], v[148:151]
    s_waitcnt lgkmcnt(8)
    ds_read_b64_tr_b16 a[172:173], v35 offset:24576
    v_mfma_f32_16x16x32_bf16 v[88:91], a[152:155], a[192:195], v[88:91]
    ds_read_b64_tr_b16 a[174:175], v35 offset:25600
    v_mfma_f32_16x16x32_bf16 v[120:123], a[152:155], a[200:203], v[120:123]
    v_mfma_f32_16x16x32_bf16 v[152:155], a[152:155], a[208:211], v[152:155]
    s_waitcnt lgkmcnt(8)
    ds_read_b64_tr_b16 a[176:177], v36 offset:24576
    v_mfma_f32_16x16x32_bf16 v[92:95], a[156:159], a[192:195], v[92:95]
    ds_read_b64_tr_b16 a[178:179], v36 offset:25600
    v_mfma_f32_16x16x32_bf16 v[124:127], a[156:159], a[200:203], v[124:127]
    ds_read_b64_tr_b16 a[180:181], v37 offset:24576
    v_mfma_f32_16x16x32_bf16 v[156:159], a[156:159], a[208:211], v[156:159]
    s_waitcnt lgkmcnt(9)
    ds_read_b64_tr_b16 a[182:183], v37 offset:25600
    v_mfma_f32_16x16x32_bf16 v[64:67], a[160:163], a[196:199], v[64:67]
    v_mfma_f32_16x16x32_bf16 v[96:99], a[160:163], a[204:207], v[96:99]
    ds_read_b64_tr_b16 a[184:185], v38 offset:24576
    v_mfma_f32_16x16x32_bf16 v[128:131], a[160:163], a[212:215], v[128:131]
    s_waitcnt lgkmcnt(9)
    ds_read_b64_tr_b16 a[186:187], v38 offset:25600
    v_mfma_f32_16x16x32_bf16 v[68:71], a[164:167], a[196:199], v[68:71]
    ds_read_b64_tr_b16 a[188:189], v39 offset:24576
    v_mfma_f32_16x16x32_bf16 v[100:103], a[164:167], a[204:207], v[100:103]
    ds_read_b64_tr_b16 a[190:191], v39 offset:25600
    v_mfma_f32_16x16x32_bf16 v[132:135], a[164:167], a[212:215], v[132:135]
    s_waitcnt lgkmcnt(10)
    v_mfma_f32_16x16x32_bf16 v[72:75], a[168:171], a[196:199], v[72:75]
    v_mfma_f32_16x16x32_bf16 v[104:107], a[168:171], a[204:207], v[104:107]
    v_mfma_f32_16x16x32_bf16 v[136:139], a[168:171], a[212:215], v[136:139]
    s_waitcnt lgkmcnt(8)
    v_mfma_f32_16x16x32_bf16 v[76:79], a[172:175], a[196:199], v[76:79]
    v_mfma_f32_16x16x32_bf16 v[108:111], a[172:175], a[204:207], v[108:111]
    v_mfma_f32_16x16x32_bf16 v[140:143], a[172:175], a[212:215], v[140:143]
    s_waitcnt lgkmcnt(6)
    v_mfma_f32_16x16x32_bf16 v[80:83], a[176:179], a[196:199], v[80:83]
    s_waitcnt lgkmcnt(0)
    s_barrier
    ds_read_b128 a[224:227], v208 offset:32768
    ds_read_b64_tr_b16 a[128:129], v32 offset:32768
    v_mfma_f32_16x16x32_bf16 v[112:115], a[176:179], a[204:207], v[112:115]
    ds_read_b64_tr_b16 a[130:131], v32 offset:33792
    v_mfma_f32_16x16x32_bf16 v[144:147], a[176:179], a[212:215], v[144:147]
    ds_read_b128 a[232:235], v210 offset:32768
    v_mfma_f32_16x16x32_bf16 v[84:87], a[180:183], a[196:199], v[84:87]
    ds_read_b128 a[240:243], v212 offset:32768
    v_mfma_f32_16x16x32_bf16 v[116:119], a[180:183], a[204:207], v[116:119]
    ds_read_b64_tr_b16 a[132:133], v33 offset:32768
    v_mfma_f32_16x16x32_bf16 v[148:151], a[180:183], a[212:215], v[148:151]
    ds_read_b64_tr_b16 a[134:135], v33 offset:33792
    v_mfma_f32_16x16x32_bf16 v[88:91], a[184:187], a[196:199], v[88:91]
    ds_read_b64_tr_b16 a[136:137], v34 offset:32768
    ds_read_b64_tr_b16 a[138:139], v34 offset:33792
    v_mfma_f32_16x16x32_bf16 v[120:123], a[184:187], a[204:207], v[120:123]
    ds_read_b128 a[228:231], v209 offset:32768
    v_mfma_f32_16x16x32_bf16 v[152:155], a[184:187], a[212:215], v[152:155]
    ds_read_b128 a[236:239], v211 offset:32768
    v_mfma_f32_16x16x32_bf16 v[92:95], a[188:191], a[196:199], v[92:95]
    ds_read_b128 a[244:247], v213 offset:32768
    v_mfma_f32_16x16x32_bf16 v[124:127], a[188:191], a[204:207], v[124:127]
    ds_read_b64_tr_b16 a[140:141], v35 offset:32768
    v_mfma_f32_16x16x32_bf16 v[156:159], a[188:191], a[212:215], v[156:159]
    ds_read_b64_tr_b16 a[142:143], v35 offset:33792
    s_waitcnt lgkmcnt(9)
    v_mfma_f32_16x16x32_bf16 v[64:67], a[128:131], a[224:227], v[64:67]
    ds_read_b64_tr_b16 a[144:145], v36 offset:32768
    v_mfma_f32_16x16x32_bf16 v[96:99], a[128:131], a[232:235], v[96:99]
    ds_read_b64_tr_b16 a[146:147], v36 offset:33792
    v_mfma_f32_16x16x32_bf16 v[128:131], a[128:131], a[240:243], v[128:131]
    s_waitcnt lgkmcnt(9)
    ds_read_b64_tr_b16 a[148:149], v37 offset:32768
    v_mfma_f32_16x16x32_bf16 v[68:71], a[132:135], a[224:227], v[68:71]
    ds_read_b64_tr_b16 a[150:151], v37 offset:33792
    v_mfma_f32_16x16x32_bf16 v[100:103], a[132:135], a[232:235], v[100:103]
    v_mfma_f32_16x16x32_bf16 v[132:135], a[132:135], a[240:243], v[132:135]
    s_waitcnt lgkmcnt(9)
    ds_read_b64_tr_b16 a[152:153], v38 offset:32768
    v_mfma_f32_16x16x32_bf16 v[72:75], a[136:139], a[224:227], v[72:75]
    ds_read_b64_tr_b16 a[154:155], v38 offset:33792
    v_mfma_f32_16x16x32_bf16 v[104:107], a[136:139], a[232:235], v[104:107]
    ds_read_b64_tr_b16 a[156:157], v39 offset:32768
    v_mfma_f32_16x16x32_bf16 v[136:139], a[136:139], a[240:243], v[136:139]
    s_waitcnt lgkmcnt(7)
    s_barrier
    ds_read_b64_tr_b16 a[158:159], v39 offset:33792
    v_mfma_f32_16x16x32_bf16 v[76:79], a[140:143], a[224:227], v[76:79]
    v_mfma_f32_16x16x32_bf16 v[108:111], a[140:143], a[232:235], v[108:111]
    ds_read_b64_tr_b16 a[160:161], v32 offset:40960
    v_mfma_f32_16x16x32_bf16 v[140:143], a[140:143], a[240:243], v[140:143]
    s_waitcnt lgkmcnt(7)
    ds_read_b64_tr_b16 a[162:163], v32 offset:41984
    v_mfma_f32_16x16x32_bf16 v[80:83], a[144:147], a[224:227], v[80:83]
    ds_read_b64_tr_b16 a[164:165], v33 offset:40960
    v_mfma_f32_16x16x32_bf16 v[112:115], a[144:147], a[232:235], v[112:115]
    ds_read_b64_tr_b16 a[166:167], v33 offset:41984
    v_mfma_f32_16x16x32_bf16 v[144:147], a[144:147], a[240:243], v[144:147]
    s_waitcnt lgkmcnt(8)
    v_mfma_f32_16x16x32_bf16 v[84:87], a[148:151], a[224:227], v[84:87]
    ds_read_b64_tr_b16 a[168:169], v34 offset:40960
    v_mfma_f32_16x16x32_bf16 v[116:119], a[148:151], a[232:235], v[116:119]
    ds_read_b64_tr_b16 a[170:171], v34 offset:41984
    v_mfma_f32_16x16x32_bf16 v[148:151], a[148:151], a[240:243], v[148:151]
    s_waitcnt lgkmcnt(8)
    ds_read_b64_tr_b16 a[172:173], v35 offset:40960
    v_mfma_f32_16x16x32_bf16 v[88:91], a[152:155], a[224:227], v[88:91]
    ds_read_b64_tr_b16 a[174:175], v35 offset:41984
    v_mfma_f32_16x16x32_bf16 v[120:123], a[152:155], a[232:235], v[120:123]
    v_mfma_f32_16x16x32_bf16 v[152:155], a[152:155], a[240:243], v[152:155]
    s_waitcnt lgkmcnt(8)
    ds_read_b64_tr_b16 a[176:177], v36 offset:40960
    v_mfma_f32_16x16x32_bf16 v[92:95], a[156:159], a[224:227], v[92:95]
    ds_read_b64_tr_b16 a[178:179], v36 offset:41984
    v_mfma_f32_16x16x32_bf16 v[124:127], a[156:159], a[232:235], v[124:127]
    ds_read_b64_tr_b16 a[180:181], v37 offset:40960
    v_mfma_f32_16x16x32_bf16 v[156:159], a[156:159], a[240:243], v[156:159]
    s_waitcnt lgkmcnt(9)
    ds_read_b64_tr_b16 a[182:183], v37 offset:41984
    v_mfma_f32_16x16x32_bf16 v[64:67], a[160:163], a[228:231], v[64:67]
    v_mfma_f32_16x16x32_bf16 v[96:99], a[160:163], a[236:239], v[96:99]
    ds_read_b64_tr_b16 a[184:185], v38 offset:40960
    v_mfma_f32_16x16x32_bf16 v[128:131], a[160:163], a[244:247], v[128:131]
    s_waitcnt lgkmcnt(9)
    ds_read_b64_tr_b16 a[186:187], v38 offset:41984
    v_mfma_f32_16x16x32_bf16 v[68:71], a[164:167], a[228:231], v[68:71]
    ds_read_b64_tr_b16 a[188:189], v39 offset:40960
    v_mfma_f32_16x16x32_bf16 v[100:103], a[164:167], a[236:239], v[100:103]
    ds_read_b64_tr_b16 a[190:191], v39 offset:41984
    v_mfma_f32_16x16x32_bf16 v[132:135], a[164:167], a[244:247], v[132:135]
    s_waitcnt lgkmcnt(10)
    v_mfma_f32_16x16x32_bf16 v[72:75], a[168:171], a[228:231], v[72:75]
    v_mfma_f32_16x16x32_bf16 v[104:107], a[168:171], a[236:239], v[104:107]
    v_mfma_f32_16x16x32_bf16 v[136:139], a[168:171], a[244:247], v[136:139]
    s_waitcnt lgkmcnt(8)
    v_mfma_f32_16x16x32_bf16 v[76:79], a[172:175], a[228:231], v[76:79]
    v_mfma_f32_16x16x32_bf16 v[108:111], a[172:175], a[236:239], v[108:111]
    v_mfma_f32_16x16x32_bf16 v[140:143], a[172:175], a[244:247], v[140:143]
    s_waitcnt lgkmcnt(6)
    v_mfma_f32_16x16x32_bf16 v[80:83], a[176:179], a[228:231], v[80:83]
    s_waitcnt lgkmcnt(0)
    s_barrier
    ds_read_b128 a[192:195], v208 offset:0
    ds_read_b64_tr_b16 a[128:129], v32 offset:0
    v_mfma_f32_16x16x32_bf16 v[112:115], a[176:179], a[236:239], v[112:115]
    ds_read_b64_tr_b16 a[130:131], v32 offset:1024
    v_mfma_f32_16x16x32_bf16 v[144:147], a[176:179], a[244:247], v[144:147]
    ds_read_b128 a[200:203], v210 offset:0
    v_mfma_f32_16x16x32_bf16 v[84:87], a[180:183], a[228:231], v[84:87]
    ds_read_b128 a[208:211], v212 offset:0
    v_mfma_f32_16x16x32_bf16 v[116:119], a[180:183], a[236:239], v[116:119]
    ds_read_b64_tr_b16 a[132:133], v33 offset:0
    v_mfma_f32_16x16x32_bf16 v[148:151], a[180:183], a[244:247], v[148:151]
    ds_read_b64_tr_b16 a[134:135], v33 offset:1024
    v_mfma_f32_16x16x32_bf16 v[88:91], a[184:187], a[228:231], v[88:91]
    ds_read_b64_tr_b16 a[136:137], v34 offset:0
    ds_read_b64_tr_b16 a[138:139], v34 offset:1024
    v_mfma_f32_16x16x32_bf16 v[120:123], a[184:187], a[236:239], v[120:123]
    ds_read_b128 a[196:199], v209 offset:0
    v_mfma_f32_16x16x32_bf16 v[152:155], a[184:187], a[244:247], v[152:155]
    ds_read_b128 a[204:207], v211 offset:0
    v_mfma_f32_16x16x32_bf16 v[92:95], a[188:191], a[228:231], v[92:95]
    ds_read_b128 a[212:215], v213 offset:0
    v_mfma_f32_16x16x32_bf16 v[124:127], a[188:191], a[236:239], v[124:127]
    ds_read_b64_tr_b16 a[140:141], v35 offset:0
    v_mfma_f32_16x16x32_bf16 v[156:159], a[188:191], a[244:247], v[156:159]
    ds_read_b64_tr_b16 a[142:143], v35 offset:1024
    s_waitcnt lgkmcnt(9)
    v_mfma_f32_16x16x32_bf16 v[64:67], a[128:131], a[192:195], v[64:67]
    ds_read_b64_tr_b16 a[144:145], v36 offset:0
    v_mfma_f32_16x16x32_bf16 v[96:99], a[128:131], a[200:203], v[96:99]
    ds_read_b64_tr_b16 a[146:147], v36 offset:1024
    v_mfma_f32_16x16x32_bf16 v[128:131], a[128:131], a[208:211], v[128:131]
    s_waitcnt lgkmcnt(9)
    ds_read_b64_tr_b16 a[148:149], v37 offset:0
    v_mfma_f32_16x16x32_bf16 v[68:71], a[132:135], a[192:195], v[68:71]
    ds_read_b64_tr_b16 a[150:151], v37 offset:1024
    v_mfma_f32_16x16x32_bf16 v[100:103], a[132:135], a[200:203], v[100:103]
    v_mfma_f32_16x16x32_bf16 v[132:135], a[132:135], a[208:211], v[132:135]
    s_waitcnt lgkmcnt(9)
    ds_read_b64_tr_b16 a[152:153], v38 offset:0
    v_mfma_f32_16x16x32_bf16 v[72:75], a[136:139], a[192:195], v[72:75]
    ds_read_b64_tr_b16 a[154:155], v38 offset:1024
    v_mfma_f32_16x16x32_bf16 v[104:107], a[136:139], a[200:203], v[104:107]
    ds_read_b64_tr_b16 a[156:157], v39 offset:0
    v_mfma_f32_16x16x32_bf16 v[136:139], a[136:139], a[208:211], v[136:139]
    s_waitcnt lgkmcnt(7)
    s_barrier
    ds_read_b64_tr_b16 a[158:159], v39 offset:1024
    v_mfma_f32_16x16x32_bf16 v[76:79], a[140:143], a[192:195], v[76:79]
    v_mfma_f32_16x16x32_bf16 v[108:111], a[140:143], a[200:203], v[108:111]
    ds_read_b64_tr_b16 a[160:161], v32 offset:8192
    v_mfma_f32_16x16x32_bf16 v[140:143], a[140:143], a[208:211], v[140:143]
    s_waitcnt lgkmcnt(7)
    ds_read_b64_tr_b16 a[162:163], v32 offset:9216
    v_mfma_f32_16x16x32_bf16 v[80:83], a[144:147], a[192:195], v[80:83]
    ds_read_b64_tr_b16 a[164:165], v33 offset:8192
    v_mfma_f32_16x16x32_bf16 v[112:115], a[144:147], a[200:203], v[112:115]
    ds_read_b64_tr_b16 a[166:167], v33 offset:9216
    v_mfma_f32_16x16x32_bf16 v[144:147], a[144:147], a[208:211], v[144:147]
    s_waitcnt lgkmcnt(8)
    v_mfma_f32_16x16x32_bf16 v[84:87], a[148:151], a[192:195], v[84:87]
    ds_read_b64_tr_b16 a[168:169], v34 offset:8192
    v_mfma_f32_16x16x32_bf16 v[116:119], a[148:151], a[200:203], v[116:119]
    ds_read_b64_tr_b16 a[170:171], v34 offset:9216
    v_mfma_f32_16x16x32_bf16 v[148:151], a[148:151], a[208:211], v[148:151]
    s_waitcnt lgkmcnt(8)
    ds_read_b64_tr_b16 a[172:173], v35 offset:8192
    v_mfma_f32_16x16x32_bf16 v[88:91], a[152:155], a[192:195], v[88:91]
    ds_read_b64_tr_b16 a[174:175], v35 offset:9216
    v_mfma_f32_16x16x32_bf16 v[120:123], a[152:155], a[200:203], v[120:123]
    v_mfma_f32_16x16x32_bf16 v[152:155], a[152:155], a[208:211], v[152:155]
    s_waitcnt lgkmcnt(8)
    ds_read_b64_tr_b16 a[176:177], v36 offset:8192
    v_mfma_f32_16x16x32_bf16 v[92:95], a[156:159], a[192:195], v[92:95]
    ds_read_b64_tr_b16 a[178:179], v36 offset:9216
    v_mfma_f32_16x16x32_bf16 v[124:127], a[156:159], a[200:203], v[124:127]
    ds_read_b64_tr_b16 a[180:181], v37 offset:8192
    v_mfma_f32_16x16x32_bf16 v[156:159], a[156:159], a[208:211], v[156:159]
    s_waitcnt lgkmcnt(9)
    ds_read_b64_tr_b16 a[182:183], v37 offset:9216
    v_mfma_f32_16x16x32_bf16 v[64:67], a[160:163], a[196:199], v[64:67]
    s_mov_b32 s46, 0
    v_mfma_f32_16x16x32_bf16 v[96:99], a[160:163], a[204:207], v[96:99]
    s_mov_b32 m0, 49152
    ds_read_b64_tr_b16 a[184:185], v38 offset:8192
    v_mfma_f32_16x16x32_bf16 v[128:131], a[160:163], a[212:215], v[128:131]
    s_waitcnt lgkmcnt(9)
    ds_read_b64_tr_b16 a[186:187], v38 offset:9216
    buffer_load_dwordx4 v14, s[12:15], s46 offen offset:0 nt lds
    v_mfma_f32_16x16x32_bf16 v[68:71], a[164:167], a[196:199], v[68:71]
    ds_read_b64_tr_b16 a[188:189], v39 offset:8192
    buffer_load_dwordx4 v15, s[12:15], s46 offen offset:1024 nt lds
    v_mfma_f32_16x16x32_bf16 v[100:103], a[164:167], a[204:207], v[100:103]
    ds_read_b64_tr_b16 a[190:191], v39 offset:9216
    buffer_load_dwordx4 v14, s[12:15], s46 offen offset:2048 nt lds
    v_mfma_f32_16x16x32_bf16 v[132:135], a[164:167], a[212:215], v[132:135]
    s_waitcnt lgkmcnt(10)
    buffer_load_dwordx4 v15, s[12:15], s46 offen offset:3072 nt lds
    s_mov_b32 s46, 4096
    s_mov_b32 m0, 53248
    v_mfma_f32_16x16x32_bf16 v[72:75], a[168:171], a[196:199], v[72:75]
    buffer_load_dwordx4 v14, s[12:15], s46 offen offset:0 nt lds
    v_mfma_f32_16x16x32_bf16 v[104:107], a[168:171], a[204:207], v[104:107]
    buffer_load_dwordx4 v15, s[12:15], s46 offen offset:1024 nt lds
    v_mfma_f32_16x16x32_bf16 v[136:139], a[168:171], a[212:215], v[136:139]
    s_waitcnt lgkmcnt(8)
    buffer_load_dwordx4 v14, s[12:15], s46 offen offset:2048 nt lds
    v_mfma_f32_16x16x32_bf16 v[76:79], a[172:175], a[196:199], v[76:79]
    buffer_load_dwordx4 v15, s[12:15], s46 offen offset:3072 nt lds
    v_mfma_f32_16x16x32_bf16 v[108:111], a[172:175], a[204:207], v[108:111]
    v_mfma_f32_16x16x32_bf16 v[140:143], a[172:175], a[212:215], v[140:143]
    s_waitcnt lgkmcnt(6)
    v_mfma_f32_16x16x32_bf16 v[80:83], a[176:179], a[196:199], v[80:83]
    s_waitcnt lgkmcnt(0)
    s_barrier
    ds_read_b128 a[224:227], v208 offset:32768
    ds_read_b64_tr_b16 a[128:129], v32 offset:16384
    v_mfma_f32_16x16x32_bf16 v[112:115], a[176:179], a[204:207], v[112:115]
    ds_read_b64_tr_b16 a[130:131], v32 offset:17408
    v_mfma_f32_16x16x32_bf16 v[144:147], a[176:179], a[212:215], v[144:147]
    ds_read_b128 a[232:235], v210 offset:32768
    v_mfma_f32_16x16x32_bf16 v[84:87], a[180:183], a[196:199], v[84:87]
    ds_read_b128 a[240:243], v212 offset:32768
    v_mfma_f32_16x16x32_bf16 v[116:119], a[180:183], a[204:207], v[116:119]
    ds_read_b64_tr_b16 a[132:133], v33 offset:16384
    v_mfma_f32_16x16x32_bf16 v[148:151], a[180:183], a[212:215], v[148:151]
    ds_read_b64_tr_b16 a[134:135], v33 offset:17408
    v_mfma_f32_16x16x32_bf16 v[88:91], a[184:187], a[196:199], v[88:91]
    ds_read_b64_tr_b16 a[136:137], v34 offset:16384
    ds_read_b64_tr_b16 a[138:139], v34 offset:17408
    v_mfma_f32_16x16x32_bf16 v[120:123], a[184:187], a[204:207], v[120:123]
    ds_read_b128 a[228:231], v209 offset:32768
    v_mfma_f32_16x16x32_bf16 v[152:155], a[184:187], a[212:215], v[152:155]
    ds_read_b128 a[236:239], v211 offset:32768
    v_mfma_f32_16x16x32_bf16 v[92:95], a[188:191], a[196:199], v[92:95]
    ds_read_b128 a[244:247], v213 offset:32768
    v_mfma_f32_16x16x32_bf16 v[124:127], a[188:191], a[204:207], v[124:127]
    ds_read_b64_tr_b16 a[140:141], v35 offset:16384
    v_mfma_f32_16x16x32_bf16 v[156:159], a[188:191], a[212:215], v[156:159]
    ds_read_b64_tr_b16 a[142:143], v35 offset:17408
    s_waitcnt lgkmcnt(9)
    v_mfma_f32_16x16x32_bf16 v[64:67], a[128:131], a[224:227], v[64:67]
    ds_read_b64_tr_b16 a[144:145], v36 offset:16384
    v_mfma_f32_16x16x32_bf16 v[96:99], a[128:131], a[232:235], v[96:99]
    ds_read_b64_tr_b16 a[146:147], v36 offset:17408
    v_mfma_f32_16x16x32_bf16 v[128:131], a[128:131], a[240:243], v[128:131]
    s_waitcnt lgkmcnt(9)
    ds_read_b64_tr_b16 a[148:149], v37 offset:16384
    v_mfma_f32_16x16x32_bf16 v[68:71], a[132:135], a[224:227], v[68:71]
    ds_read_b64_tr_b16 a[150:151], v37 offset:17408
    v_mfma_f32_16x16x32_bf16 v[100:103], a[132:135], a[232:235], v[100:103]
    v_mfma_f32_16x16x32_bf16 v[132:135], a[132:135], a[240:243], v[132:135]
    s_waitcnt lgkmcnt(9)
    ds_read_b64_tr_b16 a[152:153], v38 offset:16384
    v_mfma_f32_16x16x32_bf16 v[72:75], a[136:139], a[224:227], v[72:75]
    ds_read_b64_tr_b16 a[154:155], v38 offset:17408
    v_mfma_f32_16x16x32_bf16 v[104:107], a[136:139], a[232:235], v[104:107]
    ds_read_b64_tr_b16 a[156:157], v39 offset:16384
    v_mfma_f32_16x16x32_bf16 v[136:139], a[136:139], a[240:243], v[136:139]
    s_waitcnt lgkmcnt(7)
    s_barrier
    ds_read_b64_tr_b16 a[158:159], v39 offset:17408
    v_mfma_f32_16x16x32_bf16 v[76:79], a[140:143], a[224:227], v[76:79]
    v_mfma_f32_16x16x32_bf16 v[108:111], a[140:143], a[232:235], v[108:111]
    ds_read_b64_tr_b16 a[160:161], v32 offset:24576
    v_mfma_f32_16x16x32_bf16 v[140:143], a[140:143], a[240:243], v[140:143]
    s_waitcnt lgkmcnt(7)
    ds_read_b64_tr_b16 a[162:163], v32 offset:25600
    v_mfma_f32_16x16x32_bf16 v[80:83], a[144:147], a[224:227], v[80:83]
    ds_read_b64_tr_b16 a[164:165], v33 offset:24576
    v_mfma_f32_16x16x32_bf16 v[112:115], a[144:147], a[232:235], v[112:115]
    ds_read_b64_tr_b16 a[166:167], v33 offset:25600
    v_mfma_f32_16x16x32_bf16 v[144:147], a[144:147], a[240:243], v[144:147]
    s_waitcnt lgkmcnt(8)
    v_mfma_f32_16x16x32_bf16 v[84:87], a[148:151], a[224:227], v[84:87]
    ds_read_b64_tr_b16 a[168:169], v34 offset:24576
    v_mfma_f32_16x16x32_bf16 v[116:119], a[148:151], a[232:235], v[116:119]
    ds_read_b64_tr_b16 a[170:171], v34 offset:25600
    v_mfma_f32_16x16x32_bf16 v[148:151], a[148:151], a[240:243], v[148:151]
    s_waitcnt lgkmcnt(8)
    ds_read_b64_tr_b16 a[172:173], v35 offset:24576
    v_mfma_f32_16x16x32_bf16 v[88:91], a[152:155], a[224:227], v[88:91]
    ds_read_b64_tr_b16 a[174:175], v35 offset:25600
    v_mfma_f32_16x16x32_bf16 v[120:123], a[152:155], a[232:235], v[120:123]
    v_mfma_f32_16x16x32_bf16 v[152:155], a[152:155], a[240:243], v[152:155]
    s_waitcnt lgkmcnt(8)
    ds_read_b64_tr_b16 a[176:177], v36 offset:24576
    v_mfma_f32_16x16x32_bf16 v[92:95], a[156:159], a[224:227], v[92:95]
    ds_read_b64_tr_b16 a[178:179], v36 offset:25600
    v_mfma_f32_16x16x32_bf16 v[124:127], a[156:159], a[232:235], v[124:127]
    ds_read_b64_tr_b16 a[180:181], v37 offset:24576
    v_mfma_f32_16x16x32_bf16 v[156:159], a[156:159], a[240:243], v[156:159]
    s_waitcnt lgkmcnt(9)
    ds_read_b64_tr_b16 a[182:183], v37 offset:25600
    v_mfma_f32_16x16x32_bf16 v[64:67], a[160:163], a[228:231], v[64:67]
    s_mov_b32 s46, 8192
    v_mfma_f32_16x16x32_bf16 v[96:99], a[160:163], a[236:239], v[96:99]
    s_mov_b32 m0, 57344
    ds_read_b64_tr_b16 a[184:185], v38 offset:24576
    v_mfma_f32_16x16x32_bf16 v[128:131], a[160:163], a[244:247], v[128:131]
    s_waitcnt lgkmcnt(9)
    ds_read_b64_tr_b16 a[186:187], v38 offset:25600
    buffer_load_dwordx4 v14, s[12:15], s46 offen offset:0 nt lds
    v_mfma_f32_16x16x32_bf16 v[68:71], a[164:167], a[228:231], v[68:71]
    ds_read_b64_tr_b16 a[188:189], v39 offset:24576
    buffer_load_dwordx4 v15, s[12:15], s46 offen offset:1024 nt lds
    v_mfma_f32_16x16x32_bf16 v[100:103], a[164:167], a[236:239], v[100:103]
    ds_read_b64_tr_b16 a[190:191], v39 offset:25600
    buffer_load_dwordx4 v14, s[12:15], s46 offen offset:2048 nt lds
    v_mfma_f32_16x16x32_bf16 v[132:135], a[164:167], a[244:247], v[132:135]
    s_waitcnt lgkmcnt(10)
    buffer_load_dwordx4 v15, s[12:15], s46 offen offset:3072 nt lds
    s_mov_b32 s46, 12288
    s_mov_b32 m0, 61440
    v_mfma_f32_16x16x32_bf16 v[72:75], a[168:171], a[228:231], v[72:75]
    buffer_load_dwordx4 v14, s[12:15], s46 offen offset:0 nt lds
    v_mfma_f32_16x16x32_bf16 v[104:107], a[168:171], a[236:239], v[104:107]
    buffer_load_dwordx4 v15, s[12:15], s46 offen offset:1024 nt lds
    v_mfma_f32_16x16x32_bf16 v[136:139], a[168:171], a[244:247], v[136:139]
    s_waitcnt lgkmcnt(8)
    buffer_load_dwordx4 v14, s[12:15], s46 offen offset:2048 nt lds
    v_mfma_f32_16x16x32_bf16 v[76:79], a[172:175], a[228:231], v[76:79]
    buffer_load_dwordx4 v15, s[12:15], s46 offen offset:3072 nt lds
    v_mfma_f32_16x16x32_bf16 v[108:111], a[172:175], a[236:239], v[108:111]
    v_mfma_f32_16x16x32_bf16 v[140:143], a[172:175], a[244:247], v[140:143]
    s_waitcnt lgkmcnt(6)
    v_mfma_f32_16x16x32_bf16 v[80:83], a[176:179], a[228:231], v[80:83]
    s_waitcnt lgkmcnt(0)
    s_barrier
    ds_read_b128 a[192:195], v208 offset:0
    ds_read_b64_tr_b16 a[128:129], v32 offset:32768
    v_mfma_f32_16x16x32_bf16 v[112:115], a[176:179], a[236:239], v[112:115]
    ds_read_b64_tr_b16 a[130:131], v32 offset:33792
    v_mfma_f32_16x16x32_bf16 v[144:147], a[176:179], a[244:247], v[144:147]
    ds_read_b128 a[200:203], v210 offset:0
    v_mfma_f32_16x16x32_bf16 v[84:87], a[180:183], a[228:231], v[84:87]
    ds_read_b128 a[208:211], v212 offset:0
    v_mfma_f32_16x16x32_bf16 v[116:119], a[180:183], a[236:239], v[116:119]
    ds_read_b64_tr_b16 a[132:133], v33 offset:32768
    v_mfma_f32_16x16x32_bf16 v[148:151], a[180:183], a[244:247], v[148:151]
    ds_read_b64_tr_b16 a[134:135], v33 offset:33792
    v_mfma_f32_16x16x32_bf16 v[88:91], a[184:187], a[228:231], v[88:91]
    ds_read_b64_tr_b16 a[136:137], v34 offset:32768
    ds_read_b64_tr_b16 a[138:139], v34 offset:33792
    v_mfma_f32_16x16x32_bf16 v[120:123], a[184:187], a[236:239], v[120:123]
    ds_read_b128 a[196:199], v209 offset:0
    v_mfma_f32_16x16x32_bf16 v[152:155], a[184:187], a[244:247], v[152:155]
    ds_read_b128 a[204:207], v211 offset:0
    v_mfma_f32_16x16x32_bf16 v[92:95], a[188:191], a[228:231], v[92:95]
    ds_read_b128 a[212:215], v213 offset:0
    v_mfma_f32_16x16x32_bf16 v[124:127], a[188:191], a[236:239], v[124:127]
    ds_read_b64_tr_b16 a[140:141], v35 offset:32768
    v_mfma_f32_16x16x32_bf16 v[156:159], a[188:191], a[244:247], v[156:159]
    ds_read_b64_tr_b16 a[142:143], v35 offset:33792
    s_waitcnt lgkmcnt(9)
    v_mfma_f32_16x16x32_bf16 v[64:67], a[128:131], a[192:195], v[64:67]
    ds_read_b64_tr_b16 a[144:145], v36 offset:32768
    v_mfma_f32_16x16x32_bf16 v[96:99], a[128:131], a[200:203], v[96:99]
    ds_read_b64_tr_b16 a[146:147], v36 offset:33792
    v_mfma_f32_16x16x32_bf16 v[128:131], a[128:131], a[208:211], v[128:131]
    s_waitcnt lgkmcnt(9)
    ds_read_b64_tr_b16 a[148:149], v37 offset:32768
    v_mfma_f32_16x16x32_bf16 v[68:71], a[132:135], a[192:195], v[68:71]
    ds_read_b64_tr_b16 a[150:151], v37 offset:33792
    v_mfma_f32_16x16x32_bf16 v[100:103], a[132:135], a[200:203], v[100:103]
    v_mfma_f32_16x16x32_bf16 v[132:135], a[132:135], a[208:211], v[132:135]
    s_waitcnt lgkmcnt(9)
    ds_read_b64_tr_b16 a[152:153], v38 offset:32768
    v_mfma_f32_16x16x32_bf16 v[72:75], a[136:139], a[192:195], v[72:75]
    ds_read_b64_tr_b16 a[154:155], v38 offset:33792
    v_mfma_f32_16x16x32_bf16 v[104:107], a[136:139], a[200:203], v[104:107]
    ds_read_b64_tr_b16 a[156:157], v39 offset:32768
    v_mfma_f32_16x16x32_bf16 v[136:139], a[136:139], a[208:211], v[136:139]
    s_waitcnt lgkmcnt(7)
    s_barrier
    ds_read_b64_tr_b16 a[158:159], v39 offset:33792
    v_mfma_f32_16x16x32_bf16 v[76:79], a[140:143], a[192:195], v[76:79]
    v_mfma_f32_16x16x32_bf16 v[108:111], a[140:143], a[200:203], v[108:111]
    ds_read_b64_tr_b16 a[160:161], v32 offset:40960
    v_mfma_f32_16x16x32_bf16 v[140:143], a[140:143], a[208:211], v[140:143]
    s_waitcnt lgkmcnt(7)
    ds_read_b64_tr_b16 a[162:163], v32 offset:41984
    v_mfma_f32_16x16x32_bf16 v[80:83], a[144:147], a[192:195], v[80:83]
    ds_read_b64_tr_b16 a[164:165], v33 offset:40960
    v_mfma_f32_16x16x32_bf16 v[112:115], a[144:147], a[200:203], v[112:115]
    ds_read_b64_tr_b16 a[166:167], v33 offset:41984
    v_mfma_f32_16x16x32_bf16 v[144:147], a[144:147], a[208:211], v[144:147]
    s_waitcnt lgkmcnt(8)
    v_mfma_f32_16x16x32_bf16 v[84:87], a[148:151], a[192:195], v[84:87]
    ds_read_b64_tr_b16 a[168:169], v34 offset:40960
    v_mfma_f32_16x16x32_bf16 v[116:119], a[148:151], a[200:203], v[116:119]
    ds_read_b64_tr_b16 a[170:171], v34 offset:41984
    v_mfma_f32_16x16x32_bf16 v[148:151], a[148:151], a[208:211], v[148:151]
    s_waitcnt lgkmcnt(8)
    ds_read_b64_tr_b16 a[172:173], v35 offset:40960
    v_mfma_f32_16x16x32_bf16 v[88:91], a[152:155], a[192:195], v[88:91]
    ds_read_b64_tr_b16 a[174:175], v35 offset:41984
    v_mfma_f32_16x16x32_bf16 v[120:123], a[152:155], a[200:203], v[120:123]
    v_mfma_f32_16x16x32_bf16 v[152:155], a[152:155], a[208:211], v[152:155]
    s_waitcnt lgkmcnt(8)
    s_mov_b32 s46, 16384
    ds_read_b64_tr_b16 a[176:177], v36 offset:40960
    v_mfma_f32_16x16x32_bf16 v[92:95], a[156:159], a[192:195], v[92:95]
    s_mov_b32 m0, 65536
    ds_read_b64_tr_b16 a[178:179], v36 offset:41984
    v_mfma_f32_16x16x32_bf16 v[124:127], a[156:159], a[200:203], v[124:127]
    ds_read_b64_tr_b16 a[180:181], v37 offset:40960
    buffer_load_dwordx4 v14, s[12:15], s46 offen offset:0 nt lds
    v_mfma_f32_16x16x32_bf16 v[156:159], a[156:159], a[208:211], v[156:159]
    s_waitcnt lgkmcnt(9)
    ds_read_b64_tr_b16 a[182:183], v37 offset:41984
    buffer_load_dwordx4 v15, s[12:15], s46 offen offset:1024 nt lds
    v_mfma_f32_16x16x32_bf16 v[64:67], a[160:163], a[196:199], v[64:67]
    buffer_load_dwordx4 v14, s[12:15], s46 offen offset:2048 nt lds
    v_mfma_f32_16x16x32_bf16 v[96:99], a[160:163], a[204:207], v[96:99]
    ds_read_b64_tr_b16 a[184:185], v38 offset:40960
    buffer_load_dwordx4 v15, s[12:15], s46 offen offset:3072 nt lds
    s_mov_b32 s46, 20480
    s_mov_b32 m0, 69632
    v_mfma_f32_16x16x32_bf16 v[128:131], a[160:163], a[212:215], v[128:131]
    s_waitcnt lgkmcnt(9)
    ds_read_b64_tr_b16 a[186:187], v38 offset:41984
    buffer_load_dwordx4 v14, s[12:15], s46 offen offset:0 nt lds
    v_mfma_f32_16x16x32_bf16 v[68:71], a[164:167], a[196:199], v[68:71]
    ds_read_b64_tr_b16 a[188:189], v39 offset:40960
    buffer_load_dwordx4 v15, s[12:15], s46 offen offset:1024 nt lds
    v_mfma_f32_16x16x32_bf16 v[100:103], a[164:167], a[204:207], v[100:103]
    ds_read_b64_tr_b16 a[190:191], v39 offset:41984
    buffer_load_dwordx4 v14, s[12:15], s46 offen offset:2048 nt lds
    v_mfma_f32_16x16x32_bf16 v[132:135], a[164:167], a[212:215], v[132:135]
    s_waitcnt lgkmcnt(10)
    buffer_load_dwordx4 v15, s[12:15], s46 offen offset:3072 nt lds
    s_mov_b32 s46, 24576
    s_mov_b32 m0, 73728
    v_mfma_f32_16x16x32_bf16 v[72:75], a[168:171], a[196:199], v[72:75]
    buffer_load_dwordx4 v14, s[12:15], s46 offen offset:0 nt lds
    v_mfma_f32_16x16x32_bf16 v[104:107], a[168:171], a[204:207], v[104:107]
    buffer_load_dwordx4 v15, s[12:15], s46 offen offset:1024 nt lds
    v_mfma_f32_16x16x32_bf16 v[136:139], a[168:171], a[212:215], v[136:139]
    s_waitcnt lgkmcnt(8)
    buffer_load_dwordx4 v14, s[12:15], s46 offen offset:2048 nt lds
    v_mfma_f32_16x16x32_bf16 v[76:79], a[172:175], a[196:199], v[76:79]
    buffer_load_dwordx4 v15, s[12:15], s46 offen offset:3072 nt lds
    v_mfma_f32_16x16x32_bf16 v[108:111], a[172:175], a[204:207], v[108:111]
    v_mfma_f32_16x16x32_bf16 v[140:143], a[172:175], a[212:215], v[140:143]
    s_waitcnt lgkmcnt(6)
    v_mfma_f32_16x16x32_bf16 v[80:83], a[176:179], a[196:199], v[80:83]
    s_waitcnt lgkmcnt(0)
    s_barrier
    ds_read_b128 a[224:227], v208 offset:32768
    ds_read_b64_tr_b16 a[128:129], v32 offset:0
    v_mfma_f32_16x16x32_bf16 v[112:115], a[176:179], a[204:207], v[112:115]
    ds_read_b64_tr_b16 a[130:131], v32 offset:1024
    v_mfma_f32_16x16x32_bf16 v[144:147], a[176:179], a[212:215], v[144:147]
    ds_read_b128 a[232:235], v210 offset:32768
    v_mfma_f32_16x16x32_bf16 v[84:87], a[180:183], a[196:199], v[84:87]
    ds_read_b128 a[240:243], v212 offset:32768
    v_mfma_f32_16x16x32_bf16 v[116:119], a[180:183], a[204:207], v[116:119]
    ds_read_b64_tr_b16 a[132:133], v33 offset:0
    v_mfma_f32_16x16x32_bf16 v[148:151], a[180:183], a[212:215], v[148:151]
    ds_read_b64_tr_b16 a[134:135], v33 offset:1024
    v_mfma_f32_16x16x32_bf16 v[88:91], a[184:187], a[196:199], v[88:91]
    ds_read_b64_tr_b16 a[136:137], v34 offset:0
    ds_read_b64_tr_b16 a[138:139], v34 offset:1024
    v_mfma_f32_16x16x32_bf16 v[120:123], a[184:187], a[204:207], v[120:123]
    ds_read_b128 a[228:231], v209 offset:32768
    v_mfma_f32_16x16x32_bf16 v[152:155], a[184:187], a[212:215], v[152:155]
    ds_read_b128 a[236:239], v211 offset:32768
    v_mfma_f32_16x16x32_bf16 v[92:95], a[188:191], a[196:199], v[92:95]
    ds_read_b128 a[244:247], v213 offset:32768
    v_mfma_f32_16x16x32_bf16 v[124:127], a[188:191], a[204:207], v[124:127]
    ds_read_b64_tr_b16 a[140:141], v35 offset:0
    v_mfma_f32_16x16x32_bf16 v[156:159], a[188:191], a[212:215], v[156:159]
    ds_read_b64_tr_b16 a[142:143], v35 offset:1024
    s_waitcnt lgkmcnt(9)
    v_mfma_f32_16x16x32_bf16 v[64:67], a[128:131], a[224:227], v[64:67]
    ds_read_b64_tr_b16 a[144:145], v36 offset:0
    v_mfma_f32_16x16x32_bf16 v[96:99], a[128:131], a[232:235], v[96:99]
    ds_read_b64_tr_b16 a[146:147], v36 offset:1024
    v_mfma_f32_16x16x32_bf16 v[128:131], a[128:131], a[240:243], v[128:131]
    s_waitcnt lgkmcnt(9)
    ds_read_b64_tr_b16 a[148:149], v37 offset:0
    v_mfma_f32_16x16x32_bf16 v[68:71], a[132:135], a[224:227], v[68:71]
    ds_read_b64_tr_b16 a[150:151], v37 offset:1024
    v_mfma_f32_16x16x32_bf16 v[100:103], a[132:135], a[232:235], v[100:103]
    v_mfma_f32_16x16x32_bf16 v[132:135], a[132:135], a[240:243], v[132:135]
    s_waitcnt lgkmcnt(9)
    ds_read_b64_tr_b16 a[152:153], v38 offset:0
    v_mfma_f32_16x16x32_bf16 v[72:75], a[136:139], a[224:227], v[72:75]
    ds_read_b64_tr_b16 a[154:155], v38 offset:1024
    v_mfma_f32_16x16x32_bf16 v[104:107], a[136:139], a[232:235], v[104:107]
    ds_read_b64_tr_b16 a[156:157], v39 offset:0
    v_mfma_f32_16x16x32_bf16 v[136:139], a[136:139], a[240:243], v[136:139]
    s_waitcnt lgkmcnt(7)
    s_barrier
    ds_read_b64_tr_b16 a[158:159], v39 offset:1024
    v_mfma_f32_16x16x32_bf16 v[76:79], a[140:143], a[224:227], v[76:79]
    v_mfma_f32_16x16x32_bf16 v[108:111], a[140:143], a[232:235], v[108:111]
    ds_read_b64_tr_b16 a[160:161], v32 offset:8192
    v_mfma_f32_16x16x32_bf16 v[140:143], a[140:143], a[240:243], v[140:143]
    s_waitcnt lgkmcnt(7)
    ds_read_b64_tr_b16 a[162:163], v32 offset:9216
    v_mfma_f32_16x16x32_bf16 v[80:83], a[144:147], a[224:227], v[80:83]
    ds_read_b64_tr_b16 a[164:165], v33 offset:8192
    v_mfma_f32_16x16x32_bf16 v[112:115], a[144:147], a[232:235], v[112:115]
    ds_read_b64_tr_b16 a[166:167], v33 offset:9216
    v_mfma_f32_16x16x32_bf16 v[144:147], a[144:147], a[240:243], v[144:147]
    s_waitcnt lgkmcnt(8)
    v_mfma_f32_16x16x32_bf16 v[84:87], a[148:151], a[224:227], v[84:87]
    ds_read_b64_tr_b16 a[168:169], v34 offset:8192
    v_mfma_f32_16x16x32_bf16 v[116:119], a[148:151], a[232:235], v[116:119]
    ds_read_b64_tr_b16 a[170:171], v34 offset:9216
    v_mfma_f32_16x16x32_bf16 v[148:151], a[148:151], a[240:243], v[148:151]
    s_waitcnt lgkmcnt(8)
    ds_read_b64_tr_b16 a[172:173], v35 offset:8192
    v_mfma_f32_16x16x32_bf16 v[88:91], a[152:155], a[224:227], v[88:91]
    ds_read_b64_tr_b16 a[174:175], v35 offset:9216
    v_mfma_f32_16x16x32_bf16 v[120:123], a[152:155], a[232:235], v[120:123]
    v_mfma_f32_16x16x32_bf16 v[152:155], a[152:155], a[240:243], v[152:155]
    s_waitcnt lgkmcnt(8)
    s_mov_b32 s46, 28672
    ds_read_b64_tr_b16 a[176:177], v36 offset:8192
    v_mfma_f32_16x16x32_bf16 v[92:95], a[156:159], a[224:227], v[92:95]
    s_mov_b32 m0, 77824
    ds_read_b64_tr_b16 a[178:179], v36 offset:9216
    v_mfma_f32_16x16x32_bf16 v[124:127], a[156:159], a[232:235], v[124:127]
    ds_read_b64_tr_b16 a[180:181], v37 offset:8192
    buffer_load_dwordx4 v14, s[12:15], s46 offen offset:0 nt lds
    v_mfma_f32_16x16x32_bf16 v[156:159], a[156:159], a[240:243], v[156:159]
    s_waitcnt lgkmcnt(9)
    ds_read_b64_tr_b16 a[182:183], v37 offset:9216
    buffer_load_dwordx4 v15, s[12:15], s46 offen offset:1024 nt lds
    v_mfma_f32_16x16x32_bf16 v[64:67], a[160:163], a[228:231], v[64:67]
    buffer_load_dwordx4 v14, s[12:15], s46 offen offset:2048 nt lds
    v_mfma_f32_16x16x32_bf16 v[96:99], a[160:163], a[236:239], v[96:99]
    ds_read_b64_tr_b16 a[184:185], v38 offset:8192
    buffer_load_dwordx4 v15, s[12:15], s46 offen offset:3072 nt lds
    s_mov_b32 s46, 0
    s_mov_b32 m0, 147456
    v_mfma_f32_16x16x32_bf16 v[128:131], a[160:163], a[244:247], v[128:131]
    s_waitcnt lgkmcnt(9)
    ds_read_b64_tr_b16 a[186:187], v38 offset:9216
    buffer_load_dwordx4 v14, s[16:19], s46 offen offset:0 nt lds
    v_mfma_f32_16x16x32_bf16 v[68:71], a[164:167], a[228:231], v[68:71]
    ds_read_b64_tr_b16 a[188:189], v39 offset:8192
    buffer_load_dwordx4 v15, s[16:19], s46 offen offset:1024 nt lds
    v_mfma_f32_16x16x32_bf16 v[100:103], a[164:167], a[236:239], v[100:103]
    ds_read_b64_tr_b16 a[190:191], v39 offset:9216
    buffer_load_dwordx4 v14, s[16:19], s46 offen offset:2048 nt lds
    v_mfma_f32_16x16x32_bf16 v[132:135], a[164:167], a[244:247], v[132:135]
    s_waitcnt lgkmcnt(10)
    buffer_load_dwordx4 v15, s[16:19], s46 offen offset:3072 nt lds
    s_mov_b32 s46, 4096
    s_mov_b32 m0, 151552
    v_mfma_f32_16x16x32_bf16 v[72:75], a[168:171], a[228:231], v[72:75]
    buffer_load_dwordx4 v14, s[16:19], s46 offen offset:0 nt lds
    v_mfma_f32_16x16x32_bf16 v[104:107], a[168:171], a[236:239], v[104:107]
    buffer_load_dwordx4 v15, s[16:19], s46 offen offset:1024 nt lds
    v_mfma_f32_16x16x32_bf16 v[136:139], a[168:171], a[244:247], v[136:139]
    s_waitcnt lgkmcnt(8)
    buffer_load_dwordx4 v14, s[16:19], s46 offen offset:2048 nt lds
    v_mfma_f32_16x16x32_bf16 v[76:79], a[172:175], a[228:231], v[76:79]
    buffer_load_dwordx4 v15, s[16:19], s46 offen offset:3072 nt lds
    v_mfma_f32_16x16x32_bf16 v[108:111], a[172:175], a[236:239], v[108:111]
    v_mfma_f32_16x16x32_bf16 v[140:143], a[172:175], a[244:247], v[140:143]
    s_waitcnt lgkmcnt(6)
    v_mfma_f32_16x16x32_bf16 v[80:83], a[176:179], a[228:231], v[80:83]
    s_waitcnt lgkmcnt(0)
    s_barrier
    s_mov_b32 s46, 8192
    ds_read_b128 a[192:195], v208 offset:0
    ds_read_b64_tr_b16 a[128:129], v32 offset:16384
    v_mfma_f32_16x16x32_bf16 v[112:115], a[176:179], a[236:239], v[112:115]
    s_mov_b32 m0, 155648
    ds_read_b64_tr_b16 a[130:131], v32 offset:17408
    buffer_load_dwordx2 v[56:57], off, s[36:39], 0 offset:128 sc1
    v_mfma_f32_16x16x32_bf16 v[144:147], a[176:179], a[244:247], v[144:147]
    ds_read_b128 a[200:203], v210 offset:0
    buffer_load_dwordx4 v14, s[16:19], s46 offen offset:0 nt lds
    v_mfma_f32_16x16x32_bf16 v[84:87], a[180:183], a[228:231], v[84:87]
    ds_read_b128 a[208:211], v212 offset:0
    buffer_load_dwordx4 v15, s[16:19], s46 offen offset:1024 nt lds
    v_mfma_f32_16x16x32_bf16 v[116:119], a[180:183], a[236:239], v[116:119]
    ds_read_b64_tr_b16 a[132:133], v33 offset:16384
    v_mfma_f32_16x16x32_bf16 v[148:151], a[180:183], a[244:247], v[148:151]
    ds_read_b64_tr_b16 a[134:135], v33 offset:17408
    buffer_load_dwordx4 v14, s[16:19], s46 offen offset:2048 nt lds
    v_mfma_f32_16x16x32_bf16 v[88:91], a[184:187], a[228:231], v[88:91]
    ds_read_b64_tr_b16 a[136:137], v34 offset:16384
    ds_read_b64_tr_b16 a[138:139], v34 offset:17408
    v_mfma_f32_16x16x32_bf16 v[120:123], a[184:187], a[236:239], v[120:123]
    ds_read_b128 a[196:199], v209 offset:0
    buffer_load_dwordx4 v15, s[16:19], s46 offen offset:3072 nt lds
    v_mfma_f32_16x16x32_bf16 v[152:155], a[184:187], a[244:247], v[152:155]
    s_mov_b32 s46, 12288
    s_mov_b32 m0, 159744
    ds_read_b128 a[204:207], v211 offset:0
    v_mfma_f32_16x16x32_bf16 v[92:95], a[188:191], a[228:231], v[92:95]
    ds_read_b128 a[212:215], v213 offset:0
    buffer_load_dwordx4 v14, s[16:19], s46 offen offset:0 nt lds
    v_mfma_f32_16x16x32_bf16 v[124:127], a[188:191], a[236:239], v[124:127]
    ds_read_b64_tr_b16 a[140:141], v35 offset:16384
    v_mfma_f32_16x16x32_bf16 v[156:159], a[188:191], a[244:247], v[156:159]
    ds_read_b64_tr_b16 a[142:143], v35 offset:17408
    buffer_load_dwordx4 v15, s[16:19], s46 offen offset:1024 nt lds
    s_waitcnt lgkmcnt(9)
    v_mfma_f32_16x16x32_bf16 v[64:67], a[128:131], a[192:195], v[64:67]
    ds_read_b64_tr_b16 a[144:145], v36 offset:16384
    v_mfma_f32_16x16x32_bf16 v[96:99], a[128:131], a[200:203], v[96:99]
    ds_read_b64_tr_b16 a[146:147], v36 offset:17408
    buffer_load_dwordx4 v14, s[16:19], s46 offen offset:2048 nt lds
    v_mfma_f32_16x16x32_bf16 v[128:131], a[128:131], a[208:211], v[128:131]
    s_waitcnt lgkmcnt(9)
    ds_read_b64_tr_b16 a[148:149], v37 offset:16384
    buffer_load_dwordx4 v15, s[16:19], s46 offen offset:3072 nt lds
    v_mfma_f32_16x16x32_bf16 v[68:71], a[132:135], a[192:195], v[68:71]
    s_mov_b32 s46, 32768
    s_mov_b32 m0, 0
    ds_read_b64_tr_b16 a[150:151], v37 offset:17408
    v_mfma_f32_16x16x32_bf16 v[100:103], a[132:135], a[200:203], v[100:103]
    buffer_load_dwordx4 v14, s[12:15], s46 offen offset:0 nt lds
    v_mfma_f32_16x16x32_bf16 v[132:135], a[132:135], a[208:211], v[132:135]
    s_waitcnt lgkmcnt(9)
    ds_read_b64_tr_b16 a[152:153], v38 offset:16384
    v_mfma_f32_16x16x32_bf16 v[72:75], a[136:139], a[192:195], v[72:75]
    ds_read_b64_tr_b16 a[154:155], v38 offset:17408
    buffer_load_dwordx4 v15, s[12:15], s46 offen offset:1024 nt lds
    v_mfma_f32_16x16x32_bf16 v[104:107], a[136:139], a[200:203], v[104:107]
    ds_read_b64_tr_b16 a[156:157], v39 offset:16384
    v_mfma_f32_16x16x32_bf16 v[136:139], a[136:139], a[208:211], v[136:139]
    s_waitcnt lgkmcnt(7)
    s_barrier
    ds_read_b64_tr_b16 a[158:159], v39 offset:17408
    buffer_load_dwordx4 v14, s[12:15], s46 offen offset:2048 nt lds
    v_mfma_f32_16x16x32_bf16 v[76:79], a[140:143], a[192:195], v[76:79]
    v_mfma_f32_16x16x32_bf16 v[108:111], a[140:143], a[200:203], v[108:111]
    ds_read_b64_tr_b16 a[160:161], v32 offset:24576
    buffer_load_dwordx4 v15, s[12:15], s46 offen offset:3072 nt lds
    v_mfma_f32_16x16x32_bf16 v[140:143], a[140:143], a[208:211], v[140:143]
    s_waitcnt lgkmcnt(7)
    s_mov_b32 s46, 36864
    s_mov_b32 m0, 4096
    ds_read_b64_tr_b16 a[162:163], v32 offset:25600
    v_mfma_f32_16x16x32_bf16 v[80:83], a[144:147], a[192:195], v[80:83]
    ds_read_b64_tr_b16 a[164:165], v33 offset:24576
    buffer_load_dwordx4 v14, s[12:15], s46 offen offset:0 nt lds
    v_mfma_f32_16x16x32_bf16 v[112:115], a[144:147], a[200:203], v[112:115]
    ds_read_b64_tr_b16 a[166:167], v33 offset:25600
    buffer_load_dwordx4 v15, s[12:15], s46 offen offset:1024 nt lds
    v_mfma_f32_16x16x32_bf16 v[144:147], a[144:147], a[208:211], v[144:147]
    s_waitcnt lgkmcnt(8)
    v_mfma_f32_16x16x32_bf16 v[84:87], a[148:151], a[192:195], v[84:87]
    ds_read_b64_tr_b16 a[168:169], v34 offset:24576
    buffer_load_dwordx4 v14, s[12:15], s46 offen offset:2048 nt lds
    v_mfma_f32_16x16x32_bf16 v[116:119], a[148:151], a[200:203], v[116:119]
    ds_read_b64_tr_b16 a[170:171], v34 offset:25600
    v_mfma_f32_16x16x32_bf16 v[148:151], a[148:151], a[208:211], v[148:151]
    s_waitcnt lgkmcnt(8)
    ds_read_b64_tr_b16 a[172:173], v35 offset:24576
    buffer_load_dwordx4 v15, s[12:15], s46 offen offset:3072 nt lds
    v_mfma_f32_16x16x32_bf16 v[88:91], a[152:155], a[192:195], v[88:91]
    s_mov_b32 s46, 40960
    s_mov_b32 m0, 8192
    ds_read_b64_tr_b16 a[174:175], v35 offset:25600
    v_mfma_f32_16x16x32_bf16 v[120:123], a[152:155], a[200:203], v[120:123]
    buffer_load_dwordx4 v14, s[12:15], s46 offen offset:0 nt lds
    v_mfma_f32_16x16x32_bf16 v[152:155], a[152:155], a[208:211], v[152:155]
    s_waitcnt lgkmcnt(8)
    ds_read_b64_tr_b16 a[176:177], v36 offset:24576
    v_mfma_f32_16x16x32_bf16 v[92:95], a[156:159], a[192:195], v[92:95]
    ds_read_b64_tr_b16 a[178:179], v36 offset:25600
    buffer_load_dwordx4 v15, s[12:15], s46 offen offset:1024 nt lds
    v_mfma_f32_16x16x32_bf16 v[124:127], a[156:159], a[200:203], v[124:127]
    ds_read_b64_tr_b16 a[180:181], v37 offset:24576
    v_mfma_f32_16x16x32_bf16 v[156:159], a[156:159], a[208:211], v[156:159]
    s_waitcnt lgkmcnt(9)
    ds_read_b64_tr_b16 a[182:183], v37 offset:25600
    buffer_load_dwordx4 v14, s[12:15], s46 offen offset:2048 nt lds
    v_mfma_f32_16x16x32_bf16 v[64:67], a[160:163], a[196:199], v[64:67]
    buffer_load_dwordx4 v15, s[12:15], s46 offen offset:3072 nt lds
    v_mfma_f32_16x16x32_bf16 v[96:99], a[160:163], a[204:207], v[96:99]
    s_mov_b32 s46, 45056
    s_mov_b32 m0, 12288
    ds_read_b64_tr_b16 a[184:185], v38 offset:24576
    v_mfma_f32_16x16x32_bf16 v[128:131], a[160:163], a[212:215], v[128:131]
    s_waitcnt lgkmcnt(9)
    ds_read_b64_tr_b16 a[186:187], v38 offset:25600
    buffer_load_dwordx4 v14, s[12:15], s46 offen offset:0 nt lds
    v_mfma_f32_16x16x32_bf16 v[68:71], a[164:167], a[196:199], v[68:71]
    ds_read_b64_tr_b16 a[188:189], v39 offset:24576
    v_mfma_f32_16x16x32_bf16 v[100:103], a[164:167], a[204:207], v[100:103]
    ds_read_b64_tr_b16 a[190:191], v39 offset:25600
    buffer_load_dwordx4 v15, s[12:15], s46 offen offset:1024 nt lds
    v_mfma_f32_16x16x32_bf16 v[132:135], a[164:167], a[212:215], v[132:135]
    s_waitcnt lgkmcnt(10)
    v_mfma_f32_16x16x32_bf16 v[72:75], a[168:171], a[196:199], v[72:75]
    buffer_load_dwordx4 v14, s[12:15], s46 offen offset:2048 nt lds
    v_mfma_f32_16x16x32_bf16 v[104:107], a[168:171], a[204:207], v[104:107]
    v_mfma_f32_16x16x32_bf16 v[136:139], a[168:171], a[212:215], v[136:139]
    s_waitcnt lgkmcnt(8)
    buffer_load_dwordx4 v15, s[12:15], s46 offen offset:3072 nt lds
    v_mfma_f32_16x16x32_bf16 v[76:79], a[172:175], a[196:199], v[76:79]
    v_mfma_f32_16x16x32_bf16 v[108:111], a[172:175], a[204:207], v[108:111]
    v_mfma_f32_16x16x32_bf16 v[140:143], a[172:175], a[212:215], v[140:143]
    s_waitcnt lgkmcnt(6)
    v_mfma_f32_16x16x32_bf16 v[80:83], a[176:179], a[196:199], v[80:83]
    s_waitcnt lgkmcnt(0)
    s_barrier
    s_mov_b32 s46, 16384
    ds_read_b128 a[224:227], v208 offset:32768
    ds_read_b64_tr_b16 a[128:129], v32 offset:32768
    v_mfma_f32_16x16x32_bf16 v[112:115], a[176:179], a[204:207], v[112:115]
    s_mov_b32 m0, 81920
    ds_read_b64_tr_b16 a[130:131], v32 offset:33792
    v_mfma_f32_16x16x32_bf16 v[144:147], a[176:179], a[212:215], v[144:147]
    ds_read_b128 a[232:235], v210 offset:32768
    buffer_load_dwordx4 v14, s[16:19], s46 offen offset:0 nt lds
    v_mfma_f32_16x16x32_bf16 v[84:87], a[180:183], a[196:199], v[84:87]
    ds_read_b128 a[240:243], v212 offset:32768
    v_mfma_f32_16x16x32_bf16 v[116:119], a[180:183], a[204:207], v[116:119]
    ds_read_b64_tr_b16 a[132:133], v33 offset:32768
    buffer_load_dwordx4 v15, s[16:19], s46 offen offset:1024 nt lds
    v_mfma_f32_16x16x32_bf16 v[148:151], a[180:183], a[212:215], v[148:151]
    ds_read_b64_tr_b16 a[134:135], v33 offset:33792
    v_mfma_f32_16x16x32_bf16 v[88:91], a[184:187], a[196:199], v[88:91]
    ds_read_b64_tr_b16 a[136:137], v34 offset:32768
    ds_read_b64_tr_b16 a[138:139], v34 offset:33792
    buffer_load_dwordx4 v14, s[16:19], s46 offen offset:2048 nt lds
    v_mfma_f32_16x16x32_bf16 v[120:123], a[184:187], a[204:207], v[120:123]
    ds_read_b128 a[228:231], v209 offset:32768
    v_mfma_f32_16x16x32_bf16 v[152:155], a[184:187], a[212:215], v[152:155]
    ds_read_b128 a[236:239], v211 offset:32768
    buffer_load_dwordx4 v15, s[16:19], s46 offen offset:3072 nt lds
    v_mfma_f32_16x16x32_bf16 v[92:95], a[188:191], a[196:199], v[92:95]
    s_mov_b32 s46, 20480
    s_mov_b32 m0, 86016
    ds_read_b128 a[244:247], v213 offset:32768
    v_mfma_f32_16x16x32_bf16 v[124:127], a[188:191], a[204:207], v[124:127]
    ds_read_b64_tr_b16 a[140:141], v35 offset:32768
    buffer_load_dwordx4 v14, s[16:19], s46 offen offset:0 nt lds
    v_mfma_f32_16x16x32_bf16 v[156:159], a[188:191], a[212:215], v[156:159]
    ds_read_b64_tr_b16 a[142:143], v35 offset:33792
    s_waitcnt lgkmcnt(9)
    v_mfma_f32_16x16x32_bf16 v[64:67], a[128:131], a[224:227], v[64:67]
    ds_read_b64_tr_b16 a[144:145], v36 offset:32768
    ds_read_b64_tr_b16 a[146:147], v36 offset:33792
    buffer_load_dwordx4 v15, s[16:19], s46 offen offset:1024 nt lds
    v_mfma_f32_16x16x32_bf16 v[96:99], a[128:131], a[232:235], v[96:99]
    ds_read_b64_tr_b16 a[148:149], v37 offset:32768
    v_mfma_f32_16x16x32_bf16 v[128:131], a[128:131], a[240:243], v[128:131]
    s_waitcnt lgkmcnt(10)
    ds_read_b64_tr_b16 a[150:151], v37 offset:33792
    buffer_load_dwordx4 v14, s[16:19], s46 offen offset:2048 nt lds
    v_accvgpr_write_b32 a192, 0
    v_mfma_f32_16x16x32_bf16 v[68:71], a[132:135], a[224:227], v[68:71]
    ds_read_b64_tr_b16 a[152:153], v38 offset:32768
    ds_read_b64_tr_b16 a[154:155], v38 offset:33792
    v_accvgpr_write_b32 a193, 0
    v_mfma_f32_16x16x32_bf16 v[100:103], a[132:135], a[232:235], v[100:103]
    ds_read_b64_tr_b16 a[156:157], v39 offset:32768
    buffer_load_dwordx4 v15, s[16:19], s46 offen offset:3072 nt lds
    v_accvgpr_write_b32 a194, 0
    v_mfma_f32_16x16x32_bf16 v[132:135], a[132:135], a[240:243], v[132:135]
    s_waitcnt lgkmcnt(12)
    s_mov_b32 s46, 24576
    s_mov_b32 m0, 90112
    ds_read_b64_tr_b16 a[158:159], v39 offset:33792
    v_accvgpr_write_b32 a195, 0
    v_mfma_f32_16x16x32_bf16 v[72:75], a[136:139], a[224:227], v[72:75]
    ds_read_b64_tr_b16 a[160:161], v32 offset:40960
    ds_read_b64_tr_b16 a[162:163], v32 offset:41984
    buffer_load_dwordx4 v14, s[16:19], s46 offen offset:0 nt lds
    v_accvgpr_write_b32 a196, 0
    v_mfma_f32_16x16x32_bf16 v[104:107], a[136:139], a[232:235], v[104:107]
    ds_read_b64_tr_b16 a[164:165], v33 offset:40960
    v_accvgpr_write_b32 a197, 0
    v_mfma_f32_16x16x32_bf16 v[136:139], a[136:139], a[240:243], v[136:139]
    s_waitcnt lgkmcnt(11)
    ds_read_b64_tr_b16 a[166:167], v33 offset:41984
    buffer_load_dwordx4 v15, s[16:19], s46 offen offset:1024 nt lds
    v_accvgpr_write_b32 a198, 0
    v_mfma_f32_16x16x32_bf16 v[76:79], a[140:143], a[224:227], v[76:79]
    ds_read_b64_tr_b16 a[168:169], v34 offset:40960
    ds_read_b64_tr_b16 a[170:171], v34 offset:41984
    v_accvgpr_write_b32 a199, 0
    v_mfma_f32_16x16x32_bf16 v[108:111], a[140:143], a[232:235], v[108:111]
    ds_read_b64_tr_b16 a[172:173], v35 offset:40960
    buffer_load_dwordx4 v14, s[16:19], s46 offen offset:2048 nt lds
    v_mfma_f32_16x16x32_bf16 v[140:143], a[140:143], a[240:243], v[140:143]
    s_waitcnt lgkmcnt(13)
    ds_read_b64_tr_b16 a[174:175], v35 offset:41984
    v_mfma_f32_16x16x32_bf16 v[80:83], a[144:147], a[224:227], v[80:83]
    ds_read_b64_tr_b16 a[176:177], v36 offset:40960
    ds_read_b64_tr_b16 a[178:179], v36 offset:41984
    buffer_load_dwordx4 v15, s[16:19], s46 offen offset:3072 nt lds
    v_mfma_f32_16x16x32_bf16 v[112:115], a[144:147], a[232:235], v[112:115]
    s_mov_b32 s46, 28672
    s_mov_b32 m0, 94208
    ds_read_b64_tr_b16 a[180:181], v37 offset:40960
    v_mfma_f32_16x16x32_bf16 v[144:147], a[144:147], a[240:243], v[144:147]
    s_waitcnt lgkmcnt(15)
    ds_read_b64_tr_b16 a[182:183], v37 offset:41984
    buffer_load_dwordx4 v14, s[16:19], s46 offen offset:0 nt lds
    v_mfma_f32_16x16x32_bf16 v[84:87], a[148:151], a[224:227], v[84:87]
    ds_read_b64_tr_b16 a[184:185], v38 offset:40960
    ds_read_b64_tr_b16 a[186:187], v38 offset:41984
    v_mfma_f32_16x16x32_bf16 v[116:119], a[148:151], a[232:235], v[116:119]
    ds_read_b64_tr_b16 a[188:189], v39 offset:40960
    buffer_load_dwordx4 v15, s[16:19], s46 offen offset:1024 nt lds
    v_mfma_f32_16x16x32_bf16 v[148:151], a[148:151], a[240:243], v[148:151]
    s_waitcnt lgkmcnt(15)
    ds_read_b64_tr_b16 a[190:191], v39 offset:41984
    v_mfma_f32_16x16x32_bf16 v[88:91], a[152:155], a[224:227], v[88:91]
    buffer_load_dwordx4 v14, s[16:19], s46 offen offset:2048 nt lds
    v_mfma_f32_16x16x32_bf16 v[120:123], a[152:155], a[232:235], v[120:123]
    v_mfma_f32_16x16x32_bf16 v[152:155], a[152:155], a[240:243], v[152:155]
    s_waitcnt lgkmcnt(15)
    buffer_load_dwordx4 v15, s[16:19], s46 offen offset:3072 nt lds
    v_mfma_f32_16x16x32_bf16 v[92:95], a[156:159], a[224:227], v[92:95]
    v_mfma_f32_16x16x32_bf16 v[124:127], a[156:159], a[232:235], v[124:127]
    v_mfma_f32_16x16x32_bf16 v[156:159], a[156:159], a[240:243], v[156:159]
    s_waitcnt vmcnt(63)
    s_waitcnt lgkmcnt(0)
    s_barrier
    s_and_b32 s58, s68, 7
    s_lshl_b32 s58, s58, 9
    s_add_u32 s58, s58, 45056
    s_mov_b32 s60, 16384
    v_mfma_f32_16x16x32_bf16 v[64:67], a[160:163], a[228:231], v[64:67]
    ds_read_b128 a[128:131], v2 offset:0
    v_mfma_f32_16x16x32_bf16 v[68:71], a[164:167], a[228:231], v[68:71]
    ds_read_b128 a[132:135], v3 offset:0
    v_mfma_f32_16x16x32_bf16 v[72:75], a[168:171], a[228:231], v[72:75]
    ds_read_b128 a[136:139], v4 offset:0
    v_mfma_f32_16x16x32_bf16 v[76:79], a[172:175], a[228:231], v[76:79]
    ds_read_b128 a[140:143], v5 offset:0
    v_mfma_f32_16x16x32_bf16 v[80:83], a[176:179], a[228:231], v[80:83]
    ds_read_b128 a[144:147], v2 offset:4096
    v_mul_f32 v64, s56, v64
    v_mfma_f32_16x16x32_bf16 v[84:87], a[180:183], a[228:231], v[84:87]
    ds_read_b128 a[148:151], v3 offset:4096
    v_mul_f32 v65, s56, v65
    v_mfma_f32_16x16x32_bf16 v[88:91], a[184:187], a[228:231], v[88:91]
    ds_read_b128 a[152:155], v4 offset:4096
    v_mul_f32 v66, s56, v66
    v_mfma_f32_16x16x32_bf16 v[92:95], a[188:191], a[228:231], v[92:95]
    ds_read_b128 a[156:159], v5 offset:4096
    v_mul_f32 v67, s56, v67
    v_mfma_f32_16x16x32_bf16 v[96:99], a[160:163], a[236:239], v[96:99]
    v_mul_f32 v68, s56, v68
    v_mul_f32 v69, s56, v69
    v_mfma_f32_16x16x32_bf16 v[100:103], a[164:167], a[236:239], v[100:103]
    v_mul_f32 v70, s56, v70
    v_mul_f32 v71, s56, v71
    v_mfma_f32_16x16x32_bf16 v[104:107], a[168:171], a[236:239], v[104:107]
    v_cvt_pk_bf16_f32 v192, v64, v65
    v_cvt_pk_bf16_f32 v193, v66, v67
    v_mfma_f32_16x16x32_bf16 v[108:111], a[172:175], a[236:239], v[108:111]
    v_cvt_pk_bf16_f32 v194, v68, v69
    v_cvt_pk_bf16_f32 v195, v70, v71
    v_mfma_f32_16x16x32_bf16 v[112:115], a[176:179], a[236:239], v[112:115]
    v_mul_f32 v72, s56, v72
    v_mul_f32 v73, s56, v73
    v_mfma_f32_16x16x32_bf16 v[116:119], a[180:183], a[236:239], v[116:119]
    v_mul_f32 v74, s56, v74
    v_mul_f32 v75, s56, v75
    v_mfma_f32_16x16x32_bf16 v[120:123], a[184:187], a[236:239], v[120:123]
    v_mul_f32 v76, s56, v76
    v_mul_f32 v77, s56, v77
    v_mfma_f32_16x16x32_bf16 v[124:127], a[188:191], a[236:239], v[124:127]
    v_mul_f32 v78, s56, v78
    v_mul_f32 v79, s56, v79
    v_mfma_f32_16x16x32_bf16 v[128:131], a[160:163], a[244:247], v[128:131]
    v_cvt_pk_bf16_f32 v196, v72, v73
    v_cvt_pk_bf16_f32 v197, v74, v75
    v_mfma_f32_16x16x32_bf16 v[132:135], a[164:167], a[244:247], v[132:135]
    v_cvt_pk_bf16_f32 v198, v76, v77
    v_cvt_pk_bf16_f32 v199, v78, v79
    v_mfma_f32_16x16x32_bf16 v[136:139], a[168:171], a[244:247], v[136:139]
    v_mul_f32 v80, s56, v80
    v_mul_f32 v81, s56, v81
    v_mfma_f32_16x16x32_bf16 v[140:143], a[172:175], a[244:247], v[140:143]
    v_mul_f32 v82, s56, v82
    v_mul_f32 v83, s56, v83
    v_mfma_f32_16x16x32_bf16 v[144:147], a[176:179], a[244:247], v[144:147]
    v_mul_f32 v84, s56, v84
    v_mul_f32 v85, s56, v85
    v_mfma_f32_16x16x32_bf16 v[148:151], a[180:183], a[244:247], v[148:151]
    v_mul_f32 v86, s56, v86
    v_mul_f32 v87, s56, v87
    v_mfma_f32_16x16x32_bf16 v[152:155], a[184:187], a[244:247], v[152:155]
    v_cvt_pk_bf16_f32 v200, v80, v81
    v_cvt_pk_bf16_f32 v201, v82, v83
    v_mfma_f32_16x16x32_bf16 v[156:159], a[188:191], a[244:247], v[156:159]
    v_cvt_pk_bf16_f32 v202, v84, v85
    v_cvt_pk_bf16_f32 v203, v86, v87
    v_mul_f32 v88, s56, v88
    v_mul_f32 v89, s56, v89
    v_mul_f32 v90, s56, v90
    v_mul_f32 v91, s56, v91
    v_mul_f32 v92, s56, v92
    v_mul_f32 v93, s56, v93
    v_mul_f32 v94, s56, v94
    v_mul_f32 v95, s56, v95
    v_cvt_pk_bf16_f32 v204, v88, v89
    v_cvt_pk_bf16_f32 v205, v90, v91
    s_bitcmp1_b32 s52, 12
    s_cselect_b64 s[4:5], s[16:17], s[20:21]
    s_cselect_b32 s6, s18, s22
    s_cselect_b32 s59, 77824, 0
    s_add_u32 m0, s51, s59
    s_andn2_b32 s59, s52, 4096
    s_getreg_b32 s47, hwreg(HW_REG_IB_STS, 0, 24)
    s_and_b32 s47, s47, 0xc0000f
    s_cmp_le_u32 s47, 4194306
    s_cselect_b32 s47, s58, 0
    s_cmp_lt_u32 s52, s47
    s_cbranch_scc0 L_dq_m_m3
    buffer_load_dwordx4 v14, s[4:7], s59 offen offset:0 nt lds
    buffer_load_dwordx4 v15, s[4:7], s59 offen offset:1024 nt lds
    buffer_load_dwordx4 v14, s[4:7], s59 offen offset:2048 nt lds
    buffer_load_dwordx4 v15, s[4:7], s59 offen offset:3072 nt lds
    s_add_u32 m0, m0, 4096
    s_add_u32 s59, s59, 4096
    buffer_load_dwordx4 v14, s[4:7], s59 offen offset:0 nt lds
    buffer_load_dwordx4 v15, s[4:7], s59 offen offset:1024 nt lds
    buffer_load_dwordx4 v14, s[4:7], s59 offen offset:2048 nt lds
    buffer_load_dwordx4 v15, s[4:7], s59 offen offset:3072 nt lds
    s_add_u32 s52, s52, 4096
    s_add_u32 s51, s51, 4096
L_dq_m_m3:
    s_cmp_eq_u32 s51, 81920
    s_cselect_b32 s51, 0, s51
    v_cvt_pk_bf16_f32 v206, v92, v93
    v_cvt_pk_bf16_f32 v207, v94, v95
    v_pk_mul_f32 v[96:97], v[96:97], s[56:57]
    v_pk_mul_f32 v[98:99], v[98:99], s[56:57]
    v_pk_mul_f32 v[100:101], v[100:101], s[56:57]
    v_pk_mul_f32 v[102:103], v[102:103], s[56:57]
    v_pk_mul_f32 v[104:105], v[104:105], s[56:57]
    v_pk_mul_f32 v[106:107], v[106:107], s[56:57]
    v_pk_mul_f32 v[108:109], v[108:109], s[56:57]
    v_pk_mul_f32 v[110:111], v[110:111], s[56:57]
    v_pk_mul_f32 v[112:113], v[112:113], s[56:57]
    v_pk_mul_f32 v[114:115], v[114:115], s[56:57]
    v_pk_mul_f32 v[116:117], v[116:117], s[56:57]
    v_pk_mul_f32 v[118:119], v[118:119], s[56:57]
    v_pk_mul_f32 v[120:121], v[120:121], s[56:57]
    v_pk_mul_f32 v[122:123], v[122:123], s[56:57]
    v_pk_mul_f32 v[124:125], v[124:125], s[56:57]
    v_pk_mul_f32 v[126:127], v[126:127], s[56:57]
    s_waitcnt lgkmcnt(0)
    ds_read_b128 a[160:163], v2 offset:8192
    v_cvt_pk_bf16_f32 v208, v96, v97
    v_mfma_f32_16x16x32_bf16 v[64:67], a[128:131], v[192:195], 0
    ds_read_b128 a[164:167], v3 offset:8192
    v_cvt_pk_bf16_f32 v209, v98, v99
    v_mfma_f32_16x16x32_bf16 v[64:67], a[132:135], v[196:199], v[64:67]
    ds_read_b128 a[168:171], v4 offset:8192
    v_cvt_pk_bf16_f32 v210, v100, v101
    v_mfma_f32_16x16x32_bf16 v[64:67], a[136:139], v[200:203], v[64:67]
    ds_read_b128 a[172:175], v5 offset:8192
    v_cvt_pk_bf16_f32 v211, v102, v103
    v_mfma_f32_16x16x32_bf16 v[64:67], a[140:143], v[204:207], v[64:67]
    ds_read_b128 a[176:179], v2 offset:12288
    v_cvt_pk_bf16_f32 v212, v104, v105
    v_mfma_f32_16x16x32_bf16 v[68:71], a[144:147], v[192:195], 0
    ds_read_b128 a[180:183], v3 offset:12288
    v_cvt_pk_bf16_f32 v213, v106, v107
    v_mfma_f32_16x16x32_bf16 v[68:71], a[148:151], v[196:199], v[68:71]
    ds_read_b128 a[184:187], v4 offset:12288
    v_cvt_pk_bf16_f32 v214, v108, v109
    v_mfma_f32_16x16x32_bf16 v[68:71], a[152:155], v[200:203], v[68:71]
    ds_read_b128 a[188:191], v5 offset:12288
    v_cvt_pk_bf16_f32 v215, v110, v111
    v_mfma_f32_16x16x32_bf16 v[68:71], a[156:159], v[204:207], v[68:71]
    v_cvt_pk_bf16_f32 v216, v112, v113
    v_cvt_pk_bf16_f32 v217, v114, v115
    v_cvt_pk_bf16_f32 v218, v116, v117
    v_cvt_pk_bf16_f32 v219, v118, v119
    v_cvt_pk_bf16_f32 v220, v120, v121
    v_cvt_pk_bf16_f32 v221, v122, v123
    v_cvt_pk_bf16_f32 v222, v124, v125
    v_cvt_pk_bf16_f32 v223, v126, v127
    v_max3_f32 v24, v64, v65, v66
    v_max3_f32 v28, v67, v68, v69
    v_max3_f32 v24, v24, v70, v71
    v_max_f32 v24, v24, v28
    v_mov_b32 v28, v24
    s_nop 0
    s_nop 0
    v_permlane32_swap_b32 v28, v24
    v_max_f32 v24, v24, v28
    v_mov_b32 v28, v24
    s_nop 0
    s_nop 0
    v_permlane16_swap_b32 v28, v24
    v_max_f32 v24, v24, v28
    v_sub_f32 v64, v64, v24
    v_sub_f32 v65, v65, v24
    s_bitcmp1_b32 s52, 12
    s_cselect_b64 s[4:5], s[16:17], s[20:21]
    s_cselect_b32 s6, s18, s22
    s_cselect_b32 s59, 77824, 0
    s_add_u32 m0, s51, s59
    s_andn2_b32 s59, s52, 4096
    s_getreg_b32 s47, hwreg(HW_REG_IB_STS, 0, 24)
    s_and_b32 s47, s47, 0xc0000f
    s_cmp_le_u32 s47, 4194306
    s_cselect_b32 s47, s58, 0
    s_cmp_lt_u32 s52, s47
    s_cbranch_scc0 L_dq_m_m2
    buffer_load_dwordx4 v14, s[4:7], s59 offen offset:0 nt lds
    buffer_load_dwordx4 v15, s[4:7], s59 offen offset:1024 nt lds
    buffer_load_dwordx4 v14, s[4:7], s59 offen offset:2048 nt lds
    buffer_load_dwordx4 v15, s[4:7], s59 offen offset:3072 nt lds
    s_add_u32 m0, m0, 4096
    s_add_u32 s59, s59, 4096
    buffer_load_dwordx4 v14, s[4:7], s59 offen offset:0 nt lds
    buffer_load_dwordx4 v15, s[4:7], s59 offen offset:1024 nt lds
    buffer_load_dwordx4 v14, s[4:7], s59 offen offset:2048 nt lds
    buffer_load_dwordx4 v15, s[4:7], s59 offen offset:3072 nt lds
    s_add_u32 s52, s52, 4096
    s_add_u32 s51, s51, 4096
L_dq_m_m2:
    s_cmp_eq_u32 s51, 81920
    s_cselect_b32 s51, 0, s51
    v_sub_f32 v66, v66, v24
    v_sub_f32 v67, v67, v24
    v_sub_f32 v68, v68, v24
    v_sub_f32 v69, v69, v24
    v_sub_f32 v70, v70, v24
    v_sub_f32 v71, v71, v24
    v_pk_mul_f32 v[128:129], v[128:129], s[56:57]
    v_pk_mul_f32 v[130:131], v[130:131], s[56:57]
    v_pk_mul_f32 v[132:133], v[132:133], s[56:57]
    v_pk_mul_f32 v[134:135], v[134:135], s[56:57]
    v_pk_mul_f32 v[136:137], v[136:137], s[56:57]
    v_pk_mul_f32 v[138:139], v[138:139], s[56:57]
    v_pk_mul_f32 v[140:141], v[140:141], s[56:57]
    v_pk_mul_f32 v[142:143], v[142:143], s[56:57]
    v_pk_mul_f32 v[144:145], v[144:145], s[56:57]
    v_pk_mul_f32 v[146:147], v[146:147], s[56:57]
    v_pk_mul_f32 v[148:149], v[148:149], s[56:57]
    v_pk_mul_f32 v[150:151], v[150:151], s[56:57]
    v_pk_mul_f32 v[152:153], v[152:153], s[56:57]
    v_pk_mul_f32 v[154:155], v[154:155], s[56:57]
    v_pk_mul_f32 v[156:157], v[156:157], s[56:57]
    v_pk_mul_f32 v[158:159], v[158:159], s[56:57]
    v_mfma_f32_16x16x32_bf16 v[72:75], a[128:131], v[208:211], 0
    v_cvt_pk_bf16_f32 v224, v128, v129
    v_cvt_pk_bf16_f32 v225, v130, v131
    v_mfma_f32_16x16x32_bf16 v[72:75], a[132:135], v[212:215], v[72:75]
    v_cvt_pk_bf16_f32 v226, v132, v133
    v_cvt_pk_bf16_f32 v227, v134, v135
    v_mfma_f32_16x16x32_bf16 v[72:75], a[136:139], v[216:219], v[72:75]
    v_cvt_pk_bf16_f32 v228, v136, v137
    v_cvt_pk_bf16_f32 v229, v138, v139
    v_mfma_f32_16x16x32_bf16 v[72:75], a[140:143], v[220:223], v[72:75]
    v_cvt_pk_bf16_f32 v230, v140, v141
    v_cvt_pk_bf16_f32 v231, v142, v143
    v_mfma_f32_16x16x32_bf16 v[76:79], a[144:147], v[208:211], 0
    v_cvt_pk_bf16_f32 v232, v144, v145
    v_cvt_pk_bf16_f32 v233, v146, v147
    v_mfma_f32_16x16x32_bf16 v[76:79], a[148:151], v[212:215], v[76:79]
    v_cvt_pk_bf16_f32 v234, v148, v149
    v_cvt_pk_bf16_f32 v235, v150, v151
    v_mfma_f32_16x16x32_bf16 v[76:79], a[152:155], v[216:219], v[76:79]
    v_cvt_pk_bf16_f32 v236, v152, v153
    v_cvt_pk_bf16_f32 v237, v154, v155
    v_mfma_f32_16x16x32_bf16 v[76:79], a[156:159], v[220:223], v[76:79]
    v_cvt_pk_bf16_f32 v238, v156, v157
    v_cvt_pk_bf16_f32 v239, v158, v159
    s_waitcnt lgkmcnt(0)
    s_cmp_eq_u32 s48, 65536
    s_cselect_b32 s49, s50, 16384
    s_add_u32 s48, s48, s49
    v_mfma_f32_16x16x32_bf16 v[80:83], a[128:131], v[224:227], 0
    v_mfma_f32_16x16x32_bf16 v[80:83], a[132:135], v[228:231], v[80:83]
    v_max3_f32 v25, v72, v73, v74
    v_max3_f32 v28, v75, v76, v77
    v_mfma_f32_16x16x32_bf16 v[80:83], a[136:139], v[232:235], v[80:83]
    v_max3_f32 v25, v25, v78, v79
    v_max_f32 v25, v25, v28
    v_mfma_f32_16x16x32_bf16 v[80:83], a[140:143], v[236:239], v[80:83]
    v_mov_b32 v28, v25
    v_mfma_f32_16x16x32_bf16 v[84:87], a[144:147], v[224:227], 0
    v_mfma_f32_16x16x32_bf16 v[84:87], a[148:151], v[228:231], v[84:87]
    v_permlane32_swap_b32 v28, v25
    v_mfma_f32_16x16x32_bf16 v[84:87], a[152:155], v[232:235], v[84:87]
    v_max_f32 v25, v25, v28
    v_mov_b32 v28, v25
    v_mfma_f32_16x16x32_bf16 v[84:87], a[156:159], v[236:239], v[84:87]
    s_bitcmp1_b32 s52, 12
    s_cselect_b64 s[4:5], s[16:17], s[20:21]
    s_cselect_b32 s6, s18, s22
    s_cselect_b32 s59, 77824, 0
    s_add_u32 m0, s51, s59
    s_andn2_b32 s59, s52, 4096
    s_getreg_b32 s47, hwreg(HW_REG_IB_STS, 0, 24)
    s_and_b32 s47, s47, 0xc0000f
    s_cmp_le_u32 s47, 4194306
    s_cselect_b32 s47, s58, 0
    s_cmp_lt_u32 s52, s47
    s_cbranch_scc0 L_dq_m_m1
    buffer_load_dwordx4 v14, s[4:7], s59 offen offset:0 nt lds
    buffer_load_dwordx4 v15, s[4:7], s59 offen offset:1024 nt lds
    buffer_load_dwordx4 v14, s[4:7], s59 offen offset:2048 nt lds
    buffer_load_dwordx4 v15, s[4:7], s59 offen offset:3072 nt lds
    s_add_u32 m0, m0, 4096
    s_add_u32 s59, s59, 4096
    buffer_load_dwordx4 v14, s[4:7], s59 offen offset:0 nt lds
    buffer_load_dwordx4 v15, s[4:7], s59 offen offset:1024 nt lds
    buffer_load_dwordx4 v14, s[4:7], s59 offen offset:2048 nt lds
    buffer_load_dwordx4 v15, s[4:7], s59 offen offset:3072 nt lds
    s_add_u32 s52, s52, 4096
    s_add_u32 s51, s51, 4096
L_dq_m_m1:
    s_cmp_eq_u32 s51, 81920
    s_cselect_b32 s51, 0, s51
    v_permlane16_swap_b32 v28, v25
    v_max_f32 v25, v25, v28
    v_sub_f32 v72, v72, v25
    v_sub_f32 v73, v73, v25
    v_sub_f32 v74, v74, v25
    v_sub_f32 v75, v75, v25
    v_sub_f32 v76, v76, v25
    v_sub_f32 v77, v77, v25
    v_sub_f32 v78, v78, v25
    v_sub_f32 v79, v79, v25
    v_sub_f32 v160, 0, v24
    v_sub_f32 v161, 0, v24
    v_sub_f32 v162, 0, v24
    v_sub_f32 v163, 0, v24
    v_sub_f32 v164, 0, v25
    v_sub_f32 v165, 0, v25
    v_sub_f32 v166, 0, v25
    v_mfma_f32_16x16x32_bf16 v[96:99], a[160:163], v[192:195], v[160:163]
    v_sub_f32 v167, 0, v25
    v_exp_f32 v64, v64
    v_mfma_f32_16x16x32_bf16 v[96:99], a[164:167], v[196:199], v[96:99]
    v_exp_f32 v65, v65
    v_mfma_f32_16x16x32_bf16 v[96:99], a[168:171], v[200:203], v[96:99]
    v_exp_f32 v66, v66
    v_mfma_f32_16x16x32_bf16 v[96:99], a[172:175], v[204:207], v[96:99]
    v_cvt_pk_bf16_f32 v128, v64, v65
    v_exp_f32 v67, v67
    v_mfma_f32_16x16x32_bf16 v[100:103], a[176:179], v[192:195], v[160:163]
    v_exp_f32 v68, v68
    v_mfma_f32_16x16x32_bf16 v[100:103], a[180:183], v[196:199], v[100:103]
    v_cvt_pk_bf16_f32 v129, v66, v67
    v_exp_f32 v69, v69
    v_mfma_f32_16x16x32_bf16 v[100:103], a[184:187], v[200:203], v[100:103]
    v_exp_f32 v70, v70
    v_mfma_f32_16x16x32_bf16 v[100:103], a[188:191], v[204:207], v[100:103]
    v_cvt_pk_bf16_f32 v130, v68, v69
    v_exp_f32 v71, v71
    v_mfma_f32_16x16x32_bf16 v[104:107], a[160:163], v[208:211], v[164:167]
    v_exp_f32 v72, v72
    v_mfma_f32_16x16x32_bf16 v[104:107], a[164:167], v[212:215], v[104:107]
    v_max3_f32 v26, v80, v81, v82
    v_max3_f32 v28, v83, v84, v85
    v_mfma_f32_16x16x32_bf16 v[104:107], a[168:171], v[216:219], v[104:107]
    v_max3_f32 v26, v26, v86, v87
    v_max_f32 v26, v26, v28
    v_mfma_f32_16x16x32_bf16 v[104:107], a[172:175], v[220:223], v[104:107]
    v_mov_b32 v28, v26
    v_mfma_f32_16x16x32_bf16 v[108:111], a[176:179], v[208:211], v[164:167]
    v_mfma_f32_16x16x32_bf16 v[108:111], a[180:183], v[212:215], v[108:111]
    v_permlane32_swap_b32 v28, v26
    v_mfma_f32_16x16x32_bf16 v[108:111], a[184:187], v[216:219], v[108:111]
    v_max_f32 v26, v26, v28
    v_mov_b32 v28, v26
    v_mfma_f32_16x16x32_bf16 v[108:111], a[188:191], v[220:223], v[108:111]
    s_nop 0
    v_permlane16_swap_b32 v28, v26
    v_max_f32 v26, v26, v28
    v_sub_f32 v80, v80, v26
    v_sub_f32 v81, v81, v26
    v_sub_f32 v82, v82, v26
    v_sub_f32 v83, v83, v26
    v_sub_f32 v84, v84, v26
    s_bitcmp1_b32 s52, 12
    s_cselect_b64 s[4:5], s[16:17], s[20:21]
    s_cselect_b32 s6, s18, s22
    s_cselect_b32 s59, 77824, 0
    s_add_u32 m0, s51, s59
    s_andn2_b32 s59, s52, 4096
    s_getreg_b32 s47, hwreg(HW_REG_IB_STS, 0, 24)
    s_and_b32 s47, s47, 0xc0000f
    s_cmp_le_u32 s47, 4194306
    s_cselect_b32 s47, s58, 0
    s_cmp_lt_u32 s52, s47
    s_cbranch_scc0 L_dq_m_m0
    buffer_load_dwordx4 v14, s[4:7], s59 offen offset:0 nt lds
    buffer_load_dwordx4 v15, s[4:7], s59 offen offset:1024 nt lds
    buffer_load_dwordx4 v14, s[4:7], s59 offen offset:2048 nt lds
    buffer_load_dwordx4 v15, s[4:7], s59 offen offset:3072 nt lds
    s_add_u32 m0, m0, 4096
    s_add_u32 s59, s59, 4096
    buffer_load_dwordx4 v14, s[4:7], s59 offen offset:0 nt lds
    buffer_load_dwordx4 v15, s[4:7], s59 offen offset:1024 nt lds
    buffer_load_dwordx4 v14, s[4:7], s59 offen offset:2048 nt lds
    buffer_load_dwordx4 v15, s[4:7], s59 offen offset:3072 nt lds
    s_add_u32 s52, s52, 4096
    s_add_u32 s51, s51, 4096
L_dq_m_m0:
    s_cmp_eq_u32 s51, 81920
    s_cselect_b32 s51, 0, s51
    v_sub_f32 v85, v85, v26
    v_sub_f32 v86, v86, v26
    v_sub_f32 v87, v87, v26
    v_sub_f32 v168, 0, v26
    v_sub_f32 v169, 0, v26
    v_sub_f32 v170, 0, v26
    v_sub_f32 v171, 0, v26
    v_add_u32 v2, s49, v2
    v_add_u32 v3, s49, v3
    v_add_u32 v4, s49, v4
    v_mfma_f32_16x16x32_bf16 v[112:115], a[160:163], v[224:227], v[168:171]
    v_add_u32 v5, s49, v5
    v_add_u32 v6, s49, v6
    v_mfma_f32_16x16x32_bf16 v[112:115], a[164:167], v[228:231], v[112:115]
    s_getreg_b32 s47, hwreg(HW_REG_IB_STS, 0, 24)
    s_lshr_b32 s59, s47, 22
    s_and_b32 s47, s47, 15
    s_lshl4_add_u32 s47, s59, s47
    s_lshl_b32 s47, s47, 9
    s_add_u32 s47, s47, s60
    s_cmp_le_u32 s47, s52
    s_cbranch_scc0 L_dqwait_m
L_dqok_m:
    s_barrier
    s_add_u32 s60, s60, 16384
    s_add_u32 s58, s58, 14848
    v_add_u32 v7, s49, v7
    v_mfma_f32_16x16x32_bf16 v[112:115], a[168:171], v[232:235], v[112:115]
    ds_read_b128 a[128:131], v2 offset:0
    v_add_u32 v8, s49, v8
    v_mfma_f32_16x16x32_bf16 v[112:115], a[172:175], v[236:239], v[112:115]
    ds_read_b128 a[132:135], v3 offset:0
    v_add_u32 v9, s49, v9
    v_mfma_f32_16x16x32_bf16 v[116:119], a[176:179], v[224:227], v[168:171]
    ds_read_b128 a[136:139], v4 offset:0
    v_add_u32 v10, s49, v10
    v_mfma_f32_16x16x32_bf16 v[116:119], a[180:183], v[228:231], v[116:119]
    ds_read_b128 a[140:143], v5 offset:0
    v_add_u32 v11, s49, v11
    v_mfma_f32_16x16x32_bf16 v[116:119], a[184:187], v[232:235], v[116:119]
    ds_read_b128 a[144:147], v2 offset:4096
    v_add_u32 v12, s49, v12
    v_mfma_f32_16x16x32_bf16 v[116:119], a[188:191], v[236:239], v[116:119]
    ds_read_b128 a[148:151], v3 offset:4096
    v_add_u32 v13, s49, v13
    ds_read_b128 a[152:155], v4 offset:4096
    v_cvt_pk_bf16_f32 v131, v70, v71
    ds_read_b128 a[156:159], v5 offset:4096
    v_exp_f32 v73, v73
    ds_read_b64_tr_b16 a[160:161], v6 offset:0
    v_exp_f32 v74, v74
    ds_read_b64_tr_b16 a[162:163], v6 offset:4096
    v_cvt_pk_bf16_f32 v132, v72, v73
    ds_read_b64_tr_b16 a[164:165], v7 offset:0
    v_exp_f32 v75, v75
    ds_read_b64_tr_b16 a[166:167], v7 offset:4096
    v_exp_f32 v76, v76
    ds_read_b64_tr_b16 a[168:169], v8 offset:0
    v_cvt_pk_bf16_f32 v133, v74, v75
    ds_read_b64_tr_b16 a[170:171], v8 offset:4096
    v_exp_f32 v77, v77
    ds_read_b64_tr_b16 a[172:173], v9 offset:0
    v_exp_f32 v78, v78
    v_cvt_pk_bf16_f32 v134, v76, v77
    v_exp_f32 v79, v79
    v_exp_f32 v80, v80
    v_cvt_pk_bf16_f32 v135, v78, v79
    v_exp_f32 v81, v81
    v_exp_f32 v82, v82
    v_cvt_pk_bf16_f32 v136, v80, v81
    v_exp_f32 v83, v83
    v_exp_f32 v84, v84
    v_cvt_pk_bf16_f32 v137, v82, v83
    v_exp_f32 v85, v85
    v_exp_f32 v86, v86
    v_cvt_pk_bf16_f32 v138, v84, v85
    v_exp_f32 v87, v87
    v_exp_f32 v96, v96
    v_cvt_pk_bf16_f32 v139, v86, v87
    v_exp_f32 v97, v97
    s_waitcnt lgkmcnt(7)
    v_cvt_pk_bf16_f32 v144, v96, v97
    s_waitcnt vmcnt(32)
    v_mov_b32 v24, 0
    v_mov_b32 v25, 0
    buffer_store_dwordx2 v[24:25], v17, s[24:27], s84 offen sc1
    buffer_store_dwordx2 v[24:25], v17, s[24:27], s85 offen sc1
    s_add_u32 s43, s63, 1
    s_and_b32 s43, s43, 3
    s_sub_u32 s43, s43, s63
    s_lshl1_add_u32 s43, s43, s2
    s_lshl2_add_u32 s43, s43, s40
    s_lshl_b32 s43, s43, 9
    s_add_u32 s43, s43, 17301504
    buffer_store_dwordx2 v[24:25], v17, s[24:27], s43 offen sc1
    s_add_u32 s43, s63, 2
    s_and_b32 s43, s43, 3
    s_sub_u32 s43, s43, s63
    s_lshl1_add_u32 s43, s43, s2
    s_lshl2_add_u32 s43, s43, s40
    s_lshl_b32 s43, s43, 9
    s_add_u32 s43, s43, 17301632
    buffer_store_dwordx2 v[24:25], v17, s[24:27], s43 offen sc1
    s_add_u32 s43, s63, 3
    s_and_b32 s43, s43, 3
    s_sub_u32 s43, s43, s63
    s_lshl1_add_u32 s43, s43, s2
    s_lshl2_add_u32 s43, s43, s40
    s_lshl_b32 s43, s43, 9
    s_add_u32 s43, s43, 17301760
    buffer_store_dwordx2 v[24:25], v17, s[24:27], s43 offen sc1
    v_cmp_eq_u64 vcc, 0, v[56:57]
    s_nop 4
    s_cbranch_vccnz L_non3_spin
L_non3_ok:
L_steady_q3:
    s_mul_i32 s43, s63, 1179648
    s_mul_i32 s44, s68, 36864
    s_add_u32 s43, s43, s44
    s_add_u32 s43, s43, 4096
    v_add_u32 v254, s43, v16
    v_add_u32 v244, 0, v254
    v_add_u32 v245, 6144, v254
    v_add_u32 v246, 12288, v254
    v_add_u32 v247, 18432, v254
    v_add_u32 v248, 24576, v254
    v_add_u32 v249, 30720, v254
    s_mov_b32 s53, 13
.p2align 6
L_loop_q3:
    v_mfma_f32_16x16x32_bf16 v[64:67], a[128:131], v[192:195], v[160:163]
    v_exp_f32 v98, v98
    v_mfma_f32_16x16x32_bf16 v[64:67], a[132:135], v[196:199], v[64:67]
    ds_read_b64_tr_b16 a[174:175], v9 offset:4096
    v_mfma_f32_16x16x32_bf16 v[64:67], a[136:139], v[200:203], v[64:67]
    v_exp_f32 v99, v99
    v_mfma_f32_16x16x32_bf16 v[64:67], a[140:143], v[204:207], v[64:67]
    ds_read_b64_tr_b16 a[176:177], v10 offset:0
    v_cvt_pk_bf16_f32 v145, v98, v99
    v_mfma_f32_16x16x32_bf16 v[68:71], a[144:147], v[192:195], v[160:163]
    s_bitcmp1_b32 s52, 12
    s_cselect_b64 s[4:5], s[16:17], s[20:21]
    v_exp_f32 v100, v100
    v_mfma_f32_16x16x32_bf16 v[68:71], a[148:151], v[196:199], v[68:71]
    s_cselect_b32 s6, s18, s22
    s_cselect_b32 s59, 77824, 0
    ds_read_b64_tr_b16 a[178:179], v10 offset:4096
    v_mfma_f32_16x16x32_bf16 v[68:71], a[152:155], v[200:203], v[68:71]
    s_add_u32 m0, s51, s59
    s_andn2_b32 s59, s52, 4096
    v_exp_f32 v101, v101
    v_mfma_f32_16x16x32_bf16 v[68:71], a[156:159], v[204:207], v[68:71]
    s_getreg_b32 s47, hwreg(HW_REG_IB_STS, 0, 24)
    ds_read_b64_tr_b16 a[180:181], v11 offset:0
    v_cvt_pk_bf16_f32 v146, v100, v101
    v_mfma_f32_16x16x32_bf16 v[72:75], a[128:131], v[208:211], v[164:167]
    s_and_b32 s47, s47, 0xc0000f
    v_exp_f32 v102, v102
    v_mfma_f32_16x16x32_bf16 v[72:75], a[132:135], v[212:215], v[72:75]
    s_cmp_le_u32 s47, 4194306
    ds_read_b64_tr_b16 a[182:183], v11 offset:4096
    v_mfma_f32_16x16x32_bf16 v[72:75], a[136:139], v[216:219], v[72:75]
    s_cselect_b32 s47, s58, 0
    v_exp_f32 v103, v103
    v_mfma_f32_16x16x32_bf16 v[72:75], a[140:143], v[220:223], v[72:75]
    s_cmp_lt_u32 s52, s47
    ds_read_b64_tr_b16 a[184:185], v12 offset:0
    v_cvt_pk_bf16_f32 v147, v102, v103
    v_mfma_f32_16x16x32_bf16 v[76:79], a[144:147], v[208:211], v[164:167]
    s_cbranch_scc0 L_dq_l_1
    buffer_load_dwordx4 v14, s[4:7], s59 offen offset:0 nt lds
    buffer_load_dwordx4 v15, s[4:7], s59 offen offset:1024 nt lds
    buffer_load_dwordx4 v14, s[4:7], s59 offen offset:2048 nt lds
    buffer_load_dwordx4 v15, s[4:7], s59 offen offset:3072 nt lds
    s_add_u32 m0, m0, 4096
    s_add_u32 s59, s59, 4096
    buffer_load_dwordx4 v14, s[4:7], s59 offen offset:0 nt lds
    buffer_load_dwordx4 v15, s[4:7], s59 offen offset:1024 nt lds
    buffer_load_dwordx4 v14, s[4:7], s59 offen offset:2048 nt lds
    buffer_load_dwordx4 v15, s[4:7], s59 offen offset:3072 nt lds
    s_add_u32 s52, s52, 4096
    s_add_u32 s51, s51, 4096
L_dq_l_1:
    v_exp_f32 v104, v104
    v_mfma_f32_16x16x32_bf16 v[76:79], a[148:151], v[212:215], v[76:79]
    s_cmp_eq_u32 s51, 81920
    ds_read_b64_tr_b16 a[186:187], v12 offset:4096
    v_mfma_f32_16x16x32_bf16 v[76:79], a[152:155], v[216:219], v[76:79]
    s_cselect_b32 s51, 0, s51
    v_exp_f32 v105, v105
    v_mfma_f32_16x16x32_bf16 v[76:79], a[156:159], v[220:223], v[76:79]
    ds_read_b64_tr_b16 a[188:189], v13 offset:0
    v_cvt_pk_bf16_f32 v148, v104, v105
    v_mfma_f32_16x16x32_bf16 v[80:83], a[128:131], v[224:227], v[168:171]
    v_exp_f32 v106, v106
    v_mfma_f32_16x16x32_bf16 v[80:83], a[132:135], v[228:231], v[80:83]
    ds_read_b64_tr_b16 a[190:191], v13 offset:4096
    v_mfma_f32_16x16x32_bf16 v[80:83], a[136:139], v[232:235], v[80:83]
    v_exp_f32 v107, v107
    v_mfma_f32_16x16x32_bf16 v[80:83], a[140:143], v[236:239], v[80:83]
    v_cvt_pk_bf16_f32 v149, v106, v107
    v_mfma_f32_16x16x32_bf16 v[84:87], a[144:147], v[224:227], v[168:171]
    v_exp_f32 v108, v108
    v_mfma_f32_16x16x32_bf16 v[84:87], a[148:151], v[228:231], v[84:87]
    v_mfma_f32_16x16x32_bf16 v[84:87], a[152:155], v[232:235], v[84:87]
    s_waitcnt lgkmcnt(0)
    v_exp_f32 v109, v109
    v_mfma_f32_16x16x32_bf16 v[84:87], a[156:159], v[236:239], v[84:87]
    ds_read_b128 a[128:131], v2 offset:8192
    v_cvt_pk_bf16_f32 v150, v108, v109
    v_mfma_f32_16x16x32_bf16 a[0:3], a[160:163], v[128:131], a[0:3]
    v_exp_f32 v110, v110
    v_smfmac_f32_16x16x64_bf16 a[192:195], v[20:23], v[128:135], v59
    ds_read_b128 a[132:135], v3 offset:8192
    v_mfma_f32_16x16x32_bf16 a[32:35], a[160:163], v[132:135], a[32:35]
    v_exp_f32 v111, v111
    v_smfmac_f32_16x16x64_bf16 a[196:199], v[20:23], v[132:139], v59
    ds_read_b128 a[136:139], v4 offset:8192
    v_cvt_pk_bf16_f32 v151, v110, v111
    v_mfma_f32_16x16x32_bf16 a[64:67], a[160:163], v[136:139], a[64:67]
    v_exp_f32 v112, v112
    v_mfma_f32_16x16x32_bf16 a[4:7], a[164:167], v[128:131], a[4:7]
    s_bitcmp1_b32 s52, 12
    s_cselect_b64 s[4:5], s[16:17], s[20:21]
    ds_read_b128 a[140:143], v5 offset:8192
    v_mfma_f32_16x16x32_bf16 a[36:39], a[164:167], v[132:135], a[36:39]
    s_cselect_b32 s6, s18, s22
    s_cselect_b32 s59, 77824, 0
    v_exp_f32 v113, v113
    v_mfma_f32_16x16x32_bf16 a[68:71], a[164:167], v[136:139], a[68:71]
    s_add_u32 m0, s51, s59
    s_andn2_b32 s59, s52, 4096
    ds_read_b128 a[144:147], v2 offset:12288
    v_cvt_pk_bf16_f32 v152, v112, v113
    v_mfma_f32_16x16x32_bf16 a[8:11], a[168:171], v[128:131], a[8:11]
    s_getreg_b32 s47, hwreg(HW_REG_IB_STS, 0, 24)
    v_exp_f32 v114, v114
    v_mfma_f32_16x16x32_bf16 a[40:43], a[168:171], v[132:135], a[40:43]
    s_and_b32 s47, s47, 0xc0000f
    ds_read_b128 a[148:151], v3 offset:12288
    v_mfma_f32_16x16x32_bf16 a[72:75], a[168:171], v[136:139], a[72:75]
    s_cmp_le_u32 s47, 4194306
    v_exp_f32 v115, v115
    v_mfma_f32_16x16x32_bf16 a[12:15], a[172:175], v[128:131], a[12:15]
    s_cselect_b32 s47, s58, 0
    ds_read_b128 a[152:155], v4 offset:12288
    v_cvt_pk_bf16_f32 v153, v114, v115
    v_mfma_f32_16x16x32_bf16 a[44:47], a[172:175], v[132:135], a[44:47]
    s_cmp_lt_u32 s52, s47
    v_exp_f32 v116, v116
    v_mfma_f32_16x16x32_bf16 a[76:79], a[172:175], v[136:139], a[76:79]
    s_cbranch_scc0 L_dq_l_2
    buffer_load_dwordx4 v14, s[4:7], s59 offen offset:0 nt lds
    buffer_load_dwordx4 v15, s[4:7], s59 offen offset:1024 nt lds
    buffer_load_dwordx4 v14, s[4:7], s59 offen offset:2048 nt lds
    buffer_load_dwordx4 v15, s[4:7], s59 offen offset:3072 nt lds
    s_add_u32 m0, m0, 4096
    s_add_u32 s59, s59, 4096
    buffer_load_dwordx4 v14, s[4:7], s59 offen offset:0 nt lds
    buffer_load_dwordx4 v15, s[4:7], s59 offen offset:1024 nt lds
    buffer_load_dwordx4 v14, s[4:7], s59 offen offset:2048 nt lds
    buffer_load_dwordx4 v15, s[4:7], s59 offen offset:3072 nt lds
    s_add_u32 s52, s52, 4096
    s_add_u32 s51, s51, 4096
L_dq_l_2:
    ds_read_b128 a[156:159], v5 offset:12288
    v_mfma_f32_16x16x32_bf16 a[16:19], a[176:179], v[128:131], a[16:19]
    s_cmp_eq_u32 s51, 81920
    v_exp_f32 v117, v117
    v_mfma_f32_16x16x32_bf16 a[48:51], a[176:179], v[132:135], a[48:51]
    s_cselect_b32 s51, 0, s51
    ds_read_b64_tr_b16 a[160:161], v6 offset:8192
    v_cvt_pk_bf16_f32 v154, v116, v117
    v_mfma_f32_16x16x32_bf16 a[80:83], a[176:179], v[136:139], a[80:83]
    v_exp_f32 v118, v118
    v_mfma_f32_16x16x32_bf16 a[20:23], a[180:183], v[128:131], a[20:23]
    ds_read_b64_tr_b16 a[162:163], v6 offset:12288
    v_mfma_f32_16x16x32_bf16 a[52:55], a[180:183], v[132:135], a[52:55]
    v_exp_f32 v119, v119
    v_mfma_f32_16x16x32_bf16 a[84:87], a[180:183], v[136:139], a[84:87]
    ds_read_b64_tr_b16 a[164:165], v7 offset:8192
    v_cvt_pk_bf16_f32 v155, v118, v119
    v_mfma_f32_16x16x32_bf16 a[24:27], a[184:187], v[128:131], a[24:27]
    ds_read_b64_tr_b16 a[166:167], v7 offset:12288
    v_mfma_f32_16x16x32_bf16 a[56:59], a[184:187], v[132:135], a[56:59]
    ds_read_b64_tr_b16 a[168:169], v8 offset:8192
    v_mfma_f32_16x16x32_bf16 a[88:91], a[184:187], v[136:139], a[88:91]
    v_exp_f32 v64, v64
    v_mfma_f32_16x16x32_bf16 a[28:31], a[188:191], v[128:131], a[28:31]
    ds_read_b64_tr_b16 a[170:171], v8 offset:12288
    v_mfma_f32_16x16x32_bf16 a[60:63], a[188:191], v[132:135], a[60:63]
    v_exp_f32 v65, v65
    v_mfma_f32_16x16x32_bf16 a[92:95], a[188:191], v[136:139], a[92:95]
    s_waitcnt lgkmcnt(6)
    ds_read_b64_tr_b16 a[172:173], v9 offset:8192
    v_cvt_pk_bf16_f32 v128, v64, v65
    v_mfma_f32_16x16x32_bf16 v[96:99], a[128:131], v[192:195], v[160:163]
    s_cmp_eq_u32 s48, 65536
    s_cselect_b32 s49, s50, 16384
    v_exp_f32 v66, v66
    v_mfma_f32_16x16x32_bf16 v[96:99], a[132:135], v[196:199], v[96:99]
    s_add_u32 s48, s48, s49
    ds_read_b64_tr_b16 a[174:175], v9 offset:12288
    v_mfma_f32_16x16x32_bf16 v[96:99], a[136:139], v[200:203], v[96:99]
    v_exp_f32 v67, v67
    v_mfma_f32_16x16x32_bf16 v[96:99], a[140:143], v[204:207], v[96:99]
    s_bitcmp1_b32 s52, 12
    s_cselect_b64 s[4:5], s[16:17], s[20:21]
    ds_read_b64_tr_b16 a[176:177], v10 offset:8192
    v_cvt_pk_bf16_f32 v129, v66, v67
    v_mfma_f32_16x16x32_bf16 v[100:103], a[144:147], v[192:195], v[160:163]
    s_cselect_b32 s6, s18, s22
    s_cselect_b32 s59, 77824, 0
    v_exp_f32 v68, v68
    v_mfma_f32_16x16x32_bf16 v[100:103], a[148:151], v[196:199], v[100:103]
    s_add_u32 m0, s51, s59
    s_andn2_b32 s59, s52, 4096
    ds_read_b64_tr_b16 a[178:179], v10 offset:12288
    v_add_u32 v2, s49, v2
    v_mfma_f32_16x16x32_bf16 v[100:103], a[152:155], v[200:203], v[100:103]
    s_getreg_b32 s47, hwreg(HW_REG_IB_STS, 0, 24)
    v_exp_f32 v69, v69
    v_mfma_f32_16x16x32_bf16 v[100:103], a[156:159], v[204:207], v[100:103]
    s_and_b32 s47, s47, 0xc0000f
    ds_read_b64_tr_b16 a[180:181], v11 offset:8192
    v_cvt_pk_bf16_f32 v130, v68, v69
    v_mfma_f32_16x16x32_bf16 v[104:107], a[128:131], v[208:211], v[164:167]
    s_cmp_le_u32 s47, 4194306
    v_exp_f32 v70, v70
    v_mfma_f32_16x16x32_bf16 v[104:107], a[132:135], v[212:215], v[104:107]
    s_cselect_b32 s47, s58, 0
    ds_read_b64_tr_b16 a[182:183], v11 offset:12288
    v_add_u32 v3, s49, v3
    v_mfma_f32_16x16x32_bf16 v[104:107], a[136:139], v[216:219], v[104:107]
    s_cmp_lt_u32 s52, s47
    v_exp_f32 v71, v71
    v_mfma_f32_16x16x32_bf16 v[104:107], a[140:143], v[220:223], v[104:107]
    s_cbranch_scc0 L_dq_l_3
    buffer_load_dwordx4 v14, s[4:7], s59 offen offset:0 nt lds
    buffer_load_dwordx4 v15, s[4:7], s59 offen offset:1024 nt lds
    buffer_load_dwordx4 v14, s[4:7], s59 offen offset:2048 nt lds
    buffer_load_dwordx4 v15, s[4:7], s59 offen offset:3072 nt lds
    s_add_u32 m0, m0, 4096
    s_add_u32 s59, s59, 4096
    buffer_load_dwordx4 v14, s[4:7], s59 offen offset:0 nt lds
    buffer_load_dwordx4 v15, s[4:7], s59 offen offset:1024 nt lds
    buffer_load_dwordx4 v14, s[4:7], s59 offen offset:2048 nt lds
    buffer_load_dwordx4 v15, s[4:7], s59 offen offset:3072 nt lds
    s_add_u32 s52, s52, 4096
    s_add_u32 s51, s51, 4096
L_dq_l_3:
    ds_read_b64_tr_b16 a[184:185], v12 offset:8192
    v_cvt_pk_bf16_f32 v131, v70, v71
    v_mfma_f32_16x16x32_bf16 v[108:111], a[144:147], v[208:211], v[164:167]
    s_cmp_eq_u32 s51, 81920
    v_exp_f32 v72, v72
    v_mfma_f32_16x16x32_bf16 v[108:111], a[148:151], v[212:215], v[108:111]
    s_cselect_b32 s51, 0, s51
    ds_read_b64_tr_b16 a[186:187], v12 offset:12288
    v_add_u32 v4, s49, v4
    v_mfma_f32_16x16x32_bf16 v[108:111], a[152:155], v[216:219], v[108:111]
    v_exp_f32 v73, v73
    v_mfma_f32_16x16x32_bf16 v[108:111], a[156:159], v[220:223], v[108:111]
    s_getreg_b32 s47, hwreg(HW_REG_IB_STS, 0, 24)
    ds_read_b64_tr_b16 a[188:189], v13 offset:8192
    v_cvt_pk_bf16_f32 v132, v72, v73
    v_mfma_f32_16x16x32_bf16 v[112:115], a[128:131], v[224:227], v[168:171]
    s_lshr_b32 s59, s47, 22
    v_exp_f32 v74, v74
    v_mfma_f32_16x16x32_bf16 v[112:115], a[132:135], v[228:231], v[112:115]
    s_and_b32 s47, s47, 15
    ds_read_b64_tr_b16 a[190:191], v13 offset:12288
    v_add_u32 v5, s49, v5
    v_mfma_f32_16x16x32_bf16 v[112:115], a[136:139], v[232:235], v[112:115]
    s_lshl4_add_u32 s47, s59, s47
    v_exp_f32 v75, v75
    v_mfma_f32_16x16x32_bf16 v[112:115], a[140:143], v[236:239], v[112:115]
    s_lshl_b32 s47, s47, 9
    v_cvt_pk_bf16_f32 v133, v74, v75
    v_mfma_f32_16x16x32_bf16 v[116:119], a[144:147], v[224:227], v[168:171]
    s_add_u32 s47, s47, s60
    v_exp_f32 v76, v76
    v_mfma_f32_16x16x32_bf16 v[116:119], a[148:151], v[228:231], v[116:119]
    s_cmp_le_u32 s47, s52
    v_add_u32 v6, s49, v6
    v_add_u32 v7, s49, v7
    v_mfma_f32_16x16x32_bf16 v[116:119], a[152:155], v[232:235], v[116:119]
    s_waitcnt lgkmcnt(0)
    s_cbranch_scc0 L_dqwait_l
L_dqok_l:
    s_barrier
    v_exp_f32 v77, v77
    v_mfma_f32_16x16x32_bf16 v[116:119], a[156:159], v[236:239], v[116:119]
    s_cmp_lt_u32 s60, 16384
    s_cselect_b32 s47, -3, 0
    ds_read_b128 a[128:131], v2 offset:0
    v_cvt_pk_bf16_f32 v134, v76, v77
    v_mfma_f32_16x16x32_bf16 a[0:3], a[160:163], v[144:147], a[0:3]
    s_lshl_b32 s47, s47, 9
    s_sub_u32 s58, s58, s47
    v_exp_f32 v78, v78
    v_smfmac_f32_16x16x64_bf16 a[192:195], v[20:23], v[144:151], v59
    s_add_u32 s58, s58, 14848
    s_add_u32 s47, s60, 65536
    ds_read_b128 a[132:135], v3 offset:0
    v_add_u32 v8, s49, v8
    v_add_u32 v9, s49, v9
    v_mfma_f32_16x16x32_bf16 a[32:35], a[160:163], v[148:151], a[32:35]
    s_min_u32 s58, s58, s47
    s_min_u32 s58, s58, 262144
    s_add_u32 s60, s60, 16384
    v_exp_f32 v79, v79
    v_smfmac_f32_16x16x64_bf16 a[196:199], v[20:23], v[148:155], v59
    s_bitcmp1_b32 s52, 12
    s_cselect_b64 s[4:5], s[16:17], s[20:21]
    ds_read_b128 a[136:139], v4 offset:0
    v_cvt_pk_bf16_f32 v135, v78, v79
    v_mfma_f32_16x16x32_bf16 a[64:67], a[160:163], v[152:155], a[64:67]
    s_cselect_b32 s6, s18, s22
    s_cselect_b32 s59, 77824, 0
    v_exp_f32 v80, v80
    v_mfma_f32_16x16x32_bf16 a[4:7], a[164:167], v[144:147], a[4:7]
    s_add_u32 m0, s51, s59
    s_andn2_b32 s59, s52, 4096
    ds_read_b128 a[140:143], v5 offset:0
    v_add_u32 v10, s49, v10
    v_add_u32 v11, s49, v11
    v_mfma_f32_16x16x32_bf16 a[36:39], a[164:167], v[148:151], a[36:39]
    s_getreg_b32 s47, hwreg(HW_REG_IB_STS, 0, 24)
    v_exp_f32 v81, v81
    v_mfma_f32_16x16x32_bf16 a[68:71], a[164:167], v[152:155], a[68:71]
    s_and_b32 s47, s47, 0xc0000f
    ds_read_b128 a[144:147], v2 offset:4096
    v_cvt_pk_bf16_f32 v136, v80, v81
    v_mfma_f32_16x16x32_bf16 a[8:11], a[168:171], v[144:147], a[8:11]
    s_cmp_le_u32 s47, 4194306
    v_exp_f32 v82, v82
    v_mfma_f32_16x16x32_bf16 a[40:43], a[168:171], v[148:151], a[40:43]
    s_cselect_b32 s47, s58, 0
    ds_read_b128 a[148:151], v3 offset:4096
    v_add_u32 v12, s49, v12
    v_mfma_f32_16x16x32_bf16 a[72:75], a[168:171], v[152:155], a[72:75]
    s_cmp_lt_u32 s52, s47
    v_exp_f32 v83, v83
    v_mfma_f32_16x16x32_bf16 a[12:15], a[172:175], v[144:147], a[12:15]
    s_cbranch_scc0 L_dq_l_0
    buffer_load_dwordx4 v14, s[4:7], s59 offen offset:0 nt lds
    buffer_load_dwordx4 v15, s[4:7], s59 offen offset:1024 nt lds
    buffer_load_dwordx4 v14, s[4:7], s59 offen offset:2048 nt lds
    buffer_load_dwordx4 v15, s[4:7], s59 offen offset:3072 nt lds
    s_add_u32 m0, m0, 4096
    s_add_u32 s59, s59, 4096
    buffer_load_dwordx4 v14, s[4:7], s59 offen offset:0 nt lds
    buffer_load_dwordx4 v15, s[4:7], s59 offen offset:1024 nt lds
    buffer_load_dwordx4 v14, s[4:7], s59 offen offset:2048 nt lds
    buffer_load_dwordx4 v15, s[4:7], s59 offen offset:3072 nt lds
    s_add_u32 s52, s52, 4096
    s_add_u32 s51, s51, 4096
L_dq_l_0:
    ds_read_b128 a[152:155], v4 offset:4096
    v_cvt_pk_bf16_f32 v137, v82, v83
    v_mfma_f32_16x16x32_bf16 a[44:47], a[172:175], v[148:151], a[44:47]
    s_cmp_eq_u32 s51, 81920
    v_exp_f32 v84, v84
    v_mfma_f32_16x16x32_bf16 a[76:79], a[172:175], v[152:155], a[76:79]
    s_cselect_b32 s51, 0, s51
    ds_read_b128 a[156:159], v5 offset:4096
    v_add_u32 v13, s49, v13
    v_mfma_f32_16x16x32_bf16 a[16:19], a[176:179], v[144:147], a[16:19]
    v_exp_f32 v85, v85
    v_mfma_f32_16x16x32_bf16 a[48:51], a[176:179], v[148:151], a[48:51]
    ds_read_b64_tr_b16 a[160:161], v6 offset:0
    v_cvt_pk_bf16_f32 v138, v84, v85
    v_mfma_f32_16x16x32_bf16 a[80:83], a[176:179], v[152:155], a[80:83]
    v_exp_f32 v86, v86
    v_mfma_f32_16x16x32_bf16 a[20:23], a[180:183], v[144:147], a[20:23]
    ds_read_b64_tr_b16 a[162:163], v6 offset:4096
    v_mfma_f32_16x16x32_bf16 a[52:55], a[180:183], v[148:151], a[52:55]
    v_exp_f32 v87, v87
    v_mfma_f32_16x16x32_bf16 a[84:87], a[180:183], v[152:155], a[84:87]
    ds_read_b64_tr_b16 a[164:165], v7 offset:0
    v_cvt_pk_bf16_f32 v139, v86, v87
    v_mfma_f32_16x16x32_bf16 a[24:27], a[184:187], v[144:147], a[24:27]
    ds_read_b64_tr_b16 a[166:167], v7 offset:4096
    v_mfma_f32_16x16x32_bf16 a[56:59], a[184:187], v[148:151], a[56:59]
    ds_read_b64_tr_b16 a[168:169], v8 offset:0
    v_mfma_f32_16x16x32_bf16 a[88:91], a[184:187], v[152:155], a[88:91]
    v_exp_f32 v96, v96
    v_mfma_f32_16x16x32_bf16 a[28:31], a[188:191], v[144:147], a[28:31]
    s_sub_u32 s53, s53, 1
    ds_read_b64_tr_b16 a[170:171], v8 offset:4096
    v_mfma_f32_16x16x32_bf16 a[60:63], a[188:191], v[148:151], a[60:63]
    s_cmp_lg_u32 s53, 0
    v_exp_f32 v97, v97
    v_mfma_f32_16x16x32_bf16 a[92:95], a[188:191], v[152:155], a[92:95]
    s_waitcnt lgkmcnt(6)
    ds_read_b64_tr_b16 a[172:173], v9 offset:0
    v_cvt_pk_bf16_f32 v144, v96, v97
    s_cbranch_scc1 L_loop_q3
L_dqrest:
    s_bitcmp1_b32 s52, 12
    s_cselect_b64 s[4:5], s[16:17], s[20:21]
    s_cselect_b32 s6, s18, s22
    s_cselect_b32 s59, 77824, 0
    s_add_u32 m0, s51, s59
    s_andn2_b32 s59, s52, 4096
    s_cmp_lt_u32 s52, 262144
    s_cbranch_scc0 L_dqdone
    buffer_load_dwordx4 v14, s[4:7], s59 offen offset:0 nt lds
    buffer_load_dwordx4 v15, s[4:7], s59 offen offset:1024 nt lds
    buffer_load_dwordx4 v14, s[4:7], s59 offen offset:2048 nt lds
    buffer_load_dwordx4 v15, s[4:7], s59 offen offset:3072 nt lds
    s_add_u32 m0, m0, 4096
    s_add_u32 s59, s59, 4096
    buffer_load_dwordx4 v14, s[4:7], s59 offen offset:0 nt lds
    buffer_load_dwordx4 v15, s[4:7], s59 offen offset:1024 nt lds
    buffer_load_dwordx4 v14, s[4:7], s59 offen offset:2048 nt lds
    buffer_load_dwordx4 v15, s[4:7], s59 offen offset:3072 nt lds
    s_add_u32 s52, s52, 4096
    s_add_u32 s51, s51, 4096
    s_cmp_eq_u32 s51, 81920
    s_cselect_b32 s51, 0, s51
    s_branch L_dqrest
L_dqdone:
    v_mfma_f32_16x16x32_bf16 v[64:67], a[128:131], v[192:195], v[160:163]
    v_exp_f32 v98, v98
    v_mfma_f32_16x16x32_bf16 v[64:67], a[132:135], v[196:199], v[64:67]
    ds_read_b64_tr_b16 a[174:175], v9 offset:4096
    v_mfma_f32_16x16x32_bf16 v[64:67], a[136:139], v[200:203], v[64:67]
    v_exp_f32 v99, v99
    v_mfma_f32_16x16x32_bf16 v[64:67], a[140:143], v[204:207], v[64:67]
    ds_read_b64_tr_b16 a[176:177], v10 offset:0
    v_cvt_pk_bf16_f32 v145, v98, v99
    v_mfma_f32_16x16x32_bf16 v[68:71], a[144:147], v[192:195], v[160:163]
    v_exp_f32 v100, v100
    v_mfma_f32_16x16x32_bf16 v[68:71], a[148:151], v[196:199], v[68:71]
    ds_read_b64_tr_b16 a[178:179], v10 offset:4096
    v_mfma_f32_16x16x32_bf16 v[68:71], a[152:155], v[200:203], v[68:71]
    v_exp_f32 v101, v101
    v_mfma_f32_16x16x32_bf16 v[68:71], a[156:159], v[204:207], v[68:71]
    ds_read_b64_tr_b16 a[180:181], v11 offset:0
    v_cvt_pk_bf16_f32 v146, v100, v101
    v_mfma_f32_16x16x32_bf16 v[72:75], a[128:131], v[208:211], v[164:167]
    global_load_dwordx4 v[240:243], v244, s[88:89] offset:-4096
    v_exp_f32 v102, v102
    v_mfma_f32_16x16x32_bf16 v[72:75], a[132:135], v[212:215], v[72:75]
    ds_read_b64_tr_b16 a[182:183], v11 offset:4096
    global_load_dwordx4 v[240:243], v244, s[88:89] offset:-3072
    v_mfma_f32_16x16x32_bf16 v[72:75], a[136:139], v[216:219], v[72:75]
    global_load_dwordx4 v[240:243], v244, s[88:89] offset:-2048
    v_exp_f32 v103, v103
    v_mfma_f32_16x16x32_bf16 v[72:75], a[140:143], v[220:223], v[72:75]
    ds_read_b64_tr_b16 a[184:185], v12 offset:0
    global_load_dwordx4 v[240:243], v244, s[88:89] offset:-1024
    v_cvt_pk_bf16_f32 v147, v102, v103
    v_mfma_f32_16x16x32_bf16 v[76:79], a[144:147], v[208:211], v[164:167]
    v_exp_f32 v104, v104
    v_mfma_f32_16x16x32_bf16 v[76:79], a[148:151], v[212:215], v[76:79]
    ds_read_b64_tr_b16 a[186:187], v12 offset:4096
    global_load_dwordx4 v[240:243], v244, s[88:89] offset:0
    v_mfma_f32_16x16x32_bf16 v[76:79], a[152:155], v[216:219], v[76:79]
    global_load_dwordx4 v[240:243], v244, s[88:89] offset:1024
    v_exp_f32 v105, v105
    v_mfma_f32_16x16x32_bf16 v[76:79], a[156:159], v[220:223], v[76:79]
    ds_read_b64_tr_b16 a[188:189], v13 offset:0
    global_load_dwordx4 v[240:243], v245, s[88:89] offset:-4096
    v_cvt_pk_bf16_f32 v148, v104, v105
    v_mfma_f32_16x16x32_bf16 v[80:83], a[128:131], v[224:227], v[168:171]
    global_load_dwordx4 v[240:243], v245, s[88:89] offset:-3072
    v_exp_f32 v106, v106
    v_mfma_f32_16x16x32_bf16 v[80:83], a[132:135], v[228:231], v[80:83]
    ds_read_b64_tr_b16 a[190:191], v13 offset:4096
    v_mfma_f32_16x16x32_bf16 v[80:83], a[136:139], v[232:235], v[80:83]
    global_load_dwordx4 v[240:243], v245, s[88:89] offset:-2048
    v_exp_f32 v107, v107
    v_mfma_f32_16x16x32_bf16 v[80:83], a[140:143], v[236:239], v[80:83]
    global_load_dwordx4 v[240:243], v245, s[88:89] offset:-1024
    v_cvt_pk_bf16_f32 v149, v106, v107
    v_mfma_f32_16x16x32_bf16 v[84:87], a[144:147], v[224:227], v[168:171]
    global_load_dwordx4 v[240:243], v245, s[88:89] offset:0
    v_exp_f32 v108, v108
    v_mfma_f32_16x16x32_bf16 v[84:87], a[148:151], v[228:231], v[84:87]
    v_mfma_f32_16x16x32_bf16 v[84:87], a[152:155], v[232:235], v[84:87]
    s_waitcnt lgkmcnt(0)
    global_load_dwordx4 v[240:243], v245, s[88:89] offset:1024
    v_exp_f32 v109, v109
    v_mfma_f32_16x16x32_bf16 v[84:87], a[156:159], v[236:239], v[84:87]
    ds_read_b128 a[128:131], v2 offset:8192
    global_load_dwordx4 v[240:243], v246, s[88:89] offset:-4096
    v_cvt_pk_bf16_f32 v150, v108, v109
    v_mfma_f32_16x16x32_bf16 a[0:3], a[160:163], v[128:131], a[0:3]
    global_load_dwordx4 v[240:243], v246, s[88:89] offset:-3072
    v_exp_f32 v110, v110
    v_smfmac_f32_16x16x64_bf16 a[192:195], v[20:23], v[128:135], v59
    ds_read_b128 a[132:135], v3 offset:8192
    global_load_dwordx4 v[240:243], v246, s[88:89] offset:-2048
    v_mfma_f32_16x16x32_bf16 a[32:35], a[160:163], v[132:135], a[32:35]
    v_exp_f32 v111, v111
    v_smfmac_f32_16x16x64_bf16 a[196:199], v[20:23], v[132:139], v59
    ds_read_b128 a[136:139], v4 offset:8192
    global_load_dwordx4 v[240:243], v246, s[88:89] offset:-1024
    v_cvt_pk_bf16_f32 v151, v110, v111
    v_mfma_f32_16x16x32_bf16 a[64:67], a[160:163], v[136:139], a[64:67]
    global_load_dwordx4 v[240:243], v246, s[88:89] offset:0
    v_exp_f32 v112, v112
    v_mfma_f32_16x16x32_bf16 a[4:7], a[164:167], v[128:131], a[4:7]
    ds_read_b128 a[140:143], v5 offset:8192
    global_load_dwordx4 v[240:243], v246, s[88:89] offset:1024
    v_mfma_f32_16x16x32_bf16 a[36:39], a[164:167], v[132:135], a[36:39]
    v_exp_f32 v113, v113
    v_mfma_f32_16x16x32_bf16 a[68:71], a[164:167], v[136:139], a[68:71]
    ds_read_b128 a[144:147], v2 offset:12288
    global_load_dwordx4 v[240:243], v247, s[88:89] offset:-4096
    v_cvt_pk_bf16_f32 v152, v112, v113
    v_mfma_f32_16x16x32_bf16 a[8:11], a[168:171], v[128:131], a[8:11]
    global_load_dwordx4 v[240:243], v247, s[88:89] offset:-3072
    v_exp_f32 v114, v114
    v_mfma_f32_16x16x32_bf16 a[40:43], a[168:171], v[132:135], a[40:43]
    ds_read_b128 a[148:151], v3 offset:12288
    global_load_dwordx4 v[240:243], v247, s[88:89] offset:-2048
    v_mfma_f32_16x16x32_bf16 a[72:75], a[168:171], v[136:139], a[72:75]
    global_load_dwordx4 v[240:243], v247, s[88:89] offset:-1024
    v_exp_f32 v115, v115
    v_mfma_f32_16x16x32_bf16 a[12:15], a[172:175], v[128:131], a[12:15]
    ds_read_b128 a[152:155], v4 offset:12288
    v_cvt_pk_bf16_f32 v153, v114, v115
    v_mfma_f32_16x16x32_bf16 a[44:47], a[172:175], v[132:135], a[44:47]
    global_load_dwordx4 v[240:243], v247, s[88:89] offset:0
    v_exp_f32 v116, v116
    v_mfma_f32_16x16x32_bf16 a[76:79], a[172:175], v[136:139], a[76:79]
    ds_read_b128 a[156:159], v5 offset:12288
    global_load_dwordx4 v[240:243], v247, s[88:89] offset:1024
    v_mfma_f32_16x16x32_bf16 a[16:19], a[176:179], v[128:131], a[16:19]
    global_load_dwordx4 v[240:243], v248, s[88:89] offset:-4096
    v_exp_f32 v117, v117
    v_mfma_f32_16x16x32_bf16 a[48:51], a[176:179], v[132:135], a[48:51]
    ds_read_b64_tr_b16 a[160:161], v6 offset:8192
    global_load_dwordx4 v[240:243], v248, s[88:89] offset:-3072
    v_cvt_pk_bf16_f32 v154, v116, v117
    v_mfma_f32_16x16x32_bf16 a[80:83], a[176:179], v[136:139], a[80:83]
    v_exp_f32 v118, v118
    v_mfma_f32_16x16x32_bf16 a[20:23], a[180:183], v[128:131], a[20:23]
    ds_read_b64_tr_b16 a[162:163], v6 offset:12288
    global_load_dwordx4 v[240:243], v248, s[88:89] offset:-2048
    v_mfma_f32_16x16x32_bf16 a[52:55], a[180:183], v[132:135], a[52:55]
    global_load_dwordx4 v[240:243], v248, s[88:89] offset:-1024
    v_exp_f32 v119, v119
    v_mfma_f32_16x16x32_bf16 a[84:87], a[180:183], v[136:139], a[84:87]
    ds_read_b64_tr_b16 a[164:165], v7 offset:8192
    global_load_dwordx4 v[240:243], v248, s[88:89] offset:0
    v_cvt_pk_bf16_f32 v155, v118, v119
    v_mfma_f32_16x16x32_bf16 a[24:27], a[184:187], v[128:131], a[24:27]
    ds_read_b64_tr_b16 a[166:167], v7 offset:12288
    v_mfma_f32_16x16x32_bf16 a[56:59], a[184:187], v[132:135], a[56:59]
    ds_read_b64_tr_b16 a[168:169], v8 offset:8192
    global_load_dwordx4 v[240:243], v248, s[88:89] offset:1024
    v_mfma_f32_16x16x32_bf16 a[88:91], a[184:187], v[136:139], a[88:91]
    global_load_dwordx4 v[240:243], v249, s[88:89] offset:-4096
    v_exp_f32 v64, v64
    v_mfma_f32_16x16x32_bf16 a[28:31], a[188:191], v[128:131], a[28:31]
    ds_read_b64_tr_b16 a[170:171], v8 offset:12288
    global_load_dwordx4 v[240:243], v249, s[88:89] offset:-3072
    v_mfma_f32_16x16x32_bf16 a[60:63], a[188:191], v[132:135], a[60:63]
    global_load_dwordx4 v[240:243], v249, s[88:89] offset:-2048
    v_exp_f32 v65, v65
    v_mfma_f32_16x16x32_bf16 a[92:95], a[188:191], v[136:139], a[92:95]
    s_waitcnt lgkmcnt(6)
    ds_read_b64_tr_b16 a[172:173], v9 offset:8192
    v_cvt_pk_bf16_f32 v128, v64, v65
    v_mfma_f32_16x16x32_bf16 v[96:99], a[128:131], v[192:195], v[160:163]
    s_cmp_eq_u32 s48, 65536
    s_cselect_b32 s49, s50, 16384
    global_load_dwordx4 v[240:243], v249, s[88:89] offset:-1024
    v_exp_f32 v66, v66
    v_mfma_f32_16x16x32_bf16 v[96:99], a[132:135], v[196:199], v[96:99]
    s_add_u32 s48, s48, s49
    ds_read_b64_tr_b16 a[174:175], v9 offset:12288
    global_load_dwordx4 v[240:243], v249, s[88:89] offset:0
    v_mfma_f32_16x16x32_bf16 v[96:99], a[136:139], v[200:203], v[96:99]
    global_load_dwordx4 v[240:243], v249, s[88:89] offset:1024
    v_exp_f32 v67, v67
    v_mfma_f32_16x16x32_bf16 v[96:99], a[140:143], v[204:207], v[96:99]
    ds_read_b64_tr_b16 a[176:177], v10 offset:8192
    v_cvt_pk_bf16_f32 v129, v66, v67
    v_mfma_f32_16x16x32_bf16 v[100:103], a[144:147], v[192:195], v[160:163]
    v_exp_f32 v68, v68
    v_mfma_f32_16x16x32_bf16 v[100:103], a[148:151], v[196:199], v[100:103]
    ds_read_b64_tr_b16 a[178:179], v10 offset:12288
    v_add_u32 v2, s49, v2
    v_mfma_f32_16x16x32_bf16 v[100:103], a[152:155], v[200:203], v[100:103]
    v_exp_f32 v69, v69
    v_mfma_f32_16x16x32_bf16 v[100:103], a[156:159], v[204:207], v[100:103]
    ds_read_b64_tr_b16 a[180:181], v11 offset:8192
    v_cvt_pk_bf16_f32 v130, v68, v69
    v_mfma_f32_16x16x32_bf16 v[104:107], a[128:131], v[208:211], v[164:167]
    v_exp_f32 v70, v70
    v_mfma_f32_16x16x32_bf16 v[104:107], a[132:135], v[212:215], v[104:107]
    ds_read_b64_tr_b16 a[182:183], v11 offset:12288
    v_add_u32 v3, s49, v3
    v_mfma_f32_16x16x32_bf16 v[104:107], a[136:139], v[216:219], v[104:107]
    v_exp_f32 v71, v71
    v_mfma_f32_16x16x32_bf16 v[104:107], a[140:143], v[220:223], v[104:107]
    ds_read_b64_tr_b16 a[184:185], v12 offset:8192
    v_cvt_pk_bf16_f32 v131, v70, v71
    v_mfma_f32_16x16x32_bf16 v[108:111], a[144:147], v[208:211], v[164:167]
    s_mov_b32 s46, 0
    v_exp_f32 v72, v72
    v_mfma_f32_16x16x32_bf16 v[108:111], a[148:151], v[212:215], v[108:111]
    s_mov_b32 m0, 0
    ds_read_b64_tr_b16 a[186:187], v12 offset:12288
    v_add_u32 v4, s49, v4
    v_mfma_f32_16x16x32_bf16 v[108:111], a[152:155], v[216:219], v[108:111]
    buffer_load_dwordx4 v41, s[28:31], s46 offen offset:0 lds
    buffer_load_dwordx4 v42, s[28:31], s46 offen offset:1024 lds
    v_exp_f32 v73, v73
    v_mfma_f32_16x16x32_bf16 v[108:111], a[156:159], v[220:223], v[108:111]
    ds_read_b64_tr_b16 a[188:189], v13 offset:8192
    buffer_load_dwordx4 v43, s[28:31], s46 offen offset:2048 lds
    v_cvt_pk_bf16_f32 v132, v72, v73
    s_mov_b32 s46, 18432
    s_mov_b32 m0, 3072
    v_mfma_f32_16x16x32_bf16 v[112:115], a[128:131], v[224:227], v[168:171]
    buffer_load_dwordx4 v41, s[28:31], s46 offen offset:0 lds
    v_exp_f32 v74, v74
    v_mfma_f32_16x16x32_bf16 v[112:115], a[132:135], v[228:231], v[112:115]
    ds_read_b64_tr_b16 a[190:191], v13 offset:12288
    buffer_load_dwordx4 v42, s[28:31], s46 offen offset:1024 lds
    v_add_u32 v5, s49, v5
    v_mfma_f32_16x16x32_bf16 v[112:115], a[136:139], v[232:235], v[112:115]
    buffer_load_dwordx4 v43, s[28:31], s46 offen offset:2048 lds
    v_exp_f32 v75, v75
    s_mov_b32 s46, 36864
    s_mov_b32 m0, 6144
    v_mfma_f32_16x16x32_bf16 v[112:115], a[140:143], v[236:239], v[112:115]
    buffer_load_dwordx4 v41, s[28:31], s46 offen offset:0 lds
    v_cvt_pk_bf16_f32 v133, v74, v75
    v_mfma_f32_16x16x32_bf16 v[116:119], a[144:147], v[224:227], v[168:171]
    buffer_load_dwordx4 v42, s[28:31], s46 offen offset:1024 lds
    v_exp_f32 v76, v76
    v_mfma_f32_16x16x32_bf16 v[116:119], a[148:151], v[228:231], v[116:119]
    buffer_load_dwordx4 v43, s[28:31], s46 offen offset:2048 lds
    v_add_u32 v6, s49, v6
    v_add_u32 v7, s49, v7
    s_mov_b32 s46, 55296
    s_mov_b32 m0, 9216
    v_mfma_f32_16x16x32_bf16 v[116:119], a[152:155], v[232:235], v[116:119]
    s_waitcnt lgkmcnt(0)
    s_waitcnt vmcnt(63)
    s_barrier
    buffer_load_dwordx4 v41, s[28:31], s46 offen offset:0 lds
    v_exp_f32 v77, v77
    v_mfma_f32_16x16x32_bf16 v[116:119], a[156:159], v[236:239], v[116:119]
    ds_read_b128 a[128:131], v2 offset:0
    buffer_load_dwordx4 v42, s[28:31], s46 offen offset:1024 lds
    v_cvt_pk_bf16_f32 v134, v76, v77
    v_mfma_f32_16x16x32_bf16 a[0:3], a[160:163], v[144:147], a[0:3]
    buffer_load_dwordx4 v43, s[28:31], s46 offen offset:2048 lds
    v_exp_f32 v78, v78
    s_mov_b32 s46, 73728
    s_mov_b32 m0, 12288
    v_smfmac_f32_16x16x64_bf16 a[192:195], v[20:23], v[144:151], v59
    ds_read_b128 a[132:135], v3 offset:0
    buffer_load_dwordx4 v41, s[28:31], s46 offen offset:0 lds
    v_add_u32 v8, s49, v8
    v_add_u32 v9, s49, v9
    v_mfma_f32_16x16x32_bf16 a[32:35], a[160:163], v[148:151], a[32:35]
    buffer_load_dwordx4 v42, s[28:31], s46 offen offset:1024 lds
    v_exp_f32 v79, v79
    v_smfmac_f32_16x16x64_bf16 a[196:199], v[20:23], v[148:155], v59
    ds_read_b128 a[136:139], v4 offset:0
    buffer_load_dwordx4 v43, s[28:31], s46 offen offset:2048 lds
    v_cvt_pk_bf16_f32 v135, v78, v79
    s_mov_b32 s46, 92160
    s_mov_b32 m0, 15360
    v_mfma_f32_16x16x32_bf16 a[64:67], a[160:163], v[152:155], a[64:67]
    buffer_load_dwordx4 v41, s[28:31], s46 offen offset:0 lds
    v_exp_f32 v80, v80
    v_mfma_f32_16x16x32_bf16 a[4:7], a[164:167], v[144:147], a[4:7]
    ds_read_b128 a[140:143], v5 offset:0
    buffer_load_dwordx4 v42, s[28:31], s46 offen offset:1024 lds
    v_add_u32 v10, s49, v10
    v_add_u32 v11, s49, v11
    v_mfma_f32_16x16x32_bf16 a[36:39], a[164:167], v[148:151], a[36:39]
    buffer_load_dwordx4 v43, s[28:31], s46 offen offset:2048 lds
    v_exp_f32 v81, v81
    s_mov_b32 s46, 110592
    s_mov_b32 m0, 18432
    v_mfma_f32_16x16x32_bf16 a[68:71], a[164:167], v[152:155], a[68:71]
    ds_read_b128 a[144:147], v2 offset:4096
    buffer_load_dwordx4 v41, s[28:31], s46 offen offset:0 lds
    v_cvt_pk_bf16_f32 v136, v80, v81
    v_mfma_f32_16x16x32_bf16 a[8:11], a[168:171], v[144:147], a[8:11]
    buffer_load_dwordx4 v42, s[28:31], s46 offen offset:1024 lds
    v_exp_f32 v82, v82
    v_mfma_f32_16x16x32_bf16 a[40:43], a[168:171], v[148:151], a[40:43]
    ds_read_b128 a[148:151], v3 offset:4096
    buffer_load_dwordx4 v43, s[28:31], s46 offen offset:2048 lds
    v_add_u32 v12, s49, v12
    s_mov_b32 s46, 129024
    s_mov_b32 m0, 21504
    v_mfma_f32_16x16x32_bf16 a[72:75], a[168:171], v[152:155], a[72:75]
    buffer_load_dwordx4 v41, s[28:31], s46 offen offset:0 lds
    v_exp_f32 v83, v83
    v_mfma_f32_16x16x32_bf16 a[12:15], a[172:175], v[144:147], a[12:15]
    ds_read_b128 a[152:155], v4 offset:4096
    buffer_load_dwordx4 v42, s[28:31], s46 offen offset:1024 lds
    v_cvt_pk_bf16_f32 v137, v82, v83
    v_mfma_f32_16x16x32_bf16 a[44:47], a[172:175], v[148:151], a[44:47]
    buffer_load_dwordx4 v43, s[28:31], s46 offen offset:2048 lds
    v_exp_f32 v84, v84
    s_mov_b32 s46, 147456
    s_mov_b32 m0, 24576
    v_mfma_f32_16x16x32_bf16 a[76:79], a[172:175], v[152:155], a[76:79]
    ds_read_b128 a[156:159], v5 offset:4096
    buffer_load_dwordx4 v41, s[28:31], s46 offen offset:0 lds
    v_add_u32 v13, s49, v13
    v_mfma_f32_16x16x32_bf16 a[16:19], a[176:179], v[144:147], a[16:19]
    buffer_load_dwordx4 v42, s[28:31], s46 offen offset:1024 lds
    v_exp_f32 v85, v85
    v_mfma_f32_16x16x32_bf16 a[48:51], a[176:179], v[148:151], a[48:51]
    ds_read_b64_tr_b16 a[160:161], v6 offset:0
    buffer_load_dwordx4 v43, s[28:31], s46 offen offset:2048 lds
    v_cvt_pk_bf16_f32 v138, v84, v85
    s_mov_b32 s46, 165888
    s_mov_b32 m0, 27648
    v_mfma_f32_16x16x32_bf16 a[80:83], a[176:179], v[152:155], a[80:83]
    buffer_load_dwordx4 v41, s[28:31], s46 offen offset:0 lds
    v_exp_f32 v86, v86
    v_mfma_f32_16x16x32_bf16 a[20:23], a[180:183], v[144:147], a[20:23]
    ds_read_b64_tr_b16 a[162:163], v6 offset:4096
    buffer_load_dwordx4 v42, s[28:31], s46 offen offset:1024 lds
    v_mfma_f32_16x16x32_bf16 a[52:55], a[180:183], v[148:151], a[52:55]
    buffer_load_dwordx4 v43, s[28:31], s46 offen offset:2048 lds
    v_exp_f32 v87, v87
    s_mov_b32 s46, 479232
    s_mov_b32 m0, 67584
    v_mfma_f32_16x16x32_bf16 a[84:87], a[180:183], v[152:155], a[84:87]
    ds_read_b64_tr_b16 a[164:165], v7 offset:0
    buffer_load_dwordx4 v41, s[28:31], s46 offen offset:0 lds
    v_cvt_pk_bf16_f32 v139, v86, v87
    v_mfma_f32_16x16x32_bf16 a[24:27], a[184:187], v[144:147], a[24:27]
    ds_read_b64_tr_b16 a[166:167], v7 offset:4096
    buffer_load_dwordx4 v42, s[28:31], s46 offen offset:1024 lds
    v_mfma_f32_16x16x32_bf16 a[56:59], a[184:187], v[148:151], a[56:59]
    ds_read_b64_tr_b16 a[168:169], v8 offset:0
    buffer_load_dwordx4 v43, s[28:31], s46 offen offset:2048 lds
    s_mov_b32 s46, 497664
    s_mov_b32 m0, 70656
    v_mfma_f32_16x16x32_bf16 a[88:91], a[184:187], v[152:155], a[88:91]
    buffer_load_dwordx4 v41, s[28:31], s46 offen offset:0 lds
    v_exp_f32 v96, v96
    v_mfma_f32_16x16x32_bf16 a[28:31], a[188:191], v[144:147], a[28:31]
    ds_read_b64_tr_b16 a[170:171], v8 offset:4096
    buffer_load_dwordx4 v42, s[28:31], s46 offen offset:1024 lds
    v_mfma_f32_16x16x32_bf16 a[60:63], a[188:191], v[148:151], a[60:63]
    buffer_load_dwordx4 v43, s[28:31], s46 offen offset:2048 lds
    v_exp_f32 v97, v97
    s_mov_b32 s46, 589824
    s_mov_b32 m0, 73728
    v_mfma_f32_16x16x32_bf16 a[92:95], a[188:191], v[152:155], a[92:95]
    s_waitcnt lgkmcnt(6)
    ds_read_b64_tr_b16 a[172:173], v9 offset:0
    buffer_load_dwordx4 v41, s[28:31], s46 offen offset:0 lds
    v_cvt_pk_bf16_f32 v144, v96, v97
    v_mfma_f32_16x16x32_bf16 v[64:67], a[128:131], v[192:195], v[160:163]
    buffer_load_dwordx4 v42, s[28:31], s46 offen offset:1024 lds
    v_exp_f32 v98, v98
    v_mfma_f32_16x16x32_bf16 v[64:67], a[132:135], v[196:199], v[64:67]
    ds_read_b64_tr_b16 a[174:175], v9 offset:4096
    buffer_load_dwordx4 v43, s[28:31], s46 offen offset:2048 lds
    s_mov_b32 s46, 608256
    s_mov_b32 m0, 76800
    v_mfma_f32_16x16x32_bf16 v[64:67], a[136:139], v[200:203], v[64:67]
    buffer_load_dwordx4 v41, s[28:31], s46 offen offset:0 lds
    v_exp_f32 v99, v99
    v_mfma_f32_16x16x32_bf16 v[64:67], a[140:143], v[204:207], v[64:67]
    ds_read_b64_tr_b16 a[176:177], v10 offset:0
    buffer_load_dwordx4 v42, s[28:31], s46 offen offset:1024 lds
    v_cvt_pk_bf16_f32 v145, v98, v99
    v_mfma_f32_16x16x32_bf16 v[68:71], a[144:147], v[192:195], v[160:163]
    buffer_load_dwordx4 v43, s[28:31], s46 offen offset:2048 lds
    v_exp_f32 v100, v100
    s_mov_b32 s46, 626688
    s_mov_b32 m0, 79872
    v_mfma_f32_16x16x32_bf16 v[68:71], a[148:151], v[196:199], v[68:71]
    ds_read_b64_tr_b16 a[178:179], v10 offset:4096
    buffer_load_dwordx4 v41, s[28:31], s46 offen offset:0 lds
    v_mfma_f32_16x16x32_bf16 v[68:71], a[152:155], v[200:203], v[68:71]
    buffer_load_dwordx4 v42, s[28:31], s46 offen offset:1024 lds
    v_exp_f32 v101, v101
    v_mfma_f32_16x16x32_bf16 v[68:71], a[156:159], v[204:207], v[68:71]
    ds_read_b64_tr_b16 a[180:181], v11 offset:0
    buffer_load_dwordx4 v43, s[28:31], s46 offen offset:2048 lds
    v_cvt_pk_bf16_f32 v146, v100, v101
    s_mov_b32 s46, 645120
    s_mov_b32 m0, 82944
    v_mfma_f32_16x16x32_bf16 v[72:75], a[128:131], v[208:211], v[164:167]
    buffer_load_dwordx4 v41, s[28:31], s46 offen offset:0 lds
    v_exp_f32 v102, v102
    v_mfma_f32_16x16x32_bf16 v[72:75], a[132:135], v[212:215], v[72:75]
    ds_read_b64_tr_b16 a[182:183], v11 offset:4096
    buffer_load_dwordx4 v42, s[28:31], s46 offen offset:1024 lds
    v_mfma_f32_16x16x32_bf16 v[72:75], a[136:139], v[216:219], v[72:75]
    buffer_load_dwordx4 v43, s[28:31], s46 offen offset:2048 lds
    v_exp_f32 v103, v103
    s_mov_b32 s46, 663552
    s_mov_b32 m0, 86016
    v_mfma_f32_16x16x32_bf16 v[72:75], a[140:143], v[220:223], v[72:75]
    ds_read_b64_tr_b16 a[184:185], v12 offset:0
    buffer_load_dwordx4 v41, s[28:31], s46 offen offset:0 lds
    v_cvt_pk_bf16_f32 v147, v102, v103
    v_mfma_f32_16x16x32_bf16 v[76:79], a[144:147], v[208:211], v[164:167]
    buffer_load_dwordx4 v42, s[28:31], s46 offen offset:1024 lds
    v_exp_f32 v104, v104
    v_mfma_f32_16x16x32_bf16 v[76:79], a[148:151], v[212:215], v[76:79]
    ds_read_b64_tr_b16 a[186:187], v12 offset:4096
    buffer_load_dwordx4 v43, s[28:31], s46 offen offset:2048 lds
    s_mov_b32 s46, 681984
    s_mov_b32 m0, 89088
    v_mfma_f32_16x16x32_bf16 v[76:79], a[152:155], v[216:219], v[76:79]
    buffer_load_dwordx4 v41, s[28:31], s46 offen offset:0 lds
    v_exp_f32 v105, v105
    v_mfma_f32_16x16x32_bf16 v[76:79], a[156:159], v[220:223], v[76:79]
    ds_read_b64_tr_b16 a[188:189], v13 offset:0
    buffer_load_dwordx4 v42, s[28:31], s46 offen offset:1024 lds
    v_cvt_pk_bf16_f32 v148, v104, v105
    v_mfma_f32_16x16x32_bf16 v[80:83], a[128:131], v[224:227], v[168:171]
    buffer_load_dwordx4 v43, s[28:31], s46 offen offset:2048 lds
    v_exp_f32 v106, v106
    s_mov_b32 s46, 700416
    s_mov_b32 m0, 92160
    v_mfma_f32_16x16x32_bf16 v[80:83], a[132:135], v[228:231], v[80:83]
    ds_read_b64_tr_b16 a[190:191], v13 offset:4096
    buffer_load_dwordx4 v41, s[28:31], s46 offen offset:0 lds
    v_mfma_f32_16x16x32_bf16 v[80:83], a[136:139], v[232:235], v[80:83]
    buffer_load_dwordx4 v42, s[28:31], s46 offen offset:1024 lds
    v_exp_f32 v107, v107
    v_mfma_f32_16x16x32_bf16 v[80:83], a[140:143], v[236:239], v[80:83]
    buffer_load_dwordx4 v43, s[28:31], s46 offen offset:2048 lds
    v_cvt_pk_bf16_f32 v149, v106, v107
    s_mov_b32 s46, 718848
    s_mov_b32 m0, 95232
    v_mfma_f32_16x16x32_bf16 v[84:87], a[144:147], v[224:227], v[168:171]
    buffer_load_dwordx4 v41, s[28:31], s46 offen offset:0 lds
    v_exp_f32 v108, v108
    v_mfma_f32_16x16x32_bf16 v[84:87], a[148:151], v[228:231], v[84:87]
    buffer_load_dwordx4 v42, s[28:31], s46 offen offset:1024 lds
    v_mfma_f32_16x16x32_bf16 v[84:87], a[152:155], v[232:235], v[84:87]
    s_waitcnt lgkmcnt(0)
    buffer_load_dwordx4 v43, s[28:31], s46 offen offset:2048 lds
    v_exp_f32 v109, v109
    s_mov_b32 s46, 737280
    s_mov_b32 m0, 98304
    v_mfma_f32_16x16x32_bf16 v[84:87], a[156:159], v[236:239], v[84:87]
    ds_read_b128 a[128:131], v2 offset:8192
    buffer_load_dwordx4 v41, s[28:31], s46 offen offset:0 lds
    v_cvt_pk_bf16_f32 v150, v108, v109
    v_mfma_f32_16x16x32_bf16 a[0:3], a[160:163], v[128:131], a[0:3]
    buffer_load_dwordx4 v42, s[28:31], s46 offen offset:1024 lds
    v_exp_f32 v110, v110
    v_smfmac_f32_16x16x64_bf16 a[192:195], v[20:23], v[128:135], v59
    ds_read_b128 a[132:135], v3 offset:8192
    buffer_load_dwordx4 v43, s[28:31], s46 offen offset:2048 lds
    s_mov_b32 s46, 755712
    s_mov_b32 m0, 101376
    v_mfma_f32_16x16x32_bf16 a[32:35], a[160:163], v[132:135], a[32:35]
    buffer_load_dwordx4 v41, s[28:31], s46 offen offset:0 lds
    v_exp_f32 v111, v111
    v_smfmac_f32_16x16x64_bf16 a[196:199], v[20:23], v[132:139], v59
    ds_read_b128 a[136:139], v4 offset:8192
    buffer_load_dwordx4 v42, s[28:31], s46 offen offset:1024 lds
    v_cvt_pk_bf16_f32 v151, v110, v111
    v_mfma_f32_16x16x32_bf16 a[64:67], a[160:163], v[136:139], a[64:67]
    buffer_load_dwordx4 v43, s[28:31], s46 offen offset:2048 lds
    v_exp_f32 v112, v112
    s_mov_b32 s46, 774144
    s_mov_b32 m0, 104448
    v_mfma_f32_16x16x32_bf16 a[4:7], a[164:167], v[128:131], a[4:7]
    ds_read_b128 a[140:143], v5 offset:8192
    buffer_load_dwordx4 v41, s[28:31], s46 offen offset:0 lds
    v_mfma_f32_16x16x32_bf16 a[36:39], a[164:167], v[132:135], a[36:39]
    buffer_load_dwordx4 v42, s[28:31], s46 offen offset:1024 lds
    v_exp_f32 v113, v113
    v_mfma_f32_16x16x32_bf16 a[68:71], a[164:167], v[136:139], a[68:71]
    ds_read_b128 a[144:147], v2 offset:12288
    buffer_load_dwordx4 v43, s[28:31], s46 offen offset:2048 lds
    v_cvt_pk_bf16_f32 v152, v112, v113
    s_mov_b32 s46, 792576
    s_mov_b32 m0, 107520
    v_mfma_f32_16x16x32_bf16 a[8:11], a[168:171], v[128:131], a[8:11]
    buffer_load_dwordx4 v41, s[28:31], s46 offen offset:0 lds
    v_exp_f32 v114, v114
    v_mfma_f32_16x16x32_bf16 a[40:43], a[168:171], v[132:135], a[40:43]
    ds_read_b128 a[148:151], v3 offset:12288
    buffer_load_dwordx4 v42, s[28:31], s46 offen offset:1024 lds
    v_mfma_f32_16x16x32_bf16 a[72:75], a[168:171], v[136:139], a[72:75]
    buffer_load_dwordx4 v43, s[28:31], s46 offen offset:2048 lds
    v_exp_f32 v115, v115
    s_mov_b32 s46, 884736
    s_mov_b32 m0, 110592
    v_mfma_f32_16x16x32_bf16 a[12:15], a[172:175], v[128:131], a[12:15]
    ds_read_b128 a[152:155], v4 offset:12288
    buffer_load_dwordx4 v41, s[28:31], s46 offen offset:0 lds
    v_cvt_pk_bf16_f32 v153, v114, v115
    v_mfma_f32_16x16x32_bf16 a[44:47], a[172:175], v[132:135], a[44:47]
    buffer_load_dwordx4 v42, s[28:31], s46 offen offset:1024 lds
    v_exp_f32 v116, v116
    v_mfma_f32_16x16x32_bf16 a[76:79], a[172:175], v[136:139], a[76:79]
    ds_read_b128 a[156:159], v5 offset:12288
    buffer_load_dwordx4 v43, s[28:31], s46 offen offset:2048 lds
    s_mov_b32 s46, 184320
    s_mov_b32 m0, 30720
    v_mfma_f32_16x16x32_bf16 a[16:19], a[176:179], v[128:131], a[16:19]
    buffer_load_dwordx4 v41, s[28:31], s46 offen offset:0 lds
    v_exp_f32 v117, v117
    v_mfma_f32_16x16x32_bf16 a[48:51], a[176:179], v[132:135], a[48:51]
    ds_read_b64_tr_b16 a[160:161], v6 offset:8192
    buffer_load_dwordx4 v42, s[28:31], s46 offen offset:1024 lds
    v_cvt_pk_bf16_f32 v154, v116, v117
    v_mfma_f32_16x16x32_bf16 a[80:83], a[176:179], v[136:139], a[80:83]
    buffer_load_dwordx4 v43, s[28:31], s46 offen offset:2048 lds
    v_exp_f32 v118, v118
    s_mov_b32 s46, 202752
    s_mov_b32 m0, 33792
    v_mfma_f32_16x16x32_bf16 a[20:23], a[180:183], v[128:131], a[20:23]
    ds_read_b64_tr_b16 a[162:163], v6 offset:12288
    buffer_load_dwordx4 v41, s[28:31], s46 offen offset:0 lds
    v_mfma_f32_16x16x32_bf16 a[52:55], a[180:183], v[132:135], a[52:55]
    buffer_load_dwordx4 v42, s[28:31], s46 offen offset:1024 lds
    v_exp_f32 v119, v119
    v_mfma_f32_16x16x32_bf16 a[84:87], a[180:183], v[136:139], a[84:87]
    ds_read_b64_tr_b16 a[164:165], v7 offset:8192
    buffer_load_dwordx4 v43, s[28:31], s46 offen offset:2048 lds
    v_cvt_pk_bf16_f32 v155, v118, v119
    s_mov_b32 s46, 294912
    s_mov_b32 m0, 36864
    v_mfma_f32_16x16x32_bf16 a[24:27], a[184:187], v[128:131], a[24:27]
    ds_read_b64_tr_b16 a[166:167], v7 offset:12288
    buffer_load_dwordx4 v41, s[28:31], s46 offen offset:0 lds
    v_mfma_f32_16x16x32_bf16 a[56:59], a[184:187], v[132:135], a[56:59]
    ds_read_b64_tr_b16 a[168:169], v8 offset:8192
    buffer_load_dwordx4 v42, s[28:31], s46 offen offset:1024 lds
    v_mfma_f32_16x16x32_bf16 a[88:91], a[184:187], v[136:139], a[88:91]
    buffer_load_dwordx4 v43, s[28:31], s46 offen offset:2048 lds
    v_exp_f32 v64, v64
    s_mov_b32 s46, 313344
    s_mov_b32 m0, 39936
    v_mfma_f32_16x16x32_bf16 a[28:31], a[188:191], v[128:131], a[28:31]
    ds_read_b64_tr_b16 a[170:171], v8 offset:12288
    buffer_load_dwordx4 v41, s[28:31], s46 offen offset:0 lds
    v_mfma_f32_16x16x32_bf16 a[60:63], a[188:191], v[132:135], a[60:63]
    buffer_load_dwordx4 v42, s[28:31], s46 offen offset:1024 lds
    v_exp_f32 v65, v65
    v_mfma_f32_16x16x32_bf16 a[92:95], a[188:191], v[136:139], a[92:95]
    s_waitcnt lgkmcnt(6)
    ds_read_b64_tr_b16 a[172:173], v9 offset:8192
    buffer_load_dwordx4 v43, s[28:31], s46 offen offset:2048 lds
    v_cvt_pk_bf16_f32 v128, v64, v65
    s_mov_b32 s46, 331776
    s_mov_b32 m0, 43008
    v_mfma_f32_16x16x32_bf16 v[96:99], a[128:131], v[192:195], v[160:163]
    s_cmp_eq_u32 s48, 65536
    s_cselect_b32 s49, s50, 16384
    buffer_load_dwordx4 v41, s[28:31], s46 offen offset:0 lds
    v_exp_f32 v66, v66
    v_mfma_f32_16x16x32_bf16 v[96:99], a[132:135], v[196:199], v[96:99]
    s_add_u32 s48, s48, s49
    ds_read_b64_tr_b16 a[174:175], v9 offset:12288
    buffer_load_dwordx4 v42, s[28:31], s46 offen offset:1024 lds
    v_mfma_f32_16x16x32_bf16 v[96:99], a[136:139], v[200:203], v[96:99]
    buffer_load_dwordx4 v43, s[28:31], s46 offen offset:2048 lds
    v_exp_f32 v67, v67
    s_mov_b32 s46, 350208
    s_mov_b32 m0, 46080
    v_mfma_f32_16x16x32_bf16 v[96:99], a[140:143], v[204:207], v[96:99]
    ds_read_b64_tr_b16 a[176:177], v10 offset:8192
    buffer_load_dwordx4 v41, s[28:31], s46 offen offset:0 lds
    v_cvt_pk_bf16_f32 v129, v66, v67
    v_mfma_f32_16x16x32_bf16 v[100:103], a[144:147], v[192:195], v[160:163]
    buffer_load_dwordx4 v42, s[28:31], s46 offen offset:1024 lds
    v_exp_f32 v68, v68
    v_mfma_f32_16x16x32_bf16 v[100:103], a[148:151], v[196:199], v[100:103]
    ds_read_b64_tr_b16 a[178:179], v10 offset:12288
    buffer_load_dwordx4 v43, s[28:31], s46 offen offset:2048 lds
    v_add_u32 v2, s49, v2
    s_mov_b32 s46, 903168
    s_mov_b32 m0, 113664
    v_mfma_f32_16x16x32_bf16 v[100:103], a[152:155], v[200:203], v[100:103]
    buffer_load_dwordx4 v41, s[28:31], s46 offen offset:0 lds
    v_exp_f32 v69, v69
    v_mfma_f32_16x16x32_bf16 v[100:103], a[156:159], v[204:207], v[100:103]
    ds_read_b64_tr_b16 a[180:181], v11 offset:8192
    buffer_load_dwordx4 v42, s[28:31], s46 offen offset:1024 lds
    v_cvt_pk_bf16_f32 v130, v68, v69
    v_mfma_f32_16x16x32_bf16 v[104:107], a[128:131], v[208:211], v[164:167]
    buffer_load_dwordx4 v43, s[28:31], s46 offen offset:2048 lds
    v_exp_f32 v70, v70
    s_mov_b32 s46, 921600
    s_mov_b32 m0, 116736
    v_mfma_f32_16x16x32_bf16 v[104:107], a[132:135], v[212:215], v[104:107]
    ds_read_b64_tr_b16 a[182:183], v11 offset:12288
    buffer_load_dwordx4 v41, s[28:31], s46 offen offset:0 lds
    v_add_u32 v3, s49, v3
    v_mfma_f32_16x16x32_bf16 v[104:107], a[136:139], v[216:219], v[104:107]
    buffer_load_dwordx4 v42, s[28:31], s46 offen offset:1024 lds
    v_exp_f32 v71, v71
    v_mfma_f32_16x16x32_bf16 v[104:107], a[140:143], v[220:223], v[104:107]
    ds_read_b64_tr_b16 a[184:185], v12 offset:8192
    buffer_load_dwordx4 v43, s[28:31], s46 offen offset:2048 lds
    v_cvt_pk_bf16_f32 v131, v70, v71
    s_mov_b32 s46, 940032
    s_mov_b32 m0, 119808
    v_mfma_f32_16x16x32_bf16 v[108:111], a[144:147], v[208:211], v[164:167]
    buffer_load_dwordx4 v41, s[28:31], s46 offen offset:0 lds
    v_exp_f32 v72, v72
    v_mfma_f32_16x16x32_bf16 v[108:111], a[148:151], v[212:215], v[108:111]
    ds_read_b64_tr_b16 a[186:187], v12 offset:12288
    buffer_load_dwordx4 v42, s[28:31], s46 offen offset:1024 lds
    v_add_u32 v4, s49, v4
    v_mfma_f32_16x16x32_bf16 v[108:111], a[152:155], v[216:219], v[108:111]
    buffer_load_dwordx4 v43, s[28:31], s46 offen offset:2048 lds
    v_exp_f32 v73, v73
    s_mov_b32 s46, 958464
    s_mov_b32 m0, 122880
    v_mfma_f32_16x16x32_bf16 v[108:111], a[156:159], v[220:223], v[108:111]
    ds_read_b64_tr_b16 a[188:189], v13 offset:8192
    buffer_load_dwordx4 v41, s[28:31], s46 offen offset:0 lds
    v_cvt_pk_bf16_f32 v132, v72, v73
    v_mfma_f32_16x16x32_bf16 v[112:115], a[128:131], v[224:227], v[168:171]
    buffer_load_dwordx4 v42, s[28:31], s46 offen offset:1024 lds
    v_exp_f32 v74, v74
    v_mfma_f32_16x16x32_bf16 v[112:115], a[132:135], v[228:231], v[112:115]
    ds_read_b64_tr_b16 a[190:191], v13 offset:12288
    buffer_load_dwordx4 v43, s[28:31], s46 offen offset:2048 lds
    v_add_u32 v5, s49, v5
    s_mov_b32 s46, 976896
    s_mov_b32 m0, 125952
    v_mfma_f32_16x16x32_bf16 v[112:115], a[136:139], v[232:235], v[112:115]
    buffer_load_dwordx4 v41, s[28:31], s46 offen offset:0 lds
    v_exp_f32 v75, v75
    v_mfma_f32_16x16x32_bf16 v[112:115], a[140:143], v[236:239], v[112:115]
    buffer_load_dwordx4 v42, s[28:31], s46 offen offset:1024 lds
    v_cvt_pk_bf16_f32 v133, v74, v75
    v_mfma_f32_16x16x32_bf16 v[116:119], a[144:147], v[224:227], v[168:171]
    buffer_load_dwordx4 v43, s[28:31], s46 offen offset:2048 lds
    v_exp_f32 v76, v76
    v_mfma_f32_16x16x32_bf16 v[116:119], a[148:151], v[228:231], v[116:119]
    v_add_u32 v6, s49, v6
    v_add_u32 v7, s49, v7
    v_mfma_f32_16x16x32_bf16 v[116:119], a[152:155], v[232:235], v[116:119]
    s_waitcnt lgkmcnt(0)
    s_waitcnt vmcnt(63)
    s_barrier
    s_mov_b32 s46, 368640
    v_exp_f32 v77, v77
    v_mfma_f32_16x16x32_bf16 v[116:119], a[156:159], v[236:239], v[116:119]
    s_mov_b32 m0, 49152
    ds_read_b128 a[128:131], v2 offset:0
    v_cvt_pk_bf16_f32 v134, v76, v77
    v_mfma_f32_16x16x32_bf16 a[0:3], a[160:163], v[144:147], a[0:3]
    buffer_load_dwordx4 v41, s[28:31], s46 offen offset:0 lds
    buffer_load_dwordx4 v42, s[28:31], s46 offen offset:1024 lds
    v_exp_f32 v78, v78
    v_smfmac_f32_16x16x64_bf16 a[192:195], v[20:23], v[144:151], v59
    ds_read_b128 a[132:135], v3 offset:0
    buffer_load_dwordx4 v43, s[28:31], s46 offen offset:2048 lds
    v_add_u32 v8, s49, v8
    v_add_u32 v9, s49, v9
    s_mov_b32 s46, 387072
    s_mov_b32 m0, 52224
    v_mfma_f32_16x16x32_bf16 a[32:35], a[160:163], v[148:151], a[32:35]
    buffer_load_dwordx4 v41, s[28:31], s46 offen offset:0 lds
    buffer_load_dwordx4 v42, s[28:31], s46 offen offset:1024 lds
    v_exp_f32 v79, v79
    v_smfmac_f32_16x16x64_bf16 a[196:199], v[20:23], v[148:155], v59
    ds_read_b128 a[136:139], v4 offset:0
    buffer_load_dwordx4 v43, s[28:31], s46 offen offset:2048 lds
    v_cvt_pk_bf16_f32 v135, v78, v79
    s_mov_b32 s46, 405504
    s_mov_b32 m0, 55296
    v_mfma_f32_16x16x32_bf16 a[64:67], a[160:163], v[152:155], a[64:67]
    buffer_load_dwordx4 v41, s[28:31], s46 offen offset:0 lds
    buffer_load_dwordx4 v42, s[28:31], s46 offen offset:1024 lds
    v_exp_f32 v80, v80
    v_mfma_f32_16x16x32_bf16 a[4:7], a[164:167], v[144:147], a[4:7]
    ds_read_b128 a[140:143], v5 offset:0
    buffer_load_dwordx4 v43, s[28:31], s46 offen offset:2048 lds
    v_add_u32 v10, s49, v10
    v_add_u32 v11, s49, v11
    s_mov_b32 s46, 423936
    s_mov_b32 m0, 58368
    v_mfma_f32_16x16x32_bf16 a[36:39], a[164:167], v[148:151], a[36:39]
    buffer_load_dwordx4 v41, s[28:31], s46 offen offset:0 lds
    buffer_load_dwordx4 v42, s[28:31], s46 offen offset:1024 lds
    v_exp_f32 v81, v81
    v_mfma_f32_16x16x32_bf16 a[68:71], a[164:167], v[152:155], a[68:71]
    ds_read_b128 a[144:147], v2 offset:4096
    buffer_load_dwordx4 v43, s[28:31], s46 offen offset:2048 lds
    v_cvt_pk_bf16_f32 v136, v80, v81
    s_mov_b32 s46, 442368
    s_mov_b32 m0, 61440
    v_mfma_f32_16x16x32_bf16 a[8:11], a[168:171], v[144:147], a[8:11]
    buffer_load_dwordx4 v41, s[28:31], s46 offen offset:0 lds
    v_exp_f32 v82, v82
    v_mfma_f32_16x16x32_bf16 a[40:43], a[168:171], v[148:151], a[40:43]
    ds_read_b128 a[148:151], v3 offset:4096
    buffer_load_dwordx4 v42, s[28:31], s46 offen offset:1024 lds
    buffer_load_dwordx4 v43, s[28:31], s46 offen offset:2048 lds
    v_add_u32 v12, s49, v12
    s_mov_b32 s46, 460800
    s_mov_b32 m0, 64512
    v_mfma_f32_16x16x32_bf16 a[72:75], a[168:171], v[152:155], a[72:75]
    buffer_load_dwordx4 v41, s[28:31], s46 offen offset:0 lds
    v_exp_f32 v83, v83
    v_mfma_f32_16x16x32_bf16 a[12:15], a[172:175], v[144:147], a[12:15]
    ds_read_b128 a[152:155], v4 offset:4096
    buffer_load_dwordx4 v42, s[28:31], s46 offen offset:1024 lds
    buffer_load_dwordx4 v43, s[28:31], s46 offen offset:2048 lds
    v_cvt_pk_bf16_f32 v137, v82, v83
    s_mov_b32 s46, 995328
    s_mov_b32 m0, 129024
    v_mfma_f32_16x16x32_bf16 a[44:47], a[172:175], v[148:151], a[44:47]
    buffer_load_dwordx4 v41, s[28:31], s46 offen offset:0 lds
    v_exp_f32 v84, v84
    v_mfma_f32_16x16x32_bf16 a[76:79], a[172:175], v[152:155], a[76:79]
    ds_read_b128 a[156:159], v5 offset:4096
    buffer_load_dwordx4 v42, s[28:31], s46 offen offset:1024 lds
    buffer_load_dwordx4 v43, s[28:31], s46 offen offset:2048 lds
    v_add_u32 v13, s49, v13
    s_mov_b32 s46, 1013760
    s_mov_b32 m0, 132096
    v_mfma_f32_16x16x32_bf16 a[16:19], a[176:179], v[144:147], a[16:19]
    buffer_load_dwordx4 v41, s[28:31], s46 offen offset:0 lds
    v_exp_f32 v85, v85
    v_mfma_f32_16x16x32_bf16 a[48:51], a[176:179], v[148:151], a[48:51]
    ds_read_b64_tr_b16 a[160:161], v6 offset:0
    buffer_load_dwordx4 v42, s[28:31], s46 offen offset:1024 lds
    buffer_load_dwordx4 v43, s[28:31], s46 offen offset:2048 lds
    v_cvt_pk_bf16_f32 v138, v84, v85
    s_mov_b32 s46, 1032192
    s_mov_b32 m0, 135168
    v_mfma_f32_16x16x32_bf16 a[80:83], a[176:179], v[152:155], a[80:83]
    buffer_load_dwordx4 v41, s[28:31], s46 offen offset:0 lds
    v_exp_f32 v86, v86
    v_mfma_f32_16x16x32_bf16 a[20:23], a[180:183], v[144:147], a[20:23]
    ds_read_b64_tr_b16 a[162:163], v6 offset:4096
    buffer_load_dwordx4 v42, s[28:31], s46 offen offset:1024 lds
    v_mfma_f32_16x16x32_bf16 a[52:55], a[180:183], v[148:151], a[52:55]
    buffer_load_dwordx4 v43, s[28:31], s46 offen offset:2048 lds
    s_mov_b32 s46, 1050624
    s_mov_b32 m0, 138240
    s_nop 0
    buffer_load_dwordx4 v41, s[28:31], s46 offen offset:0 lds
    v_exp_f32 v87, v87
    v_mfma_f32_16x16x32_bf16 a[84:87], a[180:183], v[152:155], a[84:87]
    ds_read_b64_tr_b16 a[164:165], v7 offset:0
    buffer_load_dwordx4 v42, s[28:31], s46 offen offset:1024 lds
    v_cvt_pk_bf16_f32 v139, v86, v87
    v_mfma_f32_16x16x32_bf16 a[24:27], a[184:187], v[144:147], a[24:27]
    ds_read_b64_tr_b16 a[166:167], v7 offset:4096
    buffer_load_dwordx4 v43, s[28:31], s46 offen offset:2048 lds
    s_mov_b32 s46, 1069056
    s_mov_b32 m0, 141312
    s_nop 0
    buffer_load_dwordx4 v41, s[28:31], s46 offen offset:0 lds
    v_mfma_f32_16x16x32_bf16 a[56:59], a[184:187], v[148:151], a[56:59]
    ds_read_b64_tr_b16 a[168:169], v8 offset:0
    buffer_load_dwordx4 v42, s[28:31], s46 offen offset:1024 lds
    v_mfma_f32_16x16x32_bf16 a[88:91], a[184:187], v[152:155], a[88:91]
    buffer_load_dwordx4 v43, s[28:31], s46 offen offset:2048 lds
    s_mov_b32 s46, 1087488
    s_mov_b32 m0, 144384
    s_nop 0
    buffer_load_dwordx4 v41, s[28:31], s46 offen offset:0 lds
    v_exp_f32 v96, v96
    v_mfma_f32_16x16x32_bf16 a[28:31], a[188:191], v[144:147], a[28:31]
    ds_read_b64_tr_b16 a[170:171], v8 offset:4096
    buffer_load_dwordx4 v42, s[28:31], s46 offen offset:1024 lds
    v_mfma_f32_16x16x32_bf16 a[60:63], a[188:191], v[148:151], a[60:63]
    buffer_load_dwordx4 v43, s[28:31], s46 offen offset:2048 lds
    v_exp_f32 v97, v97
    v_mfma_f32_16x16x32_bf16 a[92:95], a[188:191], v[152:155], a[92:95]
    s_waitcnt lgkmcnt(6)
    ds_read_b64_tr_b16 a[172:173], v9 offset:0
    v_cvt_pk_bf16_f32 v144, v96, v97
    s_mov_b64 s[86:87], 0
    ds_read_b64_tr_b16 a[174:175], v9 offset:4096
    ds_read_b64_tr_b16 a[176:177], v10 offset:0
    ds_read_b64_tr_b16 a[178:179], v10 offset:4096
    ds_read_b64_tr_b16 a[180:181], v11 offset:0
    ds_read_b64_tr_b16 a[182:183], v11 offset:4096
    ds_read_b64_tr_b16 a[184:185], v12 offset:0
    ds_read_b64_tr_b16 a[186:187], v12 offset:4096
    ds_read_b64_tr_b16 a[188:189], v13 offset:0
    ds_read_b64_tr_b16 a[190:191], v13 offset:4096
    ds_read_b64_tr_b16 a[128:129], v6 offset:8192
    ds_read_b64_tr_b16 a[130:131], v6 offset:12288
    ds_read_b64_tr_b16 a[132:133], v7 offset:8192
    ds_read_b64_tr_b16 a[134:135], v7 offset:12288
    ds_read_b64_tr_b16 a[136:137], v8 offset:8192
    ds_read_b64_tr_b16 a[138:139], v8 offset:12288
    ds_read_b64_tr_b16 a[140:141], v9 offset:8192
    ds_read_b64_tr_b16 a[142:143], v9 offset:12288
    v_mov_b32 v28, 0
    v_exp_f32 v98, v98
    v_exp_f32 v99, v99
    v_exp_f32 v100, v100
    v_exp_f32 v101, v101
    s_waitcnt lgkmcnt(8)
    ds_read_b64_tr_b16 a[144:145], v10 offset:8192
    v_exp_f32 v102, v102
    v_mfma_f32_16x16x32_bf16 a[0:3], a[160:163], v[128:131], a[0:3]
    ds_read_b64_tr_b16 a[146:147], v10 offset:12288
    v_exp_f32 v103, v103
    v_smfmac_f32_16x16x64_bf16 a[192:195], v[20:23], v[128:135], v59
    ds_read_b64_tr_b16 a[148:149], v11 offset:8192
    v_cvt_pk_bf16_f32 v145, v98, v99
    v_mfma_f32_16x16x32_bf16 a[4:7], a[164:167], v[128:131], a[4:7]
    ds_read_b64_tr_b16 a[150:151], v11 offset:12288
    v_cvt_pk_bf16_f32 v146, v100, v101
    v_mfma_f32_16x16x32_bf16 a[8:11], a[168:171], v[128:131], a[8:11]
    ds_read_b64_tr_b16 a[152:153], v12 offset:8192
    v_cvt_pk_bf16_f32 v147, v102, v103
    v_mfma_f32_16x16x32_bf16 a[12:15], a[172:175], v[128:131], a[12:15]
    ds_read_b64_tr_b16 a[154:155], v12 offset:12288
    v_exp_f32 v104, v104
    v_mfma_f32_16x16x32_bf16 a[16:19], a[176:179], v[128:131], a[16:19]
    ds_read_b64_tr_b16 a[156:157], v13 offset:8192
    v_exp_f32 v105, v105
    v_mfma_f32_16x16x32_bf16 a[20:23], a[180:183], v[128:131], a[20:23]
    ds_read_b64_tr_b16 a[158:159], v13 offset:12288
    v_exp_f32 v106, v106
    v_mfma_f32_16x16x32_bf16 a[24:27], a[184:187], v[128:131], a[24:27]
    v_exp_f32 v107, v107
    v_mfma_f32_16x16x32_bf16 a[28:31], a[188:191], v[128:131], a[28:31]
    s_waitcnt lgkmcnt(0)
    s_mov_b32 s43, 0x4b800000
    v_exp_f32 v108, v108
    v_mfma_f32_16x16x32_bf16 a[0:3], a[128:131], v[144:147], a[0:3]
    v_exp_f32 v109, v109
    v_mfma_f32_16x16x32_bf16 a[4:7], a[132:135], v[144:147], a[4:7]
    v_exp_f32 v110, v110
    v_mfma_f32_16x16x32_bf16 a[8:11], a[136:139], v[144:147], a[8:11]
    v_exp_f32 v111, v111
    v_mfma_f32_16x16x32_bf16 a[12:15], a[140:143], v[144:147], a[12:15]
    v_cvt_pk_bf16_f32 v148, v104, v105
    v_cvt_pk_bf16_f32 v149, v106, v107
    v_cvt_pk_bf16_f32 v150, v108, v109
    v_cvt_pk_bf16_f32 v151, v110, v111
    s_nop 0
    s_nop 0
    v_smfmac_f32_16x16x64_bf16 a[192:195], v[20:23], v[144:151], v59
    v_mfma_f32_16x16x32_bf16 a[16:19], a[144:147], v[144:147], a[16:19]
    v_mfma_f32_16x16x32_bf16 a[20:23], a[148:151], v[144:147], a[20:23]
    v_mfma_f32_16x16x32_bf16 a[24:27], a[152:155], v[144:147], a[24:27]
    v_mfma_f32_16x16x32_bf16 a[28:31], a[156:159], v[144:147], a[28:31]
    v_mfma_f32_16x16x32_bf16 a[32:35], a[160:163], v[132:135], a[32:35]
    v_mfma_f32_16x16x32_bf16 a[36:39], a[164:167], v[132:135], a[36:39]
    v_mfma_f32_16x16x32_bf16 a[40:43], a[168:171], v[132:135], a[40:43]
    v_mfma_f32_16x16x32_bf16 a[44:47], a[172:175], v[132:135], a[44:47]
    v_accvgpr_read_b32 v24, a192
    v_accvgpr_read_b32 v25, a193
    v_mfma_f32_16x16x32_bf16 a[48:51], a[176:179], v[132:135], a[48:51]
    v_add_f32 v24, v24, v25
    v_cmp_ngt_f32 vcc, s43, v24
    v_mfma_f32_16x16x32_bf16 a[52:55], a[180:183], v[132:135], a[52:55]
    v_rcp_f32 v24, v24
    v_mfma_f32_16x16x32_bf16 a[56:59], a[184:187], v[132:135], a[56:59]
    v_accvgpr_read_b32 v64, a0
    v_accvgpr_read_b32 v65, a1
    v_mfma_f32_16x16x32_bf16 a[60:63], a[188:191], v[132:135], a[60:63]
    v_accvgpr_read_b32 v66, a2
    v_accvgpr_read_b32 v67, a3
    v_mfma_f32_16x16x32_bf16 a[32:35], a[128:131], v[148:151], a[32:35]
    v_accvgpr_read_b32 v68, a4
    v_accvgpr_read_b32 v69, a5
    v_mfma_f32_16x16x32_bf16 a[36:39], a[132:135], v[148:151], a[36:39]
    v_accvgpr_read_b32 v70, a6
    v_accvgpr_read_b32 v71, a7
    v_mfma_f32_16x16x32_bf16 a[40:43], a[136:139], v[148:151], a[40:43]
    s_or_b64 s[86:87], s[86:87], vcc
    v_addc_co_u32 v28, vcc, 0, v28, vcc
    v_mfma_f32_16x16x32_bf16 a[44:47], a[140:143], v[148:151], a[44:47]
    v_mul_f32 v64, v64, v24
    v_mul_f32 v65, v65, v24
    v_mfma_f32_16x16x32_bf16 a[48:51], a[144:147], v[148:151], a[48:51]
    v_mul_f32 v66, v66, v24
    v_mul_f32 v67, v67, v24
    v_mfma_f32_16x16x32_bf16 a[52:55], a[148:151], v[148:151], a[52:55]
    v_mul_f32 v68, v68, v24
    v_mul_f32 v69, v69, v24
    v_mfma_f32_16x16x32_bf16 a[56:59], a[152:155], v[148:151], a[56:59]
    v_mul_f32 v70, v70, v24
    v_mul_f32 v71, v71, v24
    v_mfma_f32_16x16x32_bf16 a[60:63], a[156:159], v[148:151], a[60:63]
    v_cvt_pk_bf16_f32 v160, v64, v65
    v_cvt_pk_bf16_f32 v161, v66, v67
    v_mfma_f32_16x16x32_bf16 a[64:67], a[160:163], v[136:139], a[64:67]
    v_cvt_pk_bf16_f32 v162, v68, v69
    v_cvt_pk_bf16_f32 v163, v70, v71
    v_smfmac_f32_16x16x64_bf16 a[196:199], v[20:23], v[132:139], v59
    buffer_store_dwordx4 v[160:163], v16, s[24:27], s80 offen offset:0 sc1
    v_mfma_f32_16x16x32_bf16 a[68:71], a[164:167], v[136:139], a[68:71]
    v_accvgpr_read_b32 v72, a8
    v_accvgpr_read_b32 v73, a9
    v_mfma_f32_16x16x32_bf16 a[72:75], a[168:171], v[136:139], a[72:75]
    v_accvgpr_read_b32 v74, a10
    v_accvgpr_read_b32 v75, a11
    v_mfma_f32_16x16x32_bf16 a[76:79], a[172:175], v[136:139], a[76:79]
    v_accvgpr_read_b32 v76, a12
    v_accvgpr_read_b32 v77, a13
    v_mfma_f32_16x16x32_bf16 a[80:83], a[176:179], v[136:139], a[80:83]
    v_accvgpr_read_b32 v78, a14
    v_accvgpr_read_b32 v79, a15
    v_mfma_f32_16x16x32_bf16 a[84:87], a[180:183], v[136:139], a[84:87]
    v_mul_f32 v72, v72, v24
    v_mul_f32 v73, v73, v24
    v_mfma_f32_16x16x32_bf16 a[88:91], a[184:187], v[136:139], a[88:91]
    v_mul_f32 v74, v74, v24
    v_mul_f32 v75, v75, v24
    v_mfma_f32_16x16x32_bf16 a[92:95], a[188:191], v[136:139], a[92:95]
    v_mul_f32 v76, v76, v24
    v_mul_f32 v77, v77, v24
    v_mul_f32 v78, v78, v24
    v_mul_f32 v79, v79, v24
    v_cvt_pk_bf16_f32 v164, v72, v73
    v_cvt_pk_bf16_f32 v165, v74, v75
    v_cvt_pk_bf16_f32 v166, v76, v77
    v_cvt_pk_bf16_f32 v167, v78, v79
    buffer_store_dwordx4 v[164:167], v16, s[24:27], s80 offen offset:1024 sc1
    v_accvgpr_read_b32 v80, a16
    v_accvgpr_read_b32 v81, a17
    v_accvgpr_read_b32 v82, a18
    v_accvgpr_read_b32 v83, a19
    v_accvgpr_read_b32 v84, a20
    v_accvgpr_read_b32 v85, a21
    v_accvgpr_read_b32 v86, a22
    v_accvgpr_read_b32 v87, a23
    v_mul_f32 v80, v80, v24
    v_mul_f32 v81, v81, v24
    v_mul_f32 v82, v82, v24
    v_mul_f32 v83, v83, v24
    v_mul_f32 v84, v84, v24
    v_mul_f32 v85, v85, v24
    v_mul_f32 v86, v86, v24
    v_mul_f32 v87, v87, v24
    v_cvt_pk_bf16_f32 v168, v80, v81
    v_cvt_pk_bf16_f32 v169, v82, v83
    v_cvt_pk_bf16_f32 v170, v84, v85
    v_cvt_pk_bf16_f32 v171, v86, v87
    buffer_store_dwordx4 v[168:171], v16, s[24:27], s80 offen offset:2048 sc1
    v_accvgpr_read_b32 v88, a24
    v_accvgpr_read_b32 v89, a25
    v_accvgpr_read_b32 v90, a26
    v_accvgpr_read_b32 v91, a27
    v_accvgpr_read_b32 v92, a28
    v_accvgpr_read_b32 v93, a29
    v_accvgpr_read_b32 v94, a30
    v_accvgpr_read_b32 v95, a31
    v_mul_f32 v88, v88, v24
    v_mul_f32 v89, v89, v24
    v_mul_f32 v90, v90, v24
    v_mul_f32 v91, v91, v24
    v_mul_f32 v92, v92, v24
    v_mul_f32 v93, v93, v24
    v_mul_f32 v94, v94, v24
    v_mul_f32 v95, v95, v24
    v_cvt_pk_bf16_f32 v172, v88, v89
    v_cvt_pk_bf16_f32 v173, v90, v91
    v_cvt_pk_bf16_f32 v174, v92, v93
    v_cvt_pk_bf16_f32 v175, v94, v95
    buffer_store_dwordx4 v[172:175], v16, s[24:27], s80 offen offset:3072 sc1
    v_exp_f32 v112, v112
    v_exp_f32 v113, v113
    v_exp_f32 v114, v114
    v_exp_f32 v115, v115
    v_exp_f32 v116, v116
    v_exp_f32 v117, v117
    v_exp_f32 v118, v118
    v_exp_f32 v119, v119
    v_cvt_pk_bf16_f32 v152, v112, v113
    v_cvt_pk_bf16_f32 v153, v114, v115
    v_cvt_pk_bf16_f32 v154, v116, v117
    v_cvt_pk_bf16_f32 v155, v118, v119
    v_accvgpr_read_b32 v26, a194
    v_accvgpr_read_b32 v27, a195
    v_mfma_f32_16x16x32_bf16 a[64:67], a[128:131], v[152:155], a[64:67]
    v_add_f32 v26, v26, v27
    v_cmp_ngt_f32 vcc, s43, v26
    v_mfma_f32_16x16x32_bf16 a[68:71], a[132:135], v[152:155], a[68:71]
    v_rcp_f32 v26, v26
    v_mfma_f32_16x16x32_bf16 a[72:75], a[136:139], v[152:155], a[72:75]
    v_accvgpr_read_b32 v64, a32
    v_accvgpr_read_b32 v65, a33
    v_mfma_f32_16x16x32_bf16 a[76:79], a[140:143], v[152:155], a[76:79]
    v_accvgpr_read_b32 v66, a34
    v_accvgpr_read_b32 v67, a35
    v_smfmac_f32_16x16x64_bf16 a[196:199], v[20:23], v[148:155], v59
    v_accvgpr_read_b32 v68, a36
    v_accvgpr_read_b32 v69, a37
    v_mfma_f32_16x16x32_bf16 a[80:83], a[144:147], v[152:155], a[80:83]
    v_accvgpr_read_b32 v70, a38
    v_accvgpr_read_b32 v71, a39
    v_mfma_f32_16x16x32_bf16 a[84:87], a[148:151], v[152:155], a[84:87]
    s_or_b64 s[86:87], s[86:87], vcc
    v_addc_co_u32 v28, vcc, 0, v28, vcc
    v_mfma_f32_16x16x32_bf16 a[88:91], a[152:155], v[152:155], a[88:91]
    v_mul_f32 v64, v64, v26
    v_mul_f32 v65, v65, v26
    v_mfma_f32_16x16x32_bf16 a[92:95], a[156:159], v[152:155], a[92:95]
    v_mul_f32 v66, v66, v26
    v_mul_f32 v67, v67, v26
    v_mul_f32 v68, v68, v26
    v_mul_f32 v69, v69, v26
    v_mul_f32 v70, v70, v26
    v_mul_f32 v71, v71, v26
    v_cvt_pk_bf16_f32 v176, v64, v65
    v_cvt_pk_bf16_f32 v177, v66, v67
    v_cvt_pk_bf16_f32 v178, v68, v69
    v_cvt_pk_bf16_f32 v179, v70, v71
    buffer_store_dwordx4 v[176:179], v16, s[24:27], s81 offen offset:0 sc1
    v_accvgpr_read_b32 v72, a40
    v_accvgpr_read_b32 v73, a41
    v_accvgpr_read_b32 v74, a42
    v_accvgpr_read_b32 v75, a43
    v_accvgpr_read_b32 v76, a44
    v_accvgpr_read_b32 v77, a45
    v_accvgpr_read_b32 v78, a46
    v_accvgpr_read_b32 v79, a47
    v_pk_mul_f32 v[72:73], v[72:73], v[26:27] op_sel_hi:[1,0]
    v_pk_mul_f32 v[74:75], v[74:75], v[26:27] op_sel_hi:[1,0]
    v_pk_mul_f32 v[76:77], v[76:77], v[26:27] op_sel_hi:[1,0]
    v_pk_mul_f32 v[78:79], v[78:79], v[26:27] op_sel_hi:[1,0]
    v_cvt_pk_bf16_f32 v180, v72, v73
    v_cvt_pk_bf16_f32 v181, v74, v75
    v_cvt_pk_bf16_f32 v182, v76, v77
    v_cvt_pk_bf16_f32 v183, v78, v79
    buffer_store_dwordx4 v[180:183], v16, s[24:27], s81 offen offset:1024 sc1
    v_accvgpr_read_b32 v80, a48
    v_accvgpr_read_b32 v81, a49
    v_accvgpr_read_b32 v82, a50
    v_accvgpr_read_b32 v83, a51
    v_accvgpr_read_b32 v84, a52
    v_accvgpr_read_b32 v85, a53
    v_accvgpr_read_b32 v86, a54
    v_accvgpr_read_b32 v87, a55
    v_pk_mul_f32 v[80:81], v[80:81], v[26:27] op_sel_hi:[1,0]
    v_pk_mul_f32 v[82:83], v[82:83], v[26:27] op_sel_hi:[1,0]
    v_pk_mul_f32 v[84:85], v[84:85], v[26:27] op_sel_hi:[1,0]
    v_pk_mul_f32 v[86:87], v[86:87], v[26:27] op_sel_hi:[1,0]
    v_cvt_pk_bf16_f32 v184, v80, v81
    v_cvt_pk_bf16_f32 v185, v82, v83
    v_cvt_pk_bf16_f32 v186, v84, v85
    v_cvt_pk_bf16_f32 v187, v86, v87
    buffer_store_dwordx4 v[184:187], v16, s[24:27], s81 offen offset:2048 sc1
    v_accvgpr_read_b32 v88, a56
    v_accvgpr_read_b32 v89, a57
    v_accvgpr_read_b32 v90, a58
    v_accvgpr_read_b32 v91, a59
    v_accvgpr_read_b32 v92, a60
    v_accvgpr_read_b32 v93, a61
    v_accvgpr_read_b32 v94, a62
    v_accvgpr_read_b32 v95, a63
    v_pk_mul_f32 v[88:89], v[88:89], v[26:27] op_sel_hi:[1,0]
    v_pk_mul_f32 v[90:91], v[90:91], v[26:27] op_sel_hi:[1,0]
    v_pk_mul_f32 v[92:93], v[92:93], v[26:27] op_sel_hi:[1,0]
    v_pk_mul_f32 v[94:95], v[94:95], v[26:27] op_sel_hi:[1,0]
    v_cvt_pk_bf16_f32 v188, v88, v89
    v_cvt_pk_bf16_f32 v189, v90, v91
    v_cvt_pk_bf16_f32 v190, v92, v93
    v_cvt_pk_bf16_f32 v191, v94, v95
    buffer_store_dwordx4 v[188:191], v16, s[24:27], s81 offen offset:3072 sc1
    v_accvgpr_read_b32 v24, a198
    v_accvgpr_read_b32 v25, a199
    v_add_f32 v24, v24, v25
    v_cmp_ngt_f32 vcc, s43, v24
    v_rcp_f32 v24, v24
    v_accvgpr_read_b32 v64, a64
    v_accvgpr_read_b32 v65, a65
    v_accvgpr_read_b32 v66, a66
    v_accvgpr_read_b32 v67, a67
    v_accvgpr_read_b32 v68, a68
    v_accvgpr_read_b32 v69, a69
    v_accvgpr_read_b32 v70, a70
    v_accvgpr_read_b32 v71, a71
    v_addc_co_u32 v28, vcc, 0, v28, vcc
    v_pk_mul_f32 v[64:65], v[64:65], v[24:25] op_sel_hi:[1,0]
    v_pk_mul_f32 v[66:67], v[66:67], v[24:25] op_sel_hi:[1,0]
    v_pk_mul_f32 v[68:69], v[68:69], v[24:25] op_sel_hi:[1,0]
    v_pk_mul_f32 v[70:71], v[70:71], v[24:25] op_sel_hi:[1,0]
    v_cvt_pk_bf16_f32 v160, v64, v65
    v_cvt_pk_bf16_f32 v161, v66, v67
    v_cvt_pk_bf16_f32 v162, v68, v69
    v_cvt_pk_bf16_f32 v163, v70, v71
    v_accvgpr_read_b32 v72, a72
    buffer_store_dwordx4 v[160:163], v16, s[24:27], s82 offen offset:0 sc1
    v_accvgpr_read_b32 v73, a73
    v_accvgpr_read_b32 v74, a74
    v_accvgpr_read_b32 v75, a75
    v_accvgpr_read_b32 v76, a76
    v_accvgpr_read_b32 v77, a77
    v_accvgpr_read_b32 v78, a78
    v_accvgpr_read_b32 v79, a79
    v_pk_mul_f32 v[72:73], v[72:73], v[24:25] op_sel_hi:[1,0]
    v_pk_mul_f32 v[74:75], v[74:75], v[24:25] op_sel_hi:[1,0]
    v_pk_mul_f32 v[76:77], v[76:77], v[24:25] op_sel_hi:[1,0]
    v_pk_mul_f32 v[78:79], v[78:79], v[24:25] op_sel_hi:[1,0]
    v_cvt_pk_bf16_f32 v164, v72, v73
    v_cvt_pk_bf16_f32 v165, v74, v75
    v_cvt_pk_bf16_f32 v166, v76, v77
    v_cvt_pk_bf16_f32 v167, v78, v79
    v_accvgpr_read_b32 v80, a80
    buffer_store_dwordx4 v[164:167], v16, s[24:27], s82 offen offset:1024 sc1
    v_accvgpr_read_b32 v81, a81
    v_accvgpr_read_b32 v82, a82
    v_accvgpr_read_b32 v83, a83
    v_accvgpr_read_b32 v84, a84
    v_accvgpr_read_b32 v85, a85
    v_accvgpr_read_b32 v86, a86
    v_accvgpr_read_b32 v87, a87
    v_pk_mul_f32 v[80:81], v[80:81], v[24:25] op_sel_hi:[1,0]
    v_pk_mul_f32 v[82:83], v[82:83], v[24:25] op_sel_hi:[1,0]
    v_pk_mul_f32 v[84:85], v[84:85], v[24:25] op_sel_hi:[1,0]
    v_pk_mul_f32 v[86:87], v[86:87], v[24:25] op_sel_hi:[1,0]
    v_cvt_pk_bf16_f32 v168, v80, v81
    v_cvt_pk_bf16_f32 v169, v82, v83
    v_cvt_pk_bf16_f32 v170, v84, v85
    v_cvt_pk_bf16_f32 v171, v86, v87
    v_accvgpr_read_b32 v88, a88
    buffer_store_dwordx4 v[168:171], v16, s[24:27], s82 offen offset:2048 sc1
    v_accvgpr_read_b32 v89, a89
    v_accvgpr_read_b32 v90, a90
    v_accvgpr_read_b32 v91, a91
    v_accvgpr_read_b32 v92, a92
    v_accvgpr_read_b32 v93, a93
    v_accvgpr_read_b32 v94, a94
    v_accvgpr_read_b32 v95, a95
    v_pk_mul_f32 v[88:89], v[88:89], v[24:25] op_sel_hi:[1,0]
    v_pk_mul_f32 v[90:91], v[90:91], v[24:25] op_sel_hi:[1,0]
    v_pk_mul_f32 v[92:93], v[92:93], v[24:25] op_sel_hi:[1,0]
    v_pk_mul_f32 v[94:95], v[94:95], v[24:25] op_sel_hi:[1,0]
    v_cvt_pk_bf16_f32 v172, v88, v89
    v_cvt_pk_bf16_f32 v173, v90, v91
    v_cvt_pk_bf16_f32 v174, v92, v93
    v_cvt_pk_bf16_f32 v175, v94, v95
    buffer_store_dwordx4 v[172:175], v16, s[24:27], s82 offen offset:3072 sc1
    s_cmp_lg_u32 s55, 0
    s_cselect_b64 s[86:87], 0, s[86:87]
    s_cmp_eq_u64 s[86:87], 0
    s_cselect_b32 s44, s84, 50331648
    s_waitcnt vmcnt(4)
    buffer_store_dwordx2 v[56:57], v17, s[24:27], s44 offen sc1
    s_cselect_b32 s84, 50331648, s84
    s_cselect_b32 s80, 50331648, s80
    s_cselect_b32 s81, 50331648, s81
    s_waitcnt vmcnt(13)
    s_barrier
    v_lshlrev_b32 v29, 2, v0
    v_add_u32 v29, 147456, v29
    ds_write_b32 v29, v28
    ds_read_b64_tr_b16 a[0:1], v44 offset:0
    ds_read_b64_tr_b16 a[2:3], v44 offset:3072
    ds_read_b64_tr_b16 a[4:5], v45 offset:0
    ds_read_b64_tr_b16 a[6:7], v45 offset:3072
    ds_read_b64_tr_b16 a[8:9], v44 offset:64
    ds_read_b64_tr_b16 a[10:11], v44 offset:3136
    ds_read_b64_tr_b16 a[12:13], v45 offset:64
    ds_read_b64_tr_b16 a[14:15], v45 offset:3136
    ds_read_b64_tr_b16 a[16:17], v44 offset:128
    ds_read_b64_tr_b16 a[18:19], v44 offset:3200
    ds_read_b64_tr_b16 a[20:21], v45 offset:128
    ds_read_b64_tr_b16 a[22:23], v45 offset:3200
    ds_read_b64_tr_b16 a[24:25], v44 offset:6144
    ds_read_b64_tr_b16 a[26:27], v44 offset:9216
    ds_read_b64_tr_b16 a[28:29], v45 offset:6144
    ds_read_b64_tr_b16 a[30:31], v45 offset:9216
    ds_read_b64_tr_b16 a[32:33], v44 offset:6208
    ds_read_b64_tr_b16 a[34:35], v44 offset:9280
    ds_read_b64_tr_b16 a[36:37], v45 offset:6208
    ds_read_b64_tr_b16 a[38:39], v45 offset:9280
    ds_read_b64_tr_b16 a[40:41], v44 offset:6272
    ds_read_b64_tr_b16 a[42:43], v44 offset:9344
    ds_read_b64_tr_b16 a[44:45], v45 offset:6272
    ds_read_b64_tr_b16 a[46:47], v45 offset:9344
    ds_read_b64_tr_b16 a[48:49], v44 offset:12288
    ds_read_b64_tr_b16 a[50:51], v44 offset:15360
    ds_read_b64_tr_b16 a[52:53], v45 offset:12288
    ds_read_b64_tr_b16 a[54:55], v45 offset:15360
    ds_read_b64_tr_b16 a[56:57], v44 offset:12352
    ds_read_b64_tr_b16 a[58:59], v44 offset:15424
    ds_read_b64_tr_b16 a[60:61], v45 offset:12352
    ds_read_b64_tr_b16 a[62:63], v45 offset:15424
    ds_read_b64_tr_b16 a[64:65], v44 offset:12416
    ds_read_b64_tr_b16 a[66:67], v44 offset:15488
    ds_read_b64_tr_b16 a[68:69], v45 offset:12416
    ds_read_b64_tr_b16 a[70:71], v45 offset:15488
    ds_read_b64_tr_b16 a[72:73], v44 offset:18432
    ds_read_b64_tr_b16 a[74:75], v44 offset:21504
    ds_read_b64_tr_b16 a[76:77], v45 offset:18432
    ds_read_b64_tr_b16 a[78:79], v45 offset:21504
    ds_read_b64_tr_b16 a[80:81], v44 offset:18496
    ds_read_b64_tr_b16 a[82:83], v44 offset:21568
    ds_read_b64_tr_b16 a[84:85], v45 offset:18496
    ds_read_b64_tr_b16 a[86:87], v45 offset:21568
    ds_read_b64_tr_b16 a[88:89], v44 offset:18560
    ds_read_b64_tr_b16 a[90:91], v44 offset:21632
    ds_read_b64_tr_b16 a[92:93], v45 offset:18560
    ds_read_b64_tr_b16 a[94:95], v45 offset:21632
    s_waitcnt lgkmcnt(15)
    s_mul_i32 s45, s40, 294912
    s_add_u32 s46, s45, 221184
    s_add_u32 m0, s69, 0
    s_nop 0
    buffer_load_dwordx4 v41, s[28:31], s46 offen offset:0 lds
    buffer_load_dwordx4 v42, s[28:31], s46 offen offset:1024 lds
    buffer_load_dwordx4 v43, s[28:31], s46 offen offset:2048 lds
    s_add_u32 s46, s45, 239616
    s_add_u32 m0, s69, 3072
    s_nop 0
    buffer_load_dwordx4 v41, s[28:31], s46 offen offset:0 lds
    buffer_load_dwordx4 v42, s[28:31], s46 offen offset:1024 lds
    buffer_load_dwordx4 v43, s[28:31], s46 offen offset:2048 lds
    s_add_u32 s46, s45, 258048
    s_add_u32 m0, s69, 6144
    s_nop 0
    buffer_load_dwordx4 v41, s[28:31], s46 offen offset:0 lds
    buffer_load_dwordx4 v42, s[28:31], s46 offen offset:1024 lds
    buffer_load_dwordx4 v43, s[28:31], s46 offen offset:2048 lds
    s_add_u32 s46, s45, 276480
    s_add_u32 m0, s69, 9216
    s_nop 0
    buffer_load_dwordx4 v41, s[28:31], s46 offen offset:0 lds
    buffer_load_dwordx4 v42, s[28:31], s46 offen offset:1024 lds
    buffer_load_dwordx4 v43, s[28:31], s46 offen offset:2048 lds
    ds_read_b64_tr_b16 a[96:97], v44 offset:24576
    ds_read_b64_tr_b16 a[98:99], v44 offset:27648
    ds_read_b64_tr_b16 a[100:101], v45 offset:24576
    ds_read_b64_tr_b16 a[102:103], v45 offset:27648
    ds_read_b64_tr_b16 a[104:105], v44 offset:24640
    ds_read_b64_tr_b16 a[106:107], v44 offset:27712
    ds_read_b64_tr_b16 a[108:109], v45 offset:24640
    ds_read_b64_tr_b16 a[110:111], v45 offset:27712
    ds_read_b64_tr_b16 a[112:113], v44 offset:24704
    ds_read_b64_tr_b16 a[114:115], v44 offset:27776
    ds_read_b64_tr_b16 a[116:117], v45 offset:24704
    ds_read_b64_tr_b16 a[118:119], v45 offset:27776
    ds_read_b64_tr_b16 a[120:121], v44 offset:30720
    ds_read_b64_tr_b16 a[122:123], v44 offset:33792
    ds_read_b64_tr_b16 a[124:125], v45 offset:30720
    ds_read_b64_tr_b16 a[126:127], v45 offset:33792
    ds_read_b64_tr_b16 a[128:129], v44 offset:30784
    ds_read_b64_tr_b16 a[130:131], v44 offset:33856
    ds_read_b64_tr_b16 a[132:133], v45 offset:30784
    ds_read_b64_tr_b16 a[134:135], v45 offset:33856
    ds_read_b64_tr_b16 a[136:137], v44 offset:30848
    ds_read_b64_tr_b16 a[138:139], v44 offset:33920
    ds_read_b64_tr_b16 a[140:141], v45 offset:30848
    ds_read_b64_tr_b16 a[142:143], v45 offset:33920
    v_add_u32 v29, 147456, v16
    s_waitcnt lgkmcnt(0)
    s_barrier
    ds_read_b128 v[24:27], v29
    s_waitcnt lgkmcnt(0)
    v_or_b32 v24, v24, v25
    v_or3_b32 v24, v24, v26, v27
    v_cmp_ne_u32 vcc, 0, v24
    s_cmp_lg_u32 s55, 0
    s_cbranch_scc1 L_phase2
    s_nop 2
    s_cbranch_vccnz L_fallback_q3
L_phase2:
    s_cmp_lt_u32 s68, 30
    s_cbranch_scc1 L_tile
    s_waitcnt vmcnt(0)
    buffer_store_dwordx2 v[56:57], v17, s[24:27], s85 offen sc1
    s_branch L_fin
L_tile:
    buffer_load_dwordx2 v[24:25], v58, s[24:27], 0 offen sc1
    v_and_b32 v61, 0xffffff7f, v60
    v_add_u32 v61, 256, v61
    v_add_u32 v32, 73728, v46
    v_add_u32 v33, 73728, v47
    v_add_u32 v34, 73728, v48
    v_add_u32 v35, 73728, v49
    v_add_u32 v36, 73728, v50
    v_lshrrev_b32 v37, 5, v1
    v_lshlrev_b32 v37, 30, v37
    v_lshl_add_u32 v37, v1, 3, v37
    s_waitcnt vmcnt(1)
    buffer_store_dwordx2 v[56:57], v17, s[24:27], s85 offen sc1
    s_waitcnt vmcnt(1)
    v_cmp_ne_u64 vcc, v[24:25], v[56:57]
    s_nop 4
    s_cbranch_vccnz L_fo_spin
L_fo_ok:
    s_add_u32 s44, s96, 0
    buffer_load_dwordx4 a[192:195], v16, s[24:27], s44 offen offset:0 sc1
    buffer_load_dwordx4 a[196:199], v16, s[24:27], s44 offen offset:1024 sc1
    buffer_load_dwordx4 a[200:203], v16, s[24:27], s44 offen offset:2048 sc1
    buffer_load_dwordx4 a[204:207], v16, s[24:27], s44 offen offset:3072 sc1
    s_add_u32 s44, s96, 4096
    buffer_load_dwordx4 a[208:211], v16, s[24:27], s44 offen offset:0 sc1
    buffer_load_dwordx4 a[212:215], v16, s[24:27], s44 offen offset:1024 sc1
    buffer_load_dwordx4 a[216:219], v16, s[24:27], s44 offen offset:2048 sc1
    buffer_load_dwordx4 a[220:223], v16, s[24:27], s44 offen offset:3072 sc1
    s_add_u32 s44, s96, 32768
    buffer_load_dwordx4 a[224:227], v16, s[24:27], s44 offen offset:0 sc1
    buffer_load_dwordx4 a[228:231], v16, s[24:27], s44 offen offset:1024 sc1
    buffer_load_dwordx4 a[232:235], v16, s[24:27], s44 offen offset:2048 sc1
    ds_read_b64_tr_b16 a[144:145], v44 offset:0
    ds_read_b64_tr_b16 a[146:147], v44 offset:3072
    ds_read_b64_tr_b16 a[148:149], v45 offset:0
    ds_read_b64_tr_b16 a[150:151], v45 offset:3072
    ds_read_b64_tr_b16 a[152:153], v44 offset:64
    ds_read_b64_tr_b16 a[154:155], v44 offset:3136
    ds_read_b64_tr_b16 a[156:157], v45 offset:64
    ds_read_b64_tr_b16 a[158:159], v45 offset:3136
    ds_read_b64_tr_b16 a[160:161], v44 offset:128
    ds_read_b64_tr_b16 a[162:163], v44 offset:3200
    ds_read_b64_tr_b16 a[164:165], v45 offset:128
    ds_read_b64_tr_b16 a[166:167], v45 offset:3200
    ds_read_b64_tr_b16 a[168:169], v44 offset:6144
    ds_read_b64_tr_b16 a[170:171], v44 offset:9216
    ds_read_b64_tr_b16 a[172:173], v45 offset:6144
    ds_read_b64_tr_b16 a[174:175], v45 offset:9216
    ds_read_b64_tr_b16 a[176:177], v44 offset:6208
    ds_read_b64_tr_b16 a[178:179], v44 offset:9280
    ds_read_b64_tr_b16 a[180:181], v45 offset:6208
    ds_read_b64_tr_b16 a[182:183], v45 offset:9280
    ds_read_b64_tr_b16 a[184:185], v44 offset:6272
    ds_read_b64_tr_b16 a[186:187], v44 offset:9344
    ds_read_b64_tr_b16 a[188:189], v45 offset:6272
    ds_read_b64_tr_b16 a[190:191], v45 offset:9344
    s_waitcnt vmcnt(10)
    v_mfma_f32_16x16x32_bf16 v[64:67], a[0:3], a[192:195], 0
    s_waitcnt vmcnt(9)
    v_mfma_f32_16x16x32_bf16 v[64:67], a[24:27], a[196:199], v[64:67]
    buffer_load_dwordx4 a[236:239], v16, s[24:27], s44 offen offset:3072 sc1
    v_mfma_f32_16x16x32_bf16 v[68:71], a[4:7], a[192:195], 0
    v_mfma_f32_16x16x32_bf16 v[68:71], a[28:31], a[196:199], v[68:71]
    v_mfma_f32_16x16x32_bf16 v[72:75], a[8:11], a[192:195], 0
    v_mfma_f32_16x16x32_bf16 v[72:75], a[32:35], a[196:199], v[72:75]
    v_mfma_f32_16x16x32_bf16 v[76:79], a[12:15], a[192:195], 0
    s_add_u32 s44, s96, 36864
    v_mfma_f32_16x16x32_bf16 v[76:79], a[36:39], a[196:199], v[76:79]
    buffer_load_dwordx4 a[240:243], v16, s[24:27], s44 offen offset:0 sc1
    v_mfma_f32_16x16x32_bf16 v[80:83], a[16:19], a[192:195], 0
    v_mfma_f32_16x16x32_bf16 v[80:83], a[40:43], a[196:199], v[80:83]
    v_mfma_f32_16x16x32_bf16 v[84:87], a[20:23], a[192:195], 0
    v_mfma_f32_16x16x32_bf16 v[84:87], a[44:47], a[196:199], v[84:87]
    s_waitcnt vmcnt(10)
    v_mfma_f32_16x16x32_bf16 v[64:67], a[48:51], a[200:203], v[64:67]
    s_waitcnt vmcnt(9)
    v_mfma_f32_16x16x32_bf16 v[64:67], a[72:75], a[204:207], v[64:67]
    buffer_load_dwordx4 a[244:247], v16, s[24:27], s44 offen offset:1024 sc1
    v_mfma_f32_16x16x32_bf16 v[68:71], a[52:55], a[200:203], v[68:71]
    v_mfma_f32_16x16x32_bf16 v[68:71], a[76:79], a[204:207], v[68:71]
    v_mfma_f32_16x16x32_bf16 v[72:75], a[56:59], a[200:203], v[72:75]
    v_mfma_f32_16x16x32_bf16 v[72:75], a[80:83], a[204:207], v[72:75]
    v_mfma_f32_16x16x32_bf16 v[76:79], a[60:63], a[200:203], v[76:79]
    v_mfma_f32_16x16x32_bf16 v[76:79], a[84:87], a[204:207], v[76:79]
    buffer_load_dwordx4 a[248:251], v16, s[24:27], s44 offen offset:2048 sc1
    v_mfma_f32_16x16x32_bf16 v[80:83], a[64:67], a[200:203], v[80:83]
    v_mfma_f32_16x16x32_bf16 v[80:83], a[88:91], a[204:207], v[80:83]
    v_mfma_f32_16x16x32_bf16 v[84:87], a[68:71], a[200:203], v[84:87]
    s_waitcnt lgkmcnt(0)
    v_mfma_f32_16x16x32_bf16 v[84:87], a[92:95], a[204:207], v[84:87]
    s_waitcnt vmcnt(10)
    v_mfma_f32_16x16x32_bf16 v[64:67], a[96:99], a[208:211], v[64:67]
    s_waitcnt vmcnt(9)
    v_mfma_f32_16x16x32_bf16 v[64:67], a[120:123], a[212:215], v[64:67]
    buffer_load_dwordx4 a[252:255], v16, s[24:27], s44 offen offset:3072 sc1
    v_mfma_f32_16x16x32_bf16 v[68:71], a[100:103], a[208:211], v[68:71]
    v_mfma_f32_16x16x32_bf16 v[68:71], a[124:127], a[212:215], v[68:71]
    v_mfma_f32_16x16x32_bf16 v[72:75], a[104:107], a[208:211], v[72:75]
    v_mfma_f32_16x16x32_bf16 v[72:75], a[128:131], a[212:215], v[72:75]
    v_mfma_f32_16x16x32_bf16 v[76:79], a[108:111], a[208:211], v[76:79]
    s_add_u32 s44, s96, 65536
    v_mfma_f32_16x16x32_bf16 v[76:79], a[132:135], a[212:215], v[76:79]
    buffer_load_dwordx4 a[192:195], v16, s[24:27], s44 offen offset:0 sc1
    v_mfma_f32_16x16x32_bf16 v[80:83], a[112:115], a[208:211], v[80:83]
    v_mfma_f32_16x16x32_bf16 v[80:83], a[136:139], a[212:215], v[80:83]
    v_mfma_f32_16x16x32_bf16 v[84:87], a[116:119], a[208:211], v[84:87]
    v_mfma_f32_16x16x32_bf16 v[84:87], a[140:143], a[212:215], v[84:87]
    s_waitcnt vmcnt(10)
    v_mfma_f32_16x16x32_bf16 v[64:67], a[144:147], a[216:219], v[64:67]
    s_waitcnt vmcnt(9)
    v_mfma_f32_16x16x32_bf16 v[64:67], a[168:171], a[220:223], v[64:67]
    buffer_load_dwordx4 a[196:199], v16, s[24:27], s44 offen offset:1024 sc1
    v_mfma_f32_16x16x32_bf16 v[68:71], a[148:151], a[216:219], v[68:71]
    v_mfma_f32_16x16x32_bf16 v[68:71], a[172:175], a[220:223], v[68:71]
    v_mfma_f32_16x16x32_bf16 v[72:75], a[152:155], a[216:219], v[72:75]
    v_mfma_f32_16x16x32_bf16 v[72:75], a[176:179], a[220:223], v[72:75]
    v_mfma_f32_16x16x32_bf16 v[76:79], a[156:159], a[216:219], v[76:79]
    v_mfma_f32_16x16x32_bf16 v[76:79], a[180:183], a[220:223], v[76:79]
    buffer_load_dwordx4 a[200:203], v16, s[24:27], s44 offen offset:2048 sc1
    v_mfma_f32_16x16x32_bf16 v[80:83], a[160:163], a[216:219], v[80:83]
    v_mfma_f32_16x16x32_bf16 v[80:83], a[184:187], a[220:223], v[80:83]
    v_mfma_f32_16x16x32_bf16 v[84:87], a[164:167], a[216:219], v[84:87]
    v_mfma_f32_16x16x32_bf16 v[84:87], a[188:191], a[220:223], v[84:87]
    s_waitcnt vmcnt(10)
    ds_write_b128 v19, v[64:67] offset:0
    v_mfma_f32_16x16x32_bf16 v[88:91], a[0:3], a[224:227], 0
    s_waitcnt vmcnt(9)
    v_mfma_f32_16x16x32_bf16 v[88:91], a[24:27], a[228:231], v[88:91]
    buffer_load_dwordx4 a[204:207], v16, s[24:27], s44 offen offset:3072 sc1
    v_mfma_f32_16x16x32_bf16 v[92:95], a[4:7], a[224:227], 0
    v_mfma_f32_16x16x32_bf16 v[92:95], a[28:31], a[228:231], v[92:95]
    ds_write_b128 v18, v[68:71] offset:0
    v_mfma_f32_16x16x32_bf16 v[96:99], a[8:11], a[224:227], 0
    v_mfma_f32_16x16x32_bf16 v[96:99], a[32:35], a[228:231], v[96:99]
    v_mfma_f32_16x16x32_bf16 v[100:103], a[12:15], a[224:227], 0
    s_add_u32 s44, s96, 69632
    v_mfma_f32_16x16x32_bf16 v[100:103], a[36:39], a[228:231], v[100:103]
    buffer_load_dwordx4 a[208:211], v16, s[24:27], s44 offen offset:0 sc1
    ds_write_b128 v19, v[72:75] offset:128
    v_mfma_f32_16x16x32_bf16 v[104:107], a[16:19], a[224:227], 0
    v_mfma_f32_16x16x32_bf16 v[104:107], a[40:43], a[228:231], v[104:107]
    v_mfma_f32_16x16x32_bf16 v[108:111], a[20:23], a[224:227], 0
    v_mfma_f32_16x16x32_bf16 v[108:111], a[44:47], a[228:231], v[108:111]
    s_waitcnt vmcnt(10)
    ds_write_b128 v18, v[76:79] offset:128
    v_mfma_f32_16x16x32_bf16 v[88:91], a[48:51], a[232:235], v[88:91]
    s_waitcnt vmcnt(9)
    v_mfma_f32_16x16x32_bf16 v[88:91], a[72:75], a[236:239], v[88:91]
    buffer_load_dwordx4 a[212:215], v16, s[24:27], s44 offen offset:1024 sc1
    v_mfma_f32_16x16x32_bf16 v[92:95], a[52:55], a[232:235], v[92:95]
    v_mfma_f32_16x16x32_bf16 v[92:95], a[76:79], a[236:239], v[92:95]
    ds_write_b128 v19, v[80:83] offset:256
    v_mfma_f32_16x16x32_bf16 v[96:99], a[56:59], a[232:235], v[96:99]
    v_mfma_f32_16x16x32_bf16 v[96:99], a[80:83], a[236:239], v[96:99]
    v_mfma_f32_16x16x32_bf16 v[100:103], a[60:63], a[232:235], v[100:103]
    v_mfma_f32_16x16x32_bf16 v[100:103], a[84:87], a[236:239], v[100:103]
    buffer_load_dwordx4 a[216:219], v16, s[24:27], s44 offen offset:2048 sc1
    ds_write_b128 v18, v[84:87] offset:256
    v_mfma_f32_16x16x32_bf16 v[104:107], a[64:67], a[232:235], v[104:107]
    v_mfma_f32_16x16x32_bf16 v[104:107], a[88:91], a[236:239], v[104:107]
    v_mfma_f32_16x16x32_bf16 v[108:111], a[68:71], a[232:235], v[108:111]
    v_mfma_f32_16x16x32_bf16 v[108:111], a[92:95], a[236:239], v[108:111]
    s_waitcnt vmcnt(10)
    v_mfma_f32_16x16x32_bf16 v[88:91], a[96:99], a[240:243], v[88:91]
    s_waitcnt vmcnt(9)
    v_mfma_f32_16x16x32_bf16 v[88:91], a[120:123], a[244:247], v[88:91]
    buffer_load_dwordx4 a[220:223], v16, s[24:27], s44 offen offset:3072 sc1
    v_mfma_f32_16x16x32_bf16 v[92:95], a[100:103], a[240:243], v[92:95]
    v_mfma_f32_16x16x32_bf16 v[92:95], a[124:127], a[244:247], v[92:95]
    v_mfma_f32_16x16x32_bf16 v[96:99], a[104:107], a[240:243], v[96:99]
    v_mfma_f32_16x16x32_bf16 v[96:99], a[128:131], a[244:247], v[96:99]
    v_mfma_f32_16x16x32_bf16 v[100:103], a[108:111], a[240:243], v[100:103]
    s_add_u32 s44, s97, 0
    v_mfma_f32_16x16x32_bf16 v[100:103], a[132:135], a[244:247], v[100:103]
    buffer_load_dwordx4 a[224:227], v16, s[24:27], s44 offen offset:0 sc1
    v_mfma_f32_16x16x32_bf16 v[104:107], a[112:115], a[240:243], v[104:107]
    v_mfma_f32_16x16x32_bf16 v[104:107], a[136:139], a[244:247], v[104:107]
    v_mfma_f32_16x16x32_bf16 v[108:111], a[116:119], a[240:243], v[108:111]
    v_mfma_f32_16x16x32_bf16 v[108:111], a[140:143], a[244:247], v[108:111]
    s_waitcnt vmcnt(10)
    v_mfma_f32_16x16x32_bf16 v[88:91], a[144:147], a[248:251], v[88:91]
    s_waitcnt vmcnt(9)
    v_mfma_f32_16x16x32_bf16 v[88:91], a[168:171], a[252:255], v[88:91]
    buffer_load_dwordx4 a[228:231], v16, s[24:27], s44 offen offset:1024 sc1
    v_mfma_f32_16x16x32_bf16 v[92:95], a[148:151], a[248:251], v[92:95]
    s_add_u32 s43, s63, 1
    v_mfma_f32_16x16x32_bf16 v[92:95], a[172:175], a[252:255], v[92:95]
    v_mfma_f32_16x16x32_bf16 v[96:99], a[152:155], a[248:251], v[96:99]
    s_and_b32 s43, s43, 3
    v_mfma_f32_16x16x32_bf16 v[96:99], a[176:179], a[252:255], v[96:99]
    v_mfma_f32_16x16x32_bf16 v[100:103], a[156:159], a[248:251], v[100:103]
    s_sub_u32 s43, s43, s63
    v_mfma_f32_16x16x32_bf16 v[100:103], a[180:183], a[252:255], v[100:103]
    buffer_load_dwordx4 a[232:235], v16, s[24:27], s44 offen offset:2048 sc1
    v_mfma_f32_16x16x32_bf16 v[104:107], a[160:163], a[248:251], v[104:107]
    s_mul_i32 s3, s43, 122880
    v_mfma_f32_16x16x32_bf16 v[104:107], a[184:187], a[252:255], v[104:107]
    v_mfma_f32_16x16x32_bf16 v[108:111], a[164:167], a[248:251], v[108:111]
    s_waitcnt lgkmcnt(0)
    s_add_u32 s3, s3, s79
    v_mfma_f32_16x16x32_bf16 v[108:111], a[188:191], a[252:255], v[108:111]
    s_waitcnt vmcnt(10)
    ds_write_b128 v19, v[88:91] offset:6144
    v_mfma_f32_16x16x32_bf16 v[64:67], a[0:3], a[192:195], 0
    s_waitcnt vmcnt(9)
    s_add_u32 s70, s3, 0
    v_mfma_f32_16x16x32_bf16 v[64:67], a[24:27], a[196:199], v[64:67]
    buffer_load_dwordx4 a[236:239], v16, s[24:27], s44 offen offset:3072 sc1
    v_mfma_f32_16x16x32_bf16 v[68:71], a[4:7], a[192:195], 0
    s_lshl_b32 s43, s43, 1
    v_mfma_f32_16x16x32_bf16 v[68:71], a[28:31], a[196:199], v[68:71]
    ds_write_b128 v18, v[92:95] offset:6144
    v_mfma_f32_16x16x32_bf16 v[72:75], a[8:11], a[192:195], 0
    s_add_u32 s43, s43, s2
    v_mfma_f32_16x16x32_bf16 v[72:75], a[32:35], a[196:199], v[72:75]
    v_mfma_f32_16x16x32_bf16 v[76:79], a[12:15], a[192:195], 0
    s_add_u32 s44, s97, 4096
    s_lshl_b32 s43, s43, 11
    v_mfma_f32_16x16x32_bf16 v[76:79], a[36:39], a[196:199], v[76:79]
    buffer_load_dwordx4 a[240:243], v16, s[24:27], s44 offen offset:0 sc1
    ds_write_b128 v19, v[96:99] offset:6272
    v_mfma_f32_16x16x32_bf16 v[80:83], a[16:19], a[192:195], 0
    s_add_u32 s43, s43, 17301504
    v_mfma_f32_16x16x32_bf16 v[80:83], a[40:43], a[196:199], v[80:83]
    v_mfma_f32_16x16x32_bf16 v[84:87], a[20:23], a[192:195], 0
    s_lshl_b32 s45, s40, 9
    v_mfma_f32_16x16x32_bf16 v[84:87], a[44:47], a[196:199], v[84:87]
    s_waitcnt vmcnt(10)
    ds_write_b128 v18, v[100:103] offset:6272
    v_mfma_f32_16x16x32_bf16 v[64:67], a[48:51], a[200:203], v[64:67]
    s_waitcnt vmcnt(9)
    s_add_u32 s72, s43, s45
    v_mfma_f32_16x16x32_bf16 v[64:67], a[72:75], a[204:207], v[64:67]
    buffer_load_dwordx4 a[244:247], v16, s[24:27], s44 offen offset:1024 sc1
    v_mfma_f32_16x16x32_bf16 v[68:71], a[52:55], a[200:203], v[68:71]
    v_mfma_f32_16x16x32_bf16 v[68:71], a[76:79], a[204:207], v[68:71]
    ds_write_b128 v19, v[104:107] offset:6400
    v_mfma_f32_16x16x32_bf16 v[72:75], a[56:59], a[200:203], v[72:75]
    v_mfma_f32_16x16x32_bf16 v[72:75], a[80:83], a[204:207], v[72:75]
    v_mfma_f32_16x16x32_bf16 v[76:79], a[60:63], a[200:203], v[76:79]
    v_mfma_f32_16x16x32_bf16 v[76:79], a[84:87], a[204:207], v[76:79]
    buffer_load_dwordx4 a[248:251], v16, s[24:27], s44 offen offset:2048 sc1
    ds_write_b128 v18, v[108:111] offset:6400
    v_mfma_f32_16x16x32_bf16 v[80:83], a[64:67], a[200:203], v[80:83]
    v_mfma_f32_16x16x32_bf16 v[80:83], a[88:91], a[204:207], v[80:83]
    v_mfma_f32_16x16x32_bf16 v[84:87], a[68:71], a[200:203], v[84:87]
    v_mfma_f32_16x16x32_bf16 v[84:87], a[92:95], a[204:207], v[84:87]
    s_waitcnt vmcnt(10)
    v_mfma_f32_16x16x32_bf16 v[64:67], a[96:99], a[208:211], v[64:67]
    s_waitcnt vmcnt(9)
    v_mfma_f32_16x16x32_bf16 v[64:67], a[120:123], a[212:215], v[64:67]
    buffer_load_dwordx4 a[252:255], v16, s[24:27], s44 offen offset:3072 sc1
    v_mfma_f32_16x16x32_bf16 v[68:71], a[100:103], a[208:211], v[68:71]
    v_mfma_f32_16x16x32_bf16 v[68:71], a[124:127], a[212:215], v[68:71]
    v_mfma_f32_16x16x32_bf16 v[72:75], a[104:107], a[208:211], v[72:75]
    v_mfma_f32_16x16x32_bf16 v[72:75], a[128:131], a[212:215], v[72:75]
    v_mfma_f32_16x16x32_bf16 v[76:79], a[108:111], a[208:211], v[76:79]
    s_add_u32 s44, s97, 32768
    v_mfma_f32_16x16x32_bf16 v[76:79], a[132:135], a[212:215], v[76:79]
    buffer_load_dwordx4 a[192:195], v16, s[24:27], s44 offen offset:0 sc1
    v_mfma_f32_16x16x32_bf16 v[80:83], a[112:115], a[208:211], v[80:83]
    v_mfma_f32_16x16x32_bf16 v[80:83], a[136:139], a[212:215], v[80:83]
    v_mfma_f32_16x16x32_bf16 v[84:87], a[116:119], a[208:211], v[84:87]
    v_mfma_f32_16x16x32_bf16 v[84:87], a[140:143], a[212:215], v[84:87]
    s_waitcnt vmcnt(10)
    v_mfma_f32_16x16x32_bf16 v[64:67], a[144:147], a[216:219], v[64:67]
    s_waitcnt vmcnt(9)
    v_mfma_f32_16x16x32_bf16 v[64:67], a[168:171], a[220:223], v[64:67]
    buffer_load_dwordx4 a[196:199], v16, s[24:27], s44 offen offset:1024 sc1
    v_mfma_f32_16x16x32_bf16 v[68:71], a[148:151], a[216:219], v[68:71]
    buffer_load_dwordx2 v[24:25], v58, s[24:27], 0 offen offset:128 sc1
    v_mfma_f32_16x16x32_bf16 v[68:71], a[172:175], a[220:223], v[68:71]
    v_mfma_f32_16x16x32_bf16 v[72:75], a[152:155], a[216:219], v[72:75]
    v_mfma_f32_16x16x32_bf16 v[72:75], a[176:179], a[220:223], v[72:75]
    v_mfma_f32_16x16x32_bf16 v[76:79], a[156:159], a[216:219], v[76:79]
    v_mfma_f32_16x16x32_bf16 v[76:79], a[180:183], a[220:223], v[76:79]
    buffer_load_dwordx4 a[200:203], v16, s[24:27], s44 offen offset:2048 sc1
    v_mfma_f32_16x16x32_bf16 v[80:83], a[160:163], a[216:219], v[80:83]
    v_mfma_f32_16x16x32_bf16 v[80:83], a[184:187], a[220:223], v[80:83]
    v_mfma_f32_16x16x32_bf16 v[84:87], a[164:167], a[216:219], v[84:87]
    s_waitcnt lgkmcnt(0)
    v_mfma_f32_16x16x32_bf16 v[84:87], a[188:191], a[220:223], v[84:87]
    s_waitcnt vmcnt(11)
    ds_write_b128 v19, v[64:67] offset:12288
    v_mfma_f32_16x16x32_bf16 v[88:91], a[0:3], a[224:227], 0
    s_waitcnt vmcnt(10)
    v_mfma_f32_16x16x32_bf16 v[88:91], a[24:27], a[228:231], v[88:91]
    buffer_load_dwordx4 a[204:207], v16, s[24:27], s44 offen offset:3072 sc1
    v_mfma_f32_16x16x32_bf16 v[92:95], a[4:7], a[224:227], 0
    v_mfma_f32_16x16x32_bf16 v[92:95], a[28:31], a[228:231], v[92:95]
    ds_write_b128 v18, v[68:71] offset:12288
    v_mfma_f32_16x16x32_bf16 v[96:99], a[8:11], a[224:227], 0
    v_mfma_f32_16x16x32_bf16 v[96:99], a[32:35], a[228:231], v[96:99]
    v_mfma_f32_16x16x32_bf16 v[100:103], a[12:15], a[224:227], 0
    s_add_u32 s44, s97, 36864
    v_mfma_f32_16x16x32_bf16 v[100:103], a[36:39], a[228:231], v[100:103]
    buffer_load_dwordx4 a[208:211], v16, s[24:27], s44 offen offset:0 sc1
    ds_write_b128 v19, v[72:75] offset:12416
    v_mfma_f32_16x16x32_bf16 v[104:107], a[16:19], a[224:227], 0
    v_mfma_f32_16x16x32_bf16 v[104:107], a[40:43], a[228:231], v[104:107]
    v_mfma_f32_16x16x32_bf16 v[108:111], a[20:23], a[224:227], 0
    v_mfma_f32_16x16x32_bf16 v[108:111], a[44:47], a[228:231], v[108:111]
    s_waitcnt vmcnt(11)
    ds_write_b128 v18, v[76:79] offset:12416
    v_mfma_f32_16x16x32_bf16 v[88:91], a[48:51], a[232:235], v[88:91]
    s_waitcnt vmcnt(10)
    v_mfma_f32_16x16x32_bf16 v[88:91], a[72:75], a[236:239], v[88:91]
    buffer_load_dwordx4 a[212:215], v16, s[24:27], s44 offen offset:1024 sc1
    v_mfma_f32_16x16x32_bf16 v[92:95], a[52:55], a[232:235], v[92:95]
    v_mfma_f32_16x16x32_bf16 v[92:95], a[76:79], a[236:239], v[92:95]
    ds_write_b128 v19, v[80:83] offset:12544
    v_mfma_f32_16x16x32_bf16 v[96:99], a[56:59], a[232:235], v[96:99]
    v_mfma_f32_16x16x32_bf16 v[96:99], a[80:83], a[236:239], v[96:99]
    v_mfma_f32_16x16x32_bf16 v[100:103], a[60:63], a[232:235], v[100:103]
    v_mfma_f32_16x16x32_bf16 v[100:103], a[84:87], a[236:239], v[100:103]
    buffer_load_dwordx4 a[216:219], v16, s[24:27], s44 offen offset:2048 sc1
    ds_write_b128 v18, v[84:87] offset:12544
    v_mfma_f32_16x16x32_bf16 v[104:107], a[64:67], a[232:235], v[104:107]
    v_mfma_f32_16x16x32_bf16 v[104:107], a[88:91], a[236:239], v[104:107]
    v_mfma_f32_16x16x32_bf16 v[108:111], a[68:71], a[232:235], v[108:111]
    v_mfma_f32_16x16x32_bf16 v[108:111], a[92:95], a[236:239], v[108:111]
    s_waitcnt vmcnt(11)
    v_mfma_f32_16x16x32_bf16 v[88:91], a[96:99], a[240:243], v[88:91]
    s_waitcnt vmcnt(10)
    v_mfma_f32_16x16x32_bf16 v[88:91], a[120:123], a[244:247], v[88:91]
    s_waitcnt lgkmcnt(0)
    s_barrier
    buffer_load_dwordx4 a[220:223], v16, s[24:27], s44 offen offset:3072 sc1
    v_mfma_f32_16x16x32_bf16 v[92:95], a[100:103], a[240:243], v[92:95]
    ds_read_b128 v[112:115], v46 offset:0
    v_mfma_f32_16x16x32_bf16 v[92:95], a[124:127], a[244:247], v[92:95]
    ds_read_b128 v[116:119], v46 offset:36864
    v_mfma_f32_16x16x32_bf16 v[96:99], a[104:107], a[240:243], v[96:99]
    ds_read_b128 v[120:123], v32 offset:0
    s_waitcnt vmcnt(6)
    v_cmp_ne_u64 vcc, v[24:25], v[56:57]
    s_nop 4
    s_cbranch_vccnz L_fo2_spin
L_fo2_ok:
    v_mfma_f32_16x16x32_bf16 v[96:99], a[128:131], a[244:247], v[96:99]
    ds_read_b128 v[124:127], v32 offset:36864
    v_mfma_f32_16x16x32_bf16 v[100:103], a[108:111], a[240:243], v[100:103]
    s_add_u32 s44, s97, 65536
    ds_read_b128 v[128:131], v47 offset:0
    v_mfma_f32_16x16x32_bf16 v[100:103], a[132:135], a[244:247], v[100:103]
    buffer_load_dwordx4 a[224:227], v16, s[24:27], s44 offen offset:0 sc1
    ds_read_b128 v[132:135], v47 offset:36864
    v_mfma_f32_16x16x32_bf16 v[104:107], a[112:115], a[240:243], v[104:107]
    ds_read_b128 v[136:139], v33 offset:0
    v_mfma_f32_16x16x32_bf16 v[104:107], a[136:139], a[244:247], v[104:107]
    ds_read_b128 v[140:143], v33 offset:36864
    v_mfma_f32_16x16x32_bf16 v[108:111], a[116:119], a[240:243], v[108:111]
    ds_read_b128 v[144:147], v48 offset:0
    v_mfma_f32_16x16x32_bf16 v[108:111], a[140:143], a[244:247], v[108:111]
    s_waitcnt vmcnt(11)
    s_waitcnt lgkmcnt(5)
    ds_read_b128 v[148:151], v48 offset:36864
    v_add_f32 v112, v112, v116
    v_mfma_f32_16x16x32_bf16 v[88:91], a[144:147], a[248:251], v[88:91]
    s_waitcnt vmcnt(10)
    ds_read_b128 v[152:155], v34 offset:0
    v_add_f32 v113, v113, v117
    v_mfma_f32_16x16x32_bf16 v[88:91], a[168:171], a[252:255], v[88:91]
    buffer_load_dwordx4 a[228:231], v16, s[24:27], s44 offen offset:1024 sc1
    ds_read_b128 v[156:159], v34 offset:36864
    v_mfma_f32_16x16x32_bf16 v[92:95], a[148:151], a[248:251], v[92:95]
    ds_read_b128 v[160:163], v49 offset:0
    v_add_f32 v114, v114, v118
    v_mfma_f32_16x16x32_bf16 v[92:95], a[172:175], a[252:255], v[92:95]
    ds_read_b128 v[164:167], v49 offset:36864
    v_add_f32 v115, v115, v119
    v_mfma_f32_16x16x32_bf16 v[96:99], a[152:155], a[248:251], v[96:99]
    ds_read_b128 v[168:171], v35 offset:0
    v_add_f32 v120, v120, v124
    v_mfma_f32_16x16x32_bf16 v[96:99], a[176:179], a[252:255], v[96:99]
    ds_read_b128 v[172:175], v35 offset:36864
    v_add_f32 v121, v121, v125
    v_mfma_f32_16x16x32_bf16 v[100:103], a[156:159], a[248:251], v[100:103]
    ds_read_b128 v[176:179], v50 offset:0
    v_add_f32 v122, v122, v126
    v_mfma_f32_16x16x32_bf16 v[100:103], a[180:183], a[252:255], v[100:103]
    buffer_load_dwordx4 a[232:235], v16, s[24:27], s44 offen offset:2048 sc1
    ds_read_b128 v[180:183], v50 offset:36864
    v_mfma_f32_16x16x32_bf16 v[104:107], a[160:163], a[248:251], v[104:107]
    ds_read_b128 v[184:187], v36 offset:0
    v_add_f32 v123, v123, v127
    v_mfma_f32_16x16x32_bf16 v[104:107], a[184:187], a[252:255], v[104:107]
    ds_read_b128 v[188:191], v36 offset:36864
    v_add_f32 v112, v112, v120
    v_mfma_f32_16x16x32_bf16 v[108:111], a[164:167], a[248:251], v[108:111]
    s_waitcnt lgkmcnt(15)
    v_add_f32 v113, v113, v121
    v_add_f32 v114, v114, v122
    v_mfma_f32_16x16x32_bf16 v[108:111], a[188:191], a[252:255], v[108:111]
    s_waitcnt vmcnt(11)
    v_add_f32 v115, v115, v123
    v_cvt_pk_bf16_f32 v116, v112, v113
    v_mfma_f32_16x16x32_bf16 v[64:67], a[0:3], a[192:195], 0
    s_waitcnt vmcnt(10)
    v_cvt_pk_bf16_f32 v117, v114, v115
    v_mfma_f32_16x16x32_bf16 v[64:67], a[24:27], a[196:199], v[64:67]
    s_waitcnt lgkmcnt(12)
    buffer_load_dwordx4 a[236:239], v16, s[24:27], s44 offen offset:3072 sc1
    v_add_f32 v128, v128, v132
    v_mfma_f32_16x16x32_bf16 v[68:71], a[4:7], a[192:195], 0
    v_add_f32 v129, v129, v133
    v_add_f32 v130, v130, v134
    v_mfma_f32_16x16x32_bf16 v[68:71], a[28:31], a[196:199], v[68:71]
    v_add_f32 v131, v131, v135
    v_add_f32 v136, v136, v140
    v_mfma_f32_16x16x32_bf16 v[72:75], a[8:11], a[192:195], 0
    v_add_f32 v137, v137, v141
    v_add_f32 v138, v138, v142
    v_mfma_f32_16x16x32_bf16 v[72:75], a[32:35], a[196:199], v[72:75]
    v_add_f32 v139, v139, v143
    v_add_f32 v128, v128, v136
    v_mfma_f32_16x16x32_bf16 v[76:79], a[12:15], a[192:195], 0
    s_add_u32 s44, s97, 69632
    v_add_f32 v129, v129, v137
    v_add_f32 v130, v130, v138
    v_mfma_f32_16x16x32_bf16 v[76:79], a[36:39], a[196:199], v[76:79]
    buffer_load_dwordx4 a[240:243], v16, s[24:27], s44 offen offset:0 sc1
    v_add_f32 v131, v131, v139
    v_mfma_f32_16x16x32_bf16 v[80:83], a[16:19], a[192:195], 0
    v_cvt_pk_bf16_f32 v118, v128, v129
    v_cvt_pk_bf16_f32 v119, v130, v131
    v_mfma_f32_16x16x32_bf16 v[80:83], a[40:43], a[196:199], v[80:83]
    s_waitcnt lgkmcnt(8)
    buffer_store_dwordx4 v[116:119], v16, s[24:27], s70 offen offset:0 sc1
    v_add_f32 v144, v144, v148
    v_mfma_f32_16x16x32_bf16 v[84:87], a[20:23], a[192:195], 0
    v_add_f32 v145, v145, v149
    v_add_f32 v146, v146, v150
    v_mfma_f32_16x16x32_bf16 v[84:87], a[44:47], a[196:199], v[84:87]
    s_waitcnt vmcnt(11)
    v_add_f32 v147, v147, v151
    v_add_f32 v152, v152, v156
    v_mfma_f32_16x16x32_bf16 v[64:67], a[48:51], a[200:203], v[64:67]
    s_waitcnt vmcnt(10)
    v_add_f32 v153, v153, v157
    v_add_f32 v154, v154, v158
    v_mfma_f32_16x16x32_bf16 v[64:67], a[72:75], a[204:207], v[64:67]
    buffer_load_dwordx4 a[244:247], v16, s[24:27], s44 offen offset:1024 sc1
    v_add_f32 v155, v155, v159
    v_mfma_f32_16x16x32_bf16 v[68:71], a[52:55], a[200:203], v[68:71]
    ds_write_b128 v19, v[88:91] offset:18432
    v_add_f32 v144, v144, v152
    v_mfma_f32_16x16x32_bf16 v[68:71], a[76:79], a[204:207], v[68:71]
    v_add_f32 v145, v145, v153
    v_add_f32 v146, v146, v154
    v_mfma_f32_16x16x32_bf16 v[72:75], a[56:59], a[200:203], v[72:75]
    v_add_f32 v147, v147, v155
    v_cvt_pk_bf16_f32 v148, v144, v145
    v_mfma_f32_16x16x32_bf16 v[72:75], a[80:83], a[204:207], v[72:75]
    v_cvt_pk_bf16_f32 v149, v146, v147
    v_mfma_f32_16x16x32_bf16 v[76:79], a[60:63], a[200:203], v[76:79]
    s_waitcnt lgkmcnt(5)
    ds_write_b128 v18, v[92:95] offset:18432
    v_add_f32 v160, v160, v164
    v_mfma_f32_16x16x32_bf16 v[76:79], a[84:87], a[204:207], v[76:79]
    buffer_load_dwordx4 a[248:251], v16, s[24:27], s44 offen offset:2048 sc1
    v_add_f32 v161, v161, v165
    v_mfma_f32_16x16x32_bf16 v[80:83], a[64:67], a[200:203], v[80:83]
    v_add_f32 v162, v162, v166
    v_add_f32 v163, v163, v167
    v_mfma_f32_16x16x32_bf16 v[80:83], a[88:91], a[204:207], v[80:83]
    v_add_f32 v168, v168, v172
    v_add_f32 v169, v169, v173
    v_mfma_f32_16x16x32_bf16 v[84:87], a[68:71], a[200:203], v[84:87]
    ds_write_b128 v19, v[96:99] offset:18560
    v_add_f32 v170, v170, v174
    v_mfma_f32_16x16x32_bf16 v[84:87], a[92:95], a[204:207], v[84:87]
    s_waitcnt vmcnt(11)
    v_add_f32 v171, v171, v175
    v_add_f32 v160, v160, v168
    v_mfma_f32_16x16x32_bf16 v[64:67], a[96:99], a[208:211], v[64:67]
    s_waitcnt vmcnt(10)
    v_add_f32 v161, v161, v169
    v_add_f32 v162, v162, v170
    v_mfma_f32_16x16x32_bf16 v[64:67], a[120:123], a[212:215], v[64:67]
    buffer_load_dwordx4 a[252:255], v16, s[24:27], s44 offen offset:3072 sc1
    v_add_f32 v163, v163, v171
    v_mfma_f32_16x16x32_bf16 v[68:71], a[100:103], a[208:211], v[68:71]
    ds_write_b128 v18, v[100:103] offset:18560
    v_cvt_pk_bf16_f32 v150, v160, v161
    v_mfma_f32_16x16x32_bf16 v[68:71], a[124:127], a[212:215], v[68:71]
    v_cvt_pk_bf16_f32 v151, v162, v163
    v_mfma_f32_16x16x32_bf16 v[72:75], a[104:107], a[208:211], v[72:75]
    s_waitcnt lgkmcnt(4)
    buffer_store_dwordx4 v[148:151], v16, s[24:27], s70 offen offset:1024 sc1
    v_add_f32 v176, v176, v180
    v_mfma_f32_16x16x32_bf16 v[72:75], a[128:131], a[212:215], v[72:75]
    v_add_f32 v177, v177, v181
    v_add_f32 v178, v178, v182
    v_mfma_f32_16x16x32_bf16 v[76:79], a[108:111], a[208:211], v[76:79]
    s_add_u32 s44, s98, 0
    ds_write_b128 v19, v[104:107] offset:18688
    v_add_f32 v179, v179, v183
    v_mfma_f32_16x16x32_bf16 v[76:79], a[132:135], a[212:215], v[76:79]
    buffer_load_dwordx4 a[192:195], v16, s[24:27], s44 offen offset:0 sc1
    v_add_f32 v184, v184, v188
    v_mfma_f32_16x16x32_bf16 v[80:83], a[112:115], a[208:211], v[80:83]
    v_add_f32 v185, v185, v189
    v_add_f32 v186, v186, v190
    v_mfma_f32_16x16x32_bf16 v[80:83], a[136:139], a[212:215], v[80:83]
    v_add_f32 v187, v187, v191
    v_add_f32 v176, v176, v184
    v_mfma_f32_16x16x32_bf16 v[84:87], a[116:119], a[208:211], v[84:87]
    ds_write_b128 v18, v[108:111] offset:18688
    v_add_f32 v177, v177, v185
    v_mfma_f32_16x16x32_bf16 v[84:87], a[140:143], a[212:215], v[84:87]
    s_waitcnt vmcnt(12)
    v_add_f32 v178, v178, v186
    v_add_f32 v179, v179, v187
    v_mfma_f32_16x16x32_bf16 v[64:67], a[144:147], a[216:219], v[64:67]
    s_waitcnt vmcnt(11)
    v_cvt_pk_bf16_f32 v180, v176, v177
    v_cvt_pk_bf16_f32 v181, v178, v179
    v_mfma_f32_16x16x32_bf16 v[64:67], a[168:171], a[220:223], v[64:67]
    buffer_load_dwordx4 a[196:199], v16, s[24:27], s44 offen offset:1024 sc1
    buffer_store_dwordx2 v[180:181], v37, s[24:27], s70 offen offset:2048 sc1
    v_mfma_f32_16x16x32_bf16 v[68:71], a[148:151], a[216:219], v[68:71]
    s_add_u32 s43, s63, 2
    v_mfma_f32_16x16x32_bf16 v[68:71], a[172:175], a[220:223], v[68:71]
    v_mfma_f32_16x16x32_bf16 v[72:75], a[152:155], a[216:219], v[72:75]
    s_and_b32 s43, s43, 3
    v_mfma_f32_16x16x32_bf16 v[72:75], a[176:179], a[220:223], v[72:75]
    v_mfma_f32_16x16x32_bf16 v[76:79], a[156:159], a[216:219], v[76:79]
    s_sub_u32 s43, s43, s63
    v_mfma_f32_16x16x32_bf16 v[76:79], a[180:183], a[220:223], v[76:79]
    buffer_load_dwordx4 a[200:203], v16, s[24:27], s44 offen offset:2048 sc1
    v_mfma_f32_16x16x32_bf16 v[80:83], a[160:163], a[216:219], v[80:83]
    s_mul_i32 s3, s43, 122880
    v_mfma_f32_16x16x32_bf16 v[80:83], a[184:187], a[220:223], v[80:83]
    v_mfma_f32_16x16x32_bf16 v[84:87], a[164:167], a[216:219], v[84:87]
    s_waitcnt lgkmcnt(0)
    s_add_u32 s3, s3, s79
    v_mfma_f32_16x16x32_bf16 v[84:87], a[188:191], a[220:223], v[84:87]
    s_waitcnt vmcnt(13)
    ds_write_b128 v19, v[64:67] offset:24576
    v_mfma_f32_16x16x32_bf16 v[88:91], a[0:3], a[224:227], 0
    s_waitcnt vmcnt(12)
    s_add_u32 s71, s3, 20480
    v_mfma_f32_16x16x32_bf16 v[88:91], a[24:27], a[228:231], v[88:91]
    buffer_load_dwordx4 a[204:207], v16, s[24:27], s44 offen offset:3072 sc1
    v_mfma_f32_16x16x32_bf16 v[92:95], a[4:7], a[224:227], 0
    s_lshl_b32 s43, s43, 1
    v_mfma_f32_16x16x32_bf16 v[92:95], a[28:31], a[228:231], v[92:95]
    ds_write_b128 v18, v[68:71] offset:24576
    v_mfma_f32_16x16x32_bf16 v[96:99], a[8:11], a[224:227], 0
    s_add_u32 s43, s43, s2
    v_mfma_f32_16x16x32_bf16 v[96:99], a[32:35], a[228:231], v[96:99]
    v_mfma_f32_16x16x32_bf16 v[100:103], a[12:15], a[224:227], 0
    s_add_u32 s44, s98, 4096
    s_lshl_b32 s43, s43, 11
    v_mfma_f32_16x16x32_bf16 v[100:103], a[36:39], a[228:231], v[100:103]
    buffer_load_dwordx4 a[208:211], v16, s[24:27], s44 offen offset:0 sc1
    ds_write_b128 v19, v[72:75] offset:24704
    v_mfma_f32_16x16x32_bf16 v[104:107], a[16:19], a[224:227], 0
    s_add_u32 s43, s43, 17301632
    v_mfma_f32_16x16x32_bf16 v[104:107], a[40:43], a[228:231], v[104:107]
    v_mfma_f32_16x16x32_bf16 v[108:111], a[20:23], a[224:227], 0
    s_lshl_b32 s45, s40, 9
    v_mfma_f32_16x16x32_bf16 v[108:111], a[44:47], a[228:231], v[108:111]
    s_waitcnt vmcnt(13)
    ds_write_b128 v18, v[76:79] offset:24704
    v_mfma_f32_16x16x32_bf16 v[88:91], a[48:51], a[232:235], v[88:91]
    s_waitcnt vmcnt(12)
    s_add_u32 s73, s43, s45
    v_mfma_f32_16x16x32_bf16 v[88:91], a[72:75], a[236:239], v[88:91]
    buffer_load_dwordx4 a[212:215], v16, s[24:27], s44 offen offset:1024 sc1
    v_mfma_f32_16x16x32_bf16 v[92:95], a[52:55], a[232:235], v[92:95]
    v_mfma_f32_16x16x32_bf16 v[92:95], a[76:79], a[236:239], v[92:95]
    ds_write_b128 v19, v[80:83] offset:24832
    v_mfma_f32_16x16x32_bf16 v[96:99], a[56:59], a[232:235], v[96:99]
    v_mfma_f32_16x16x32_bf16 v[96:99], a[80:83], a[236:239], v[96:99]
    v_mfma_f32_16x16x32_bf16 v[100:103], a[60:63], a[232:235], v[100:103]
    v_mfma_f32_16x16x32_bf16 v[100:103], a[84:87], a[236:239], v[100:103]
    buffer_load_dwordx4 a[216:219], v16, s[24:27], s44 offen offset:2048 sc1
    ds_write_b128 v18, v[84:87] offset:24832
    v_mfma_f32_16x16x32_bf16 v[104:107], a[64:67], a[232:235], v[104:107]
    v_mfma_f32_16x16x32_bf16 v[104:107], a[88:91], a[236:239], v[104:107]
    v_mfma_f32_16x16x32_bf16 v[108:111], a[68:71], a[232:235], v[108:111]
    v_mfma_f32_16x16x32_bf16 v[108:111], a[92:95], a[236:239], v[108:111]
    s_waitcnt vmcnt(13)
    v_mfma_f32_16x16x32_bf16 v[88:91], a[96:99], a[240:243], v[88:91]
    s_waitcnt vmcnt(11)
    v_mfma_f32_16x16x32_bf16 v[88:91], a[120:123], a[244:247], v[88:91]
    buffer_load_dwordx4 a[220:223], v16, s[24:27], s44 offen offset:3072 sc1
    v_mfma_f32_16x16x32_bf16 v[92:95], a[100:103], a[240:243], v[92:95]
    v_mfma_f32_16x16x32_bf16 v[92:95], a[124:127], a[244:247], v[92:95]
    v_mfma_f32_16x16x32_bf16 v[96:99], a[104:107], a[240:243], v[96:99]
    v_mfma_f32_16x16x32_bf16 v[96:99], a[128:131], a[244:247], v[96:99]
    v_mfma_f32_16x16x32_bf16 v[100:103], a[108:111], a[240:243], v[100:103]
    s_add_u32 s44, s98, 32768
    v_mfma_f32_16x16x32_bf16 v[100:103], a[132:135], a[244:247], v[100:103]
    buffer_load_dwordx4 a[224:227], v16, s[24:27], s44 offen offset:0 sc1
    v_mfma_f32_16x16x32_bf16 v[104:107], a[112:115], a[240:243], v[104:107]
    v_mfma_f32_16x16x32_bf16 v[104:107], a[136:139], a[244:247], v[104:107]
    v_mfma_f32_16x16x32_bf16 v[108:111], a[116:119], a[240:243], v[108:111]
    v_mfma_f32_16x16x32_bf16 v[108:111], a[140:143], a[244:247], v[108:111]
    s_waitcnt vmcnt(12)
    v_mfma_f32_16x16x32_bf16 v[88:91], a[144:147], a[248:251], v[88:91]
    s_waitcnt vmcnt(11)
    v_mfma_f32_16x16x32_bf16 v[88:91], a[168:171], a[252:255], v[88:91]
    buffer_load_dwordx4 a[228:231], v16, s[24:27], s44 offen offset:1024 sc1
    v_mfma_f32_16x16x32_bf16 v[92:95], a[148:151], a[248:251], v[92:95]
    v_mfma_f32_16x16x32_bf16 v[92:95], a[172:175], a[252:255], v[92:95]
    s_waitcnt vmcnt(8)
    buffer_store_dwordx2 v[56:57], v17, s[24:27], s72 offen sc1
    v_mfma_f32_16x16x32_bf16 v[96:99], a[152:155], a[248:251], v[96:99]
    v_mfma_f32_16x16x32_bf16 v[96:99], a[176:179], a[252:255], v[96:99]
    v_mfma_f32_16x16x32_bf16 v[100:103], a[156:159], a[248:251], v[100:103]
    v_mfma_f32_16x16x32_bf16 v[100:103], a[180:183], a[252:255], v[100:103]
    buffer_load_dwordx4 a[232:235], v16, s[24:27], s44 offen offset:2048 sc1
    v_mfma_f32_16x16x32_bf16 v[104:107], a[160:163], a[248:251], v[104:107]
    v_mfma_f32_16x16x32_bf16 v[104:107], a[184:187], a[252:255], v[104:107]
    v_mfma_f32_16x16x32_bf16 v[108:111], a[164:167], a[248:251], v[108:111]
    s_waitcnt lgkmcnt(0)
    v_mfma_f32_16x16x32_bf16 v[108:111], a[188:191], a[252:255], v[108:111]
    s_waitcnt vmcnt(12)
    ds_write_b128 v19, v[88:91] offset:30720
    v_mfma_f32_16x16x32_bf16 v[64:67], a[0:3], a[192:195], 0
    s_waitcnt vmcnt(11)
    v_mfma_f32_16x16x32_bf16 v[64:67], a[24:27], a[196:199], v[64:67]
    buffer_load_dwordx4 a[236:239], v16, s[24:27], s44 offen offset:3072 sc1
    v_mfma_f32_16x16x32_bf16 v[68:71], a[4:7], a[192:195], 0
    v_mfma_f32_16x16x32_bf16 v[68:71], a[28:31], a[196:199], v[68:71]
    ds_write_b128 v18, v[92:95] offset:30720
    v_mfma_f32_16x16x32_bf16 v[72:75], a[8:11], a[192:195], 0
    v_mfma_f32_16x16x32_bf16 v[72:75], a[32:35], a[196:199], v[72:75]
    v_mfma_f32_16x16x32_bf16 v[76:79], a[12:15], a[192:195], 0
    s_add_u32 s44, s98, 36864
    v_mfma_f32_16x16x32_bf16 v[76:79], a[36:39], a[196:199], v[76:79]
    buffer_load_dwordx4 a[240:243], v16, s[24:27], s44 offen offset:0 sc1
    ds_write_b128 v19, v[96:99] offset:30848
    v_mfma_f32_16x16x32_bf16 v[80:83], a[16:19], a[192:195], 0
    v_mfma_f32_16x16x32_bf16 v[80:83], a[40:43], a[196:199], v[80:83]
    v_mfma_f32_16x16x32_bf16 v[84:87], a[20:23], a[192:195], 0
    v_mfma_f32_16x16x32_bf16 v[84:87], a[44:47], a[196:199], v[84:87]
    s_waitcnt vmcnt(11)
    ds_write_b128 v18, v[100:103] offset:30848
    v_mfma_f32_16x16x32_bf16 v[64:67], a[48:51], a[200:203], v[64:67]
    s_waitcnt vmcnt(10)
    v_mfma_f32_16x16x32_bf16 v[64:67], a[72:75], a[204:207], v[64:67]
    buffer_load_dwordx4 a[244:247], v16, s[24:27], s44 offen offset:1024 sc1
    v_mfma_f32_16x16x32_bf16 v[68:71], a[52:55], a[200:203], v[68:71]
    v_mfma_f32_16x16x32_bf16 v[68:71], a[76:79], a[204:207], v[68:71]
    ds_write_b128 v19, v[104:107] offset:30976
    v_mfma_f32_16x16x32_bf16 v[72:75], a[56:59], a[200:203], v[72:75]
    v_mfma_f32_16x16x32_bf16 v[72:75], a[80:83], a[204:207], v[72:75]
    v_mfma_f32_16x16x32_bf16 v[76:79], a[60:63], a[200:203], v[76:79]
    v_mfma_f32_16x16x32_bf16 v[76:79], a[84:87], a[204:207], v[76:79]
    buffer_load_dwordx4 a[248:251], v16, s[24:27], s44 offen offset:2048 sc1
    ds_write_b128 v18, v[108:111] offset:30976
    v_mfma_f32_16x16x32_bf16 v[80:83], a[64:67], a[200:203], v[80:83]
    v_mfma_f32_16x16x32_bf16 v[80:83], a[88:91], a[204:207], v[80:83]
    v_mfma_f32_16x16x32_bf16 v[84:87], a[68:71], a[200:203], v[84:87]
    v_mfma_f32_16x16x32_bf16 v[84:87], a[92:95], a[204:207], v[84:87]
    s_waitcnt vmcnt(11)
    v_mfma_f32_16x16x32_bf16 v[64:67], a[96:99], a[208:211], v[64:67]
    s_waitcnt vmcnt(10)
    v_mfma_f32_16x16x32_bf16 v[64:67], a[120:123], a[212:215], v[64:67]
    s_waitcnt lgkmcnt(0)
    s_barrier
    buffer_load_dwordx4 a[252:255], v16, s[24:27], s44 offen offset:3072 sc1
    v_mfma_f32_16x16x32_bf16 v[68:71], a[100:103], a[208:211], v[68:71]
    ds_read_b128 v[112:115], v46 offset:18432
    v_mfma_f32_16x16x32_bf16 v[68:71], a[124:127], a[212:215], v[68:71]
    ds_read_b128 v[116:119], v46 offset:55296
    v_mfma_f32_16x16x32_bf16 v[72:75], a[104:107], a[208:211], v[72:75]
    ds_read_b128 v[120:123], v32 offset:18432
    v_mfma_f32_16x16x32_bf16 v[72:75], a[128:131], a[212:215], v[72:75]
    ds_read_b128 v[124:127], v32 offset:55296
    v_mfma_f32_16x16x32_bf16 v[76:79], a[108:111], a[208:211], v[76:79]
    s_add_u32 s44, s98, 65536
    ds_read_b128 v[128:131], v47 offset:18432
    v_mfma_f32_16x16x32_bf16 v[76:79], a[132:135], a[212:215], v[76:79]
    buffer_load_dwordx4 a[192:195], v16, s[24:27], s44 offen offset:0 sc1
    ds_read_b128 v[132:135], v47 offset:55296
    v_mfma_f32_16x16x32_bf16 v[80:83], a[112:115], a[208:211], v[80:83]
    ds_read_b128 v[136:139], v33 offset:18432
    v_mfma_f32_16x16x32_bf16 v[80:83], a[136:139], a[212:215], v[80:83]
    ds_read_b128 v[140:143], v33 offset:55296
    v_mfma_f32_16x16x32_bf16 v[84:87], a[116:119], a[208:211], v[84:87]
    ds_read_b128 v[144:147], v48 offset:18432
    v_mfma_f32_16x16x32_bf16 v[84:87], a[140:143], a[212:215], v[84:87]
    s_waitcnt vmcnt(11)
    s_waitcnt lgkmcnt(5)
    ds_read_b128 v[148:151], v48 offset:55296
    v_add_f32 v112, v112, v116
    v_mfma_f32_16x16x32_bf16 v[64:67], a[144:147], a[216:219], v[64:67]
    s_waitcnt vmcnt(10)
    ds_read_b128 v[152:155], v34 offset:18432
    v_add_f32 v113, v113, v117
    v_mfma_f32_16x16x32_bf16 v[64:67], a[168:171], a[220:223], v[64:67]
    buffer_load_dwordx4 a[196:199], v16, s[24:27], s44 offen offset:1024 sc1
    ds_read_b128 v[156:159], v34 offset:55296
    v_mfma_f32_16x16x32_bf16 v[68:71], a[148:151], a[216:219], v[68:71]
    ds_read_b128 v[160:163], v49 offset:18432
    v_add_f32 v114, v114, v118
    v_mfma_f32_16x16x32_bf16 v[68:71], a[172:175], a[220:223], v[68:71]
    ds_read_b128 v[164:167], v49 offset:55296
    v_add_f32 v115, v115, v119
    v_mfma_f32_16x16x32_bf16 v[72:75], a[152:155], a[216:219], v[72:75]
    ds_read_b128 v[168:171], v35 offset:18432
    v_add_f32 v120, v120, v124
    v_mfma_f32_16x16x32_bf16 v[72:75], a[176:179], a[220:223], v[72:75]
    ds_read_b128 v[172:175], v35 offset:55296
    v_add_f32 v121, v121, v125
    v_mfma_f32_16x16x32_bf16 v[76:79], a[156:159], a[216:219], v[76:79]
    ds_read_b128 v[176:179], v50 offset:18432
    v_add_f32 v122, v122, v126
    v_mfma_f32_16x16x32_bf16 v[76:79], a[180:183], a[220:223], v[76:79]
    buffer_load_dwordx4 a[200:203], v16, s[24:27], s44 offen offset:2048 sc1
    ds_read_b128 v[180:183], v50 offset:55296
    v_mfma_f32_16x16x32_bf16 v[80:83], a[160:163], a[216:219], v[80:83]
    ds_read_b128 v[184:187], v36 offset:18432
    v_add_f32 v123, v123, v127
    v_mfma_f32_16x16x32_bf16 v[80:83], a[184:187], a[220:223], v[80:83]
    ds_read_b128 v[188:191], v36 offset:55296
    v_add_f32 v112, v112, v120
    v_mfma_f32_16x16x32_bf16 v[84:87], a[164:167], a[216:219], v[84:87]
    s_waitcnt lgkmcnt(15)
    v_add_f32 v113, v113, v121
    v_add_f32 v114, v114, v122
    v_mfma_f32_16x16x32_bf16 v[84:87], a[188:191], a[220:223], v[84:87]
    s_waitcnt vmcnt(11)
    v_add_f32 v115, v115, v123
    v_cvt_pk_bf16_f32 v116, v112, v113
    v_mfma_f32_16x16x32_bf16 v[88:91], a[0:3], a[224:227], 0
    s_waitcnt vmcnt(10)
    v_cvt_pk_bf16_f32 v117, v114, v115
    v_mfma_f32_16x16x32_bf16 v[88:91], a[24:27], a[228:231], v[88:91]
    s_waitcnt lgkmcnt(12)
    buffer_load_dwordx4 a[204:207], v16, s[24:27], s44 offen offset:3072 sc1
    v_add_f32 v128, v128, v132
    v_mfma_f32_16x16x32_bf16 v[92:95], a[4:7], a[224:227], 0
    v_add_f32 v129, v129, v133
    v_add_f32 v130, v130, v134
    v_mfma_f32_16x16x32_bf16 v[92:95], a[28:31], a[228:231], v[92:95]
    v_add_f32 v131, v131, v135
    v_add_f32 v136, v136, v140
    v_mfma_f32_16x16x32_bf16 v[96:99], a[8:11], a[224:227], 0
    v_add_f32 v137, v137, v141
    v_add_f32 v138, v138, v142
    v_mfma_f32_16x16x32_bf16 v[96:99], a[32:35], a[228:231], v[96:99]
    v_add_f32 v139, v139, v143
    v_add_f32 v128, v128, v136
    v_mfma_f32_16x16x32_bf16 v[100:103], a[12:15], a[224:227], 0
    s_add_u32 s44, s98, 69632
    v_add_f32 v129, v129, v137
    v_add_f32 v130, v130, v138
    v_mfma_f32_16x16x32_bf16 v[100:103], a[36:39], a[228:231], v[100:103]
    buffer_load_dwordx4 a[208:211], v16, s[24:27], s44 offen offset:0 sc1
    v_add_f32 v131, v131, v139
    v_mfma_f32_16x16x32_bf16 v[104:107], a[16:19], a[224:227], 0
    v_cvt_pk_bf16_f32 v118, v128, v129
    v_cvt_pk_bf16_f32 v119, v130, v131
    v_mfma_f32_16x16x32_bf16 v[104:107], a[40:43], a[228:231], v[104:107]
    s_waitcnt lgkmcnt(8)
    buffer_store_dwordx4 v[116:119], v16, s[24:27], s71 offen offset:0 sc1
    v_add_f32 v144, v144, v148
    v_mfma_f32_16x16x32_bf16 v[108:111], a[20:23], a[224:227], 0
    v_add_f32 v145, v145, v149
    v_add_f32 v146, v146, v150
    v_mfma_f32_16x16x32_bf16 v[108:111], a[44:47], a[228:231], v[108:111]
    s_waitcnt vmcnt(11)
    v_add_f32 v147, v147, v151
    v_add_f32 v152, v152, v156
    v_mfma_f32_16x16x32_bf16 v[88:91], a[48:51], a[232:235], v[88:91]
    s_waitcnt vmcnt(10)
    v_add_f32 v153, v153, v157
    v_add_f32 v154, v154, v158
    v_mfma_f32_16x16x32_bf16 v[88:91], a[72:75], a[236:239], v[88:91]
    buffer_load_dwordx4 a[212:215], v16, s[24:27], s44 offen offset:1024 sc1
    v_add_f32 v155, v155, v159
    v_mfma_f32_16x16x32_bf16 v[92:95], a[52:55], a[232:235], v[92:95]
    ds_write_b128 v19, v[64:67] offset:0
    v_add_f32 v144, v144, v152
    v_mfma_f32_16x16x32_bf16 v[92:95], a[76:79], a[236:239], v[92:95]
    v_add_f32 v145, v145, v153
    v_add_f32 v146, v146, v154
    v_mfma_f32_16x16x32_bf16 v[96:99], a[56:59], a[232:235], v[96:99]
    v_add_f32 v147, v147, v155
    v_cvt_pk_bf16_f32 v148, v144, v145
    v_mfma_f32_16x16x32_bf16 v[96:99], a[80:83], a[236:239], v[96:99]
    v_cvt_pk_bf16_f32 v149, v146, v147
    v_mfma_f32_16x16x32_bf16 v[100:103], a[60:63], a[232:235], v[100:103]
    s_waitcnt lgkmcnt(5)
    ds_write_b128 v18, v[68:71] offset:0
    v_add_f32 v160, v160, v164
    v_mfma_f32_16x16x32_bf16 v[100:103], a[84:87], a[236:239], v[100:103]
    buffer_load_dwordx4 a[216:219], v16, s[24:27], s44 offen offset:2048 sc1
    v_add_f32 v161, v161, v165
    v_mfma_f32_16x16x32_bf16 v[104:107], a[64:67], a[232:235], v[104:107]
    v_add_f32 v162, v162, v166
    v_add_f32 v163, v163, v167
    v_mfma_f32_16x16x32_bf16 v[104:107], a[88:91], a[236:239], v[104:107]
    v_add_f32 v168, v168, v172
    v_add_f32 v169, v169, v173
    v_mfma_f32_16x16x32_bf16 v[108:111], a[68:71], a[232:235], v[108:111]
    ds_write_b128 v19, v[72:75] offset:128
    v_add_f32 v170, v170, v174
    v_mfma_f32_16x16x32_bf16 v[108:111], a[92:95], a[236:239], v[108:111]
    s_waitcnt vmcnt(11)
    v_add_f32 v171, v171, v175
    v_add_f32 v160, v160, v168
    v_mfma_f32_16x16x32_bf16 v[88:91], a[96:99], a[240:243], v[88:91]
    s_waitcnt vmcnt(10)
    v_add_f32 v161, v161, v169
    v_add_f32 v162, v162, v170
    v_mfma_f32_16x16x32_bf16 v[88:91], a[120:123], a[244:247], v[88:91]
    buffer_load_dwordx4 a[220:223], v16, s[24:27], s44 offen offset:3072 sc1
    v_add_f32 v163, v163, v171
    v_mfma_f32_16x16x32_bf16 v[92:95], a[100:103], a[240:243], v[92:95]
    ds_write_b128 v18, v[76:79] offset:128
    v_cvt_pk_bf16_f32 v150, v160, v161
    v_mfma_f32_16x16x32_bf16 v[92:95], a[124:127], a[244:247], v[92:95]
    v_cvt_pk_bf16_f32 v151, v162, v163
    v_mfma_f32_16x16x32_bf16 v[96:99], a[104:107], a[240:243], v[96:99]
    s_waitcnt lgkmcnt(4)
    buffer_store_dwordx4 v[148:151], v16, s[24:27], s71 offen offset:1024 sc1
    v_add_f32 v176, v176, v180
    v_mfma_f32_16x16x32_bf16 v[96:99], a[128:131], a[244:247], v[96:99]
    v_add_f32 v177, v177, v181
    v_add_f32 v178, v178, v182
    v_mfma_f32_16x16x32_bf16 v[100:103], a[108:111], a[240:243], v[100:103]
    s_add_u32 s44, s99, 0
    ds_write_b128 v19, v[80:83] offset:256
    v_add_f32 v179, v179, v183
    v_mfma_f32_16x16x32_bf16 v[100:103], a[132:135], a[244:247], v[100:103]
    buffer_load_dwordx4 a[224:227], v16, s[24:27], s44 offen offset:0 sc1
    v_add_f32 v184, v184, v188
    v_mfma_f32_16x16x32_bf16 v[104:107], a[112:115], a[240:243], v[104:107]
    v_add_f32 v185, v185, v189
    v_add_f32 v186, v186, v190
    v_mfma_f32_16x16x32_bf16 v[104:107], a[136:139], a[244:247], v[104:107]
    v_add_f32 v187, v187, v191
    v_add_f32 v176, v176, v184
    v_mfma_f32_16x16x32_bf16 v[108:111], a[116:119], a[240:243], v[108:111]
    ds_write_b128 v18, v[84:87] offset:256
    v_add_f32 v177, v177, v185
    v_mfma_f32_16x16x32_bf16 v[108:111], a[140:143], a[244:247], v[108:111]
    s_waitcnt vmcnt(12)
    v_add_f32 v178, v178, v186
    v_add_f32 v179, v179, v187
    v_mfma_f32_16x16x32_bf16 v[88:91], a[144:147], a[248:251], v[88:91]
    s_waitcnt vmcnt(11)
    v_cvt_pk_bf16_f32 v180, v176, v177
    v_cvt_pk_bf16_f32 v181, v178, v179
    v_mfma_f32_16x16x32_bf16 v[88:91], a[168:171], a[252:255], v[88:91]
    buffer_load_dwordx4 a[228:231], v16, s[24:27], s44 offen offset:1024 sc1
    buffer_store_dwordx2 v[180:181], v37, s[24:27], s71 offen offset:2048 sc1
    v_mfma_f32_16x16x32_bf16 v[92:95], a[148:151], a[248:251], v[92:95]
    s_add_u32 s43, s63, 3
    v_mfma_f32_16x16x32_bf16 v[92:95], a[172:175], a[252:255], v[92:95]
    v_mfma_f32_16x16x32_bf16 v[96:99], a[152:155], a[248:251], v[96:99]
    s_and_b32 s43, s43, 3
    v_mfma_f32_16x16x32_bf16 v[96:99], a[176:179], a[252:255], v[96:99]
    v_mfma_f32_16x16x32_bf16 v[100:103], a[156:159], a[248:251], v[100:103]
    s_sub_u32 s43, s43, s63
    v_mfma_f32_16x16x32_bf16 v[100:103], a[180:183], a[252:255], v[100:103]
    buffer_load_dwordx4 a[232:235], v16, s[24:27], s44 offen offset:2048 sc1
    v_mfma_f32_16x16x32_bf16 v[104:107], a[160:163], a[248:251], v[104:107]
    s_mul_i32 s3, s43, 122880
    v_mfma_f32_16x16x32_bf16 v[104:107], a[184:187], a[252:255], v[104:107]
    v_mfma_f32_16x16x32_bf16 v[108:111], a[164:167], a[248:251], v[108:111]
    s_waitcnt lgkmcnt(0)
    s_add_u32 s3, s3, s79
    v_mfma_f32_16x16x32_bf16 v[108:111], a[188:191], a[252:255], v[108:111]
    s_waitcnt vmcnt(13)
    ds_write_b128 v19, v[88:91] offset:6144
    v_mfma_f32_16x16x32_bf16 v[64:67], a[0:3], a[192:195], 0
    s_waitcnt vmcnt(12)
    s_add_u32 s70, s3, 40960
    v_mfma_f32_16x16x32_bf16 v[64:67], a[24:27], a[196:199], v[64:67]
    buffer_load_dwordx4 a[236:239], v16, s[24:27], s44 offen offset:3072 sc1
    v_mfma_f32_16x16x32_bf16 v[68:71], a[4:7], a[192:195], 0
    s_lshl_b32 s43, s43, 1
    v_mfma_f32_16x16x32_bf16 v[68:71], a[28:31], a[196:199], v[68:71]
    s_add_u32 s44, s99, 4096
    ds_write_b128 v18, v[92:95] offset:6144
    v_mfma_f32_16x16x32_bf16 v[72:75], a[8:11], a[192:195], 0
    s_add_u32 s43, s43, s2
    buffer_load_dwordx4 a[240:243], v16, s[24:27], s44 offen offset:0 sc1
    v_mfma_f32_16x16x32_bf16 v[72:75], a[32:35], a[196:199], v[72:75]
    v_mfma_f32_16x16x32_bf16 v[76:79], a[12:15], a[192:195], 0
    s_lshl_b32 s43, s43, 11
    v_mfma_f32_16x16x32_bf16 v[76:79], a[36:39], a[196:199], v[76:79]
    buffer_load_dwordx4 a[244:247], v16, s[24:27], s44 offen offset:1024 sc1
    ds_write_b128 v19, v[96:99] offset:6272
    v_mfma_f32_16x16x32_bf16 v[80:83], a[16:19], a[192:195], 0
    s_add_u32 s43, s43, 17301760
    v_mfma_f32_16x16x32_bf16 v[80:83], a[40:43], a[196:199], v[80:83]
    v_mfma_f32_16x16x32_bf16 v[84:87], a[20:23], a[192:195], 0
    s_lshl_b32 s45, s40, 9
    v_mfma_f32_16x16x32_bf16 v[84:87], a[44:47], a[196:199], v[84:87]
    s_waitcnt vmcnt(14)
    ds_write_b128 v18, v[100:103] offset:6272
    v_mfma_f32_16x16x32_bf16 v[64:67], a[48:51], a[200:203], v[64:67]
    s_waitcnt vmcnt(13)
    s_add_u32 s72, s43, s45
    v_mfma_f32_16x16x32_bf16 v[64:67], a[72:75], a[204:207], v[64:67]
    buffer_load_dwordx4 a[248:251], v16, s[24:27], s44 offen offset:2048 sc1
    v_mfma_f32_16x16x32_bf16 v[68:71], a[52:55], a[200:203], v[68:71]
    v_mfma_f32_16x16x32_bf16 v[68:71], a[76:79], a[204:207], v[68:71]
    ds_write_b128 v19, v[104:107] offset:6400
    v_mfma_f32_16x16x32_bf16 v[72:75], a[56:59], a[200:203], v[72:75]
    buffer_load_dwordx4 a[252:255], v16, s[24:27], s44 offen offset:3072 sc1
    v_mfma_f32_16x16x32_bf16 v[72:75], a[80:83], a[204:207], v[72:75]
    v_mfma_f32_16x16x32_bf16 v[76:79], a[60:63], a[200:203], v[76:79]
    s_add_u32 s44, s99, 32768
    v_mfma_f32_16x16x32_bf16 v[76:79], a[84:87], a[204:207], v[76:79]
    buffer_load_dwordx4 a[192:195], v16, s[24:27], s44 offen offset:0 sc1
    ds_write_b128 v18, v[108:111] offset:6400
    v_mfma_f32_16x16x32_bf16 v[80:83], a[64:67], a[200:203], v[80:83]
    v_mfma_f32_16x16x32_bf16 v[80:83], a[88:91], a[204:207], v[80:83]
    v_mfma_f32_16x16x32_bf16 v[84:87], a[68:71], a[200:203], v[84:87]
    v_mfma_f32_16x16x32_bf16 v[84:87], a[92:95], a[204:207], v[84:87]
    s_waitcnt vmcnt(15)
    v_mfma_f32_16x16x32_bf16 v[64:67], a[96:99], a[208:211], v[64:67]
    s_waitcnt vmcnt(13)
    v_mfma_f32_16x16x32_bf16 v[64:67], a[120:123], a[212:215], v[64:67]
    s_waitcnt lgkmcnt(0)
    s_barrier
    buffer_load_dwordx4 a[196:199], v16, s[24:27], s44 offen offset:1024 sc1
    v_mfma_f32_16x16x32_bf16 v[68:71], a[100:103], a[208:211], v[68:71]
    ds_read_b128 v[112:115], v46 offset:0
    v_mfma_f32_16x16x32_bf16 v[68:71], a[124:127], a[212:215], v[68:71]
    ds_read_b128 v[116:119], v46 offset:36864
    v_mfma_f32_16x16x32_bf16 v[72:75], a[104:107], a[208:211], v[72:75]
    buffer_load_dwordx4 a[200:203], v16, s[24:27], s44 offen offset:2048 sc1
    ds_read_b128 v[120:123], v32 offset:0
    v_mfma_f32_16x16x32_bf16 v[72:75], a[128:131], a[212:215], v[72:75]
    ds_read_b128 v[124:127], v32 offset:36864
    v_mfma_f32_16x16x32_bf16 v[76:79], a[108:111], a[208:211], v[76:79]
    ds_read_b128 v[128:131], v47 offset:0
    v_mfma_f32_16x16x32_bf16 v[76:79], a[132:135], a[212:215], v[76:79]
    buffer_load_dwordx4 a[204:207], v16, s[24:27], s44 offen offset:3072 sc1
    ds_read_b128 v[132:135], v47 offset:36864
    v_mfma_f32_16x16x32_bf16 v[80:83], a[112:115], a[208:211], v[80:83]
    ds_read_b128 v[136:139], v33 offset:0
    v_mfma_f32_16x16x32_bf16 v[80:83], a[136:139], a[212:215], v[80:83]
    ds_read_b128 v[140:143], v33 offset:36864
    v_mfma_f32_16x16x32_bf16 v[84:87], a[116:119], a[208:211], v[84:87]
    ds_read_b128 v[144:147], v48 offset:0
    v_mfma_f32_16x16x32_bf16 v[84:87], a[140:143], a[212:215], v[84:87]
    s_waitcnt vmcnt(15)
    s_waitcnt lgkmcnt(5)
    ds_read_b128 v[148:151], v48 offset:36864
    v_add_f32 v112, v112, v116
    v_mfma_f32_16x16x32_bf16 v[64:67], a[144:147], a[216:219], v[64:67]
    s_waitcnt vmcnt(14)
    s_add_u32 s44, s99, 36864
    ds_read_b128 v[152:155], v34 offset:0
    v_add_f32 v113, v113, v117
    v_mfma_f32_16x16x32_bf16 v[64:67], a[168:171], a[220:223], v[64:67]
    buffer_load_dwordx4 a[208:211], v16, s[24:27], s44 offen offset:0 sc1
    ds_read_b128 v[156:159], v34 offset:36864
    v_mfma_f32_16x16x32_bf16 v[68:71], a[148:151], a[216:219], v[68:71]
    v_add_f32 v114, v114, v118
    v_add_f32 v115, v115, v119
    v_mfma_f32_16x16x32_bf16 v[68:71], a[172:175], a[220:223], v[68:71]
    s_waitcnt vmcnt(11)
    buffer_store_dwordx2 v[56:57], v17, s[24:27], s73 offen sc1
    v_add_f32 v120, v120, v124
    v_mfma_f32_16x16x32_bf16 v[72:75], a[152:155], a[216:219], v[72:75]
    v_add_f32 v121, v121, v125
    v_add_f32 v122, v122, v126
    v_mfma_f32_16x16x32_bf16 v[72:75], a[176:179], a[220:223], v[72:75]
    v_add_f32 v123, v123, v127
    v_add_f32 v112, v112, v120
    v_mfma_f32_16x16x32_bf16 v[76:79], a[156:159], a[216:219], v[76:79]
    v_add_f32 v113, v113, v121
    v_add_f32 v114, v114, v122
    v_mfma_f32_16x16x32_bf16 v[76:79], a[180:183], a[220:223], v[76:79]
    buffer_load_dwordx4 a[212:215], v16, s[24:27], s44 offen offset:1024 sc1
    v_add_f32 v115, v115, v123
    v_mfma_f32_16x16x32_bf16 v[80:83], a[160:163], a[216:219], v[80:83]
    v_cvt_pk_bf16_f32 v116, v112, v113
    v_cvt_pk_bf16_f32 v117, v114, v115
    v_mfma_f32_16x16x32_bf16 v[80:83], a[184:187], a[220:223], v[80:83]
    s_waitcnt lgkmcnt(4)
    v_add_f32 v128, v128, v132
    v_add_f32 v129, v129, v133
    v_mfma_f32_16x16x32_bf16 v[84:87], a[164:167], a[216:219], v[84:87]
    s_waitcnt lgkmcnt(12)
    v_add_f32 v130, v130, v134
    v_add_f32 v131, v131, v135
    v_mfma_f32_16x16x32_bf16 v[84:87], a[188:191], a[220:223], v[84:87]
    s_waitcnt vmcnt(15)
    ds_write_b128 v19, v[64:67] offset:12288
    v_add_f32 v136, v136, v140
    v_mfma_f32_16x16x32_bf16 v[88:91], a[0:3], a[224:227], 0
    s_waitcnt vmcnt(14)
    v_add_f32 v137, v137, v141
    v_add_f32 v138, v138, v142
    v_mfma_f32_16x16x32_bf16 v[88:91], a[24:27], a[228:231], v[88:91]
    buffer_load_dwordx4 a[216:219], v16, s[24:27], s44 offen offset:2048 sc1
    v_add_f32 v139, v139, v143
    v_mfma_f32_16x16x32_bf16 v[92:95], a[4:7], a[224:227], 0
    ds_write_b128 v18, v[68:71] offset:12288
    v_add_f32 v128, v128, v136
    v_mfma_f32_16x16x32_bf16 v[92:95], a[28:31], a[228:231], v[92:95]
    v_add_f32 v129, v129, v137
    v_add_f32 v130, v130, v138
    v_mfma_f32_16x16x32_bf16 v[96:99], a[8:11], a[224:227], 0
    v_add_f32 v131, v131, v139
    v_cvt_pk_bf16_f32 v118, v128, v129
    v_mfma_f32_16x16x32_bf16 v[96:99], a[32:35], a[228:231], v[96:99]
    ds_write_b128 v19, v[72:75] offset:12416
    v_cvt_pk_bf16_f32 v119, v130, v131
    v_mfma_f32_16x16x32_bf16 v[100:103], a[12:15], a[224:227], 0
    s_waitcnt lgkmcnt(3)
    buffer_store_dwordx4 v[116:119], v16, s[24:27], s70 offen offset:0 sc1
    v_add_f32 v144, v144, v148
    v_mfma_f32_16x16x32_bf16 v[100:103], a[36:39], a[228:231], v[100:103]
    buffer_load_dwordx4 a[220:223], v16, s[24:27], s44 offen offset:3072 sc1
    v_add_f32 v145, v145, v149
    v_mfma_f32_16x16x32_bf16 v[104:107], a[16:19], a[224:227], 0
    ds_write_b128 v18, v[76:79] offset:12416
    v_add_f32 v146, v146, v150
    v_mfma_f32_16x16x32_bf16 v[104:107], a[40:43], a[228:231], v[104:107]
    v_add_f32 v147, v147, v151
    v_add_f32 v152, v152, v156
    v_mfma_f32_16x16x32_bf16 v[108:111], a[20:23], a[224:227], 0
    v_add_f32 v153, v153, v157
    v_add_f32 v154, v154, v158
    v_mfma_f32_16x16x32_bf16 v[108:111], a[44:47], a[228:231], v[108:111]
    s_waitcnt vmcnt(15)
    ds_write_b128 v19, v[80:83] offset:12544
    v_add_f32 v155, v155, v159
    v_mfma_f32_16x16x32_bf16 v[88:91], a[48:51], a[232:235], v[88:91]
    s_waitcnt vmcnt(14)
    s_add_u32 s44, s99, 65536
    v_add_f32 v144, v144, v152
    v_add_f32 v145, v145, v153
    v_mfma_f32_16x16x32_bf16 v[88:91], a[72:75], a[236:239], v[88:91]
    buffer_load_dwordx4 a[224:227], v16, s[24:27], s44 offen offset:0 sc1
    v_add_f32 v146, v146, v154
    v_mfma_f32_16x16x32_bf16 v[92:95], a[52:55], a[232:235], v[92:95]
    ds_write_b128 v18, v[84:87] offset:12544
    v_add_f32 v147, v147, v155
    v_mfma_f32_16x16x32_bf16 v[92:95], a[76:79], a[236:239], v[92:95]
    v_cvt_pk_bf16_f32 v148, v144, v145
    v_cvt_pk_bf16_f32 v149, v146, v147
    v_mfma_f32_16x16x32_bf16 v[96:99], a[56:59], a[232:235], v[96:99]
    v_mfma_f32_16x16x32_bf16 v[96:99], a[80:83], a[236:239], v[96:99]
    v_mfma_f32_16x16x32_bf16 v[100:103], a[60:63], a[232:235], v[100:103]
    v_mfma_f32_16x16x32_bf16 v[100:103], a[84:87], a[236:239], v[100:103]
    buffer_load_dwordx4 a[228:231], v16, s[24:27], s44 offen offset:1024 sc1
    v_mfma_f32_16x16x32_bf16 v[104:107], a[64:67], a[232:235], v[104:107]
    s_waitcnt lgkmcnt(0)
    s_barrier
    v_mfma_f32_16x16x32_bf16 v[104:107], a[88:91], a[236:239], v[104:107]
    ds_read_b128 v[160:163], v49 offset:0
    v_mfma_f32_16x16x32_bf16 v[108:111], a[68:71], a[232:235], v[108:111]
    ds_read_b128 v[164:167], v49 offset:36864
    v_mfma_f32_16x16x32_bf16 v[108:111], a[92:95], a[236:239], v[108:111]
    s_waitcnt vmcnt(15)
    ds_read_b128 v[168:171], v35 offset:0
    v_mfma_f32_16x16x32_bf16 v[88:91], a[96:99], a[240:243], v[88:91]
    s_waitcnt vmcnt(14)
    ds_read_b128 v[172:175], v35 offset:36864
    v_mfma_f32_16x16x32_bf16 v[88:91], a[120:123], a[244:247], v[88:91]
    buffer_load_dwordx4 a[232:235], v16, s[24:27], s44 offen offset:2048 sc1
    ds_read_b128 v[176:179], v50 offset:0
    v_mfma_f32_16x16x32_bf16 v[92:95], a[100:103], a[240:243], v[92:95]
    ds_read_b128 v[180:183], v50 offset:36864
    v_mfma_f32_16x16x32_bf16 v[92:95], a[124:127], a[244:247], v[92:95]
    ds_read_b128 v[184:187], v36 offset:0
    v_mfma_f32_16x16x32_bf16 v[96:99], a[104:107], a[240:243], v[96:99]
    ds_read_b128 v[188:191], v36 offset:36864
    v_mfma_f32_16x16x32_bf16 v[96:99], a[128:131], a[244:247], v[96:99]
    v_mfma_f32_16x16x32_bf16 v[100:103], a[108:111], a[240:243], v[100:103]
    s_waitcnt lgkmcnt(4)
    v_add_f32 v160, v160, v164
    v_add_f32 v161, v161, v165
    v_mfma_f32_16x16x32_bf16 v[100:103], a[132:135], a[244:247], v[100:103]
    buffer_load_dwordx4 a[236:239], v16, s[24:27], s44 offen offset:3072 sc1
    v_add_f32 v162, v162, v166
    v_mfma_f32_16x16x32_bf16 v[104:107], a[112:115], a[240:243], v[104:107]
    v_add_f32 v163, v163, v167
    v_add_f32 v168, v168, v172
    v_mfma_f32_16x16x32_bf16 v[104:107], a[136:139], a[244:247], v[104:107]
    v_add_f32 v169, v169, v173
    v_add_f32 v170, v170, v174
    v_mfma_f32_16x16x32_bf16 v[108:111], a[116:119], a[240:243], v[108:111]
    v_add_f32 v171, v171, v175
    v_add_f32 v160, v160, v168
    v_mfma_f32_16x16x32_bf16 v[108:111], a[140:143], a[244:247], v[108:111]
    s_waitcnt vmcnt(15)
    v_add_f32 v161, v161, v169
    v_add_f32 v162, v162, v170
    v_mfma_f32_16x16x32_bf16 v[88:91], a[144:147], a[248:251], v[88:91]
    s_waitcnt vmcnt(14)
    s_add_u32 s44, s99, 69632
    v_add_f32 v163, v163, v171
    v_cvt_pk_bf16_f32 v150, v160, v161
    v_mfma_f32_16x16x32_bf16 v[88:91], a[168:171], a[252:255], v[88:91]
    buffer_load_dwordx4 a[240:243], v16, s[24:27], s44 offen offset:0 sc1
    v_cvt_pk_bf16_f32 v151, v162, v163
    v_mfma_f32_16x16x32_bf16 v[92:95], a[148:151], a[248:251], v[92:95]
    s_waitcnt lgkmcnt(0)
    buffer_store_dwordx4 v[148:151], v16, s[24:27], s70 offen offset:1024 sc1
    v_add_f32 v176, v176, v180
    v_mfma_f32_16x16x32_bf16 v[92:95], a[172:175], a[252:255], v[92:95]
    v_add_f32 v177, v177, v181
    v_add_f32 v178, v178, v182
    v_mfma_f32_16x16x32_bf16 v[96:99], a[152:155], a[248:251], v[96:99]
    v_add_f32 v179, v179, v183
    v_add_f32 v184, v184, v188
    v_mfma_f32_16x16x32_bf16 v[96:99], a[176:179], a[252:255], v[96:99]
    v_add_f32 v185, v185, v189
    v_add_f32 v186, v186, v190
    v_mfma_f32_16x16x32_bf16 v[100:103], a[156:159], a[248:251], v[100:103]
    v_add_f32 v187, v187, v191
    v_add_f32 v176, v176, v184
    v_mfma_f32_16x16x32_bf16 v[100:103], a[180:183], a[252:255], v[100:103]
    buffer_load_dwordx4 a[244:247], v16, s[24:27], s44 offen offset:1024 sc1
    v_add_f32 v177, v177, v185
    v_mfma_f32_16x16x32_bf16 v[104:107], a[160:163], a[248:251], v[104:107]
    v_add_f32 v178, v178, v186
    v_add_f32 v179, v179, v187
    v_mfma_f32_16x16x32_bf16 v[104:107], a[184:187], a[252:255], v[104:107]
    v_cvt_pk_bf16_f32 v180, v176, v177
    v_cvt_pk_bf16_f32 v181, v178, v179
    v_mfma_f32_16x16x32_bf16 v[108:111], a[164:167], a[248:251], v[108:111]
    s_waitcnt lgkmcnt(8)
    buffer_store_dwordx2 v[180:181], v37, s[24:27], s70 offen offset:2048 sc1
    v_mfma_f32_16x16x32_bf16 v[108:111], a[188:191], a[252:255], v[108:111]
    s_waitcnt vmcnt(17)
    ds_write_b128 v19, v[88:91] offset:18432
    v_mfma_f32_16x16x32_bf16 v[64:67], a[0:3], a[192:195], 0
    s_waitcnt vmcnt(16)
    v_mfma_f32_16x16x32_bf16 v[64:67], a[24:27], a[196:199], v[64:67]
    buffer_load_dwordx4 a[248:251], v16, s[24:27], s44 offen offset:2048 sc1
    v_mfma_f32_16x16x32_bf16 v[68:71], a[4:7], a[192:195], 0
    v_mfma_f32_16x16x32_bf16 v[68:71], a[28:31], a[196:199], v[68:71]
    ds_write_b128 v18, v[92:95] offset:18432
    v_mfma_f32_16x16x32_bf16 v[72:75], a[8:11], a[192:195], 0
    v_mfma_f32_16x16x32_bf16 v[72:75], a[32:35], a[196:199], v[72:75]
    v_mfma_f32_16x16x32_bf16 v[76:79], a[12:15], a[192:195], 0
    v_mfma_f32_16x16x32_bf16 v[76:79], a[36:39], a[196:199], v[76:79]
    buffer_load_dwordx4 a[252:255], v16, s[24:27], s44 offen offset:3072 sc1
    ds_write_b128 v19, v[96:99] offset:18560
    v_mfma_f32_16x16x32_bf16 v[80:83], a[16:19], a[192:195], 0
    v_mfma_f32_16x16x32_bf16 v[80:83], a[40:43], a[196:199], v[80:83]
    v_mfma_f32_16x16x32_bf16 v[84:87], a[20:23], a[192:195], 0
    v_mfma_f32_16x16x32_bf16 v[84:87], a[44:47], a[196:199], v[84:87]
    s_waitcnt vmcnt(17)
    ds_write_b128 v18, v[100:103] offset:18560
    v_mfma_f32_16x16x32_bf16 v[64:67], a[48:51], a[200:203], v[64:67]
    s_waitcnt vmcnt(16)
    v_mfma_f32_16x16x32_bf16 v[64:67], a[72:75], a[204:207], v[64:67]
    v_mfma_f32_16x16x32_bf16 v[68:71], a[52:55], a[200:203], v[68:71]
    buffer_load_dwordx2 v[24:25], v60, s[24:27], 0 offen sc1
    v_mfma_f32_16x16x32_bf16 v[68:71], a[76:79], a[204:207], v[68:71]
    ds_write_b128 v19, v[104:107] offset:18688
    v_mfma_f32_16x16x32_bf16 v[72:75], a[56:59], a[200:203], v[72:75]
    v_mfma_f32_16x16x32_bf16 v[72:75], a[80:83], a[204:207], v[72:75]
    v_mfma_f32_16x16x32_bf16 v[76:79], a[60:63], a[200:203], v[76:79]
    v_mfma_f32_16x16x32_bf16 v[76:79], a[84:87], a[204:207], v[76:79]
    ds_write_b128 v18, v[108:111] offset:18688
    v_mfma_f32_16x16x32_bf16 v[80:83], a[64:67], a[200:203], v[80:83]
    v_mfma_f32_16x16x32_bf16 v[80:83], a[88:91], a[204:207], v[80:83]
    v_mfma_f32_16x16x32_bf16 v[84:87], a[68:71], a[200:203], v[84:87]
    v_mfma_f32_16x16x32_bf16 v[84:87], a[92:95], a[204:207], v[84:87]
    s_waitcnt vmcnt(16)
    v_mfma_f32_16x16x32_bf16 v[64:67], a[96:99], a[208:211], v[64:67]
    s_waitcnt vmcnt(14)
    v_mfma_f32_16x16x32_bf16 v[64:67], a[120:123], a[212:215], v[64:67]
    v_mfma_f32_16x16x32_bf16 v[68:71], a[100:103], a[208:211], v[68:71]
    v_mfma_f32_16x16x32_bf16 v[68:71], a[124:127], a[212:215], v[68:71]
    v_mfma_f32_16x16x32_bf16 v[72:75], a[104:107], a[208:211], v[72:75]
    v_mfma_f32_16x16x32_bf16 v[72:75], a[128:131], a[212:215], v[72:75]
    v_mfma_f32_16x16x32_bf16 v[76:79], a[108:111], a[208:211], v[76:79]
    v_mfma_f32_16x16x32_bf16 v[76:79], a[132:135], a[212:215], v[76:79]
    v_mfma_f32_16x16x32_bf16 v[80:83], a[112:115], a[208:211], v[80:83]
    v_mfma_f32_16x16x32_bf16 v[80:83], a[136:139], a[212:215], v[80:83]
    v_mfma_f32_16x16x32_bf16 v[84:87], a[116:119], a[208:211], v[84:87]
    v_mfma_f32_16x16x32_bf16 v[84:87], a[140:143], a[212:215], v[84:87]
    s_waitcnt vmcnt(13)
    v_mfma_f32_16x16x32_bf16 v[64:67], a[144:147], a[216:219], v[64:67]
    s_waitcnt vmcnt(11)
    v_mfma_f32_16x16x32_bf16 v[64:67], a[168:171], a[220:223], v[64:67]
    v_mfma_f32_16x16x32_bf16 v[68:71], a[148:151], a[216:219], v[68:71]
    v_mfma_f32_16x16x32_bf16 v[68:71], a[172:175], a[220:223], v[68:71]
    v_mfma_f32_16x16x32_bf16 v[72:75], a[152:155], a[216:219], v[72:75]
    s_waitcnt vmcnt(3)
    buffer_store_dwordx2 v[56:57], v17, s[24:27], s72 offen sc1
    v_mfma_f32_16x16x32_bf16 v[72:75], a[176:179], a[220:223], v[72:75]
    v_mfma_f32_16x16x32_bf16 v[76:79], a[156:159], a[216:219], v[76:79]
    v_mfma_f32_16x16x32_bf16 v[76:79], a[180:183], a[220:223], v[76:79]
    v_mfma_f32_16x16x32_bf16 v[80:83], a[160:163], a[216:219], v[80:83]
    v_mfma_f32_16x16x32_bf16 v[80:83], a[184:187], a[220:223], v[80:83]
    v_mfma_f32_16x16x32_bf16 v[84:87], a[164:167], a[216:219], v[84:87]
    s_waitcnt lgkmcnt(0)
    v_mfma_f32_16x16x32_bf16 v[84:87], a[188:191], a[220:223], v[84:87]
    s_waitcnt vmcnt(11)
    ds_write_b128 v19, v[64:67] offset:24576
    v_mfma_f32_16x16x32_bf16 v[88:91], a[0:3], a[224:227], 0
    s_waitcnt vmcnt(10)
    v_mfma_f32_16x16x32_bf16 v[88:91], a[24:27], a[228:231], v[88:91]
    v_mfma_f32_16x16x32_bf16 v[92:95], a[4:7], a[224:227], 0
    ds_write_b128 v18, v[68:71] offset:24576
    s_waitcnt vmcnt(1)
    v_cmp_ne_u64 vcc, v[24:25], v[56:57]
    s_nop 4
    s_cbranch_vccnz L_fa_spin
L_fa_ok:
    v_mfma_f32_16x16x32_bf16 v[92:95], a[28:31], a[228:231], v[92:95]
    s_add_u32 s46, s79, 0
    v_mfma_f32_16x16x32_bf16 v[96:99], a[8:11], a[224:227], 0
    buffer_load_dwordx4 v[192:195], v16, s[24:27], s46 offen offset:0 sc1
    v_mfma_f32_16x16x32_bf16 v[96:99], a[32:35], a[228:231], v[96:99]
    ds_write_b128 v19, v[72:75] offset:24704
    buffer_load_dwordx4 v[196:199], v16, s[24:27], s46 offen offset:1024 sc1
    v_mfma_f32_16x16x32_bf16 v[100:103], a[12:15], a[224:227], 0
    buffer_load_dwordx2 v[200:201], v37, s[24:27], s46 offen offset:2048 sc1
    s_add_u32 s46, s79, 20480
    v_mfma_f32_16x16x32_bf16 v[100:103], a[36:39], a[228:231], v[100:103]
    buffer_load_dwordx4 v[202:205], v16, s[24:27], s46 offen offset:0 sc1
    v_mfma_f32_16x16x32_bf16 v[104:107], a[16:19], a[224:227], 0
    ds_write_b128 v18, v[76:79] offset:24704
    buffer_load_dwordx4 v[206:209], v16, s[24:27], s46 offen offset:1024 sc1
    v_mfma_f32_16x16x32_bf16 v[104:107], a[40:43], a[228:231], v[104:107]
    buffer_load_dwordx2 v[210:211], v37, s[24:27], s46 offen offset:2048 sc1
    v_mfma_f32_16x16x32_bf16 v[108:111], a[20:23], a[224:227], 0
    v_mfma_f32_16x16x32_bf16 v[108:111], a[44:47], a[228:231], v[108:111]
    s_waitcnt vmcnt(15)
    ds_write_b128 v19, v[80:83] offset:24832
    v_mfma_f32_16x16x32_bf16 v[88:91], a[48:51], a[232:235], v[88:91]
    s_waitcnt vmcnt(14)
    v_mfma_f32_16x16x32_bf16 v[88:91], a[72:75], a[236:239], v[88:91]
    v_mfma_f32_16x16x32_bf16 v[92:95], a[52:55], a[232:235], v[92:95]
    ds_write_b128 v18, v[84:87] offset:24832
    v_mfma_f32_16x16x32_bf16 v[92:95], a[76:79], a[236:239], v[92:95]
    v_mfma_f32_16x16x32_bf16 v[96:99], a[56:59], a[232:235], v[96:99]
    v_mfma_f32_16x16x32_bf16 v[96:99], a[80:83], a[236:239], v[96:99]
    v_mfma_f32_16x16x32_bf16 v[100:103], a[60:63], a[232:235], v[100:103]
    v_mfma_f32_16x16x32_bf16 v[100:103], a[84:87], a[236:239], v[100:103]
    v_mfma_f32_16x16x32_bf16 v[104:107], a[64:67], a[232:235], v[104:107]
    s_waitcnt lgkmcnt(0)
    s_barrier
    v_mfma_f32_16x16x32_bf16 v[104:107], a[88:91], a[236:239], v[104:107]
    ds_read_b128 v[112:115], v46 offset:18432
    v_mfma_f32_16x16x32_bf16 v[108:111], a[68:71], a[232:235], v[108:111]
    ds_read_b128 v[116:119], v46 offset:55296
    buffer_load_dwordx2 v[24:25], v61, s[24:27], 0 offen sc1
    v_mfma_f32_16x16x32_bf16 v[108:111], a[92:95], a[236:239], v[108:111]
    s_waitcnt vmcnt(14)
    ds_read_b128 v[120:123], v32 offset:18432
    v_mfma_f32_16x16x32_bf16 v[88:91], a[96:99], a[240:243], v[88:91]
    s_waitcnt vmcnt(12)
    ds_read_b128 v[124:127], v32 offset:55296
    v_mfma_f32_16x16x32_bf16 v[88:91], a[120:123], a[244:247], v[88:91]
    ds_read_b128 v[128:131], v47 offset:18432
    v_mfma_f32_16x16x32_bf16 v[92:95], a[100:103], a[240:243], v[92:95]
    ds_read_b128 v[132:135], v47 offset:55296
    v_mfma_f32_16x16x32_bf16 v[92:95], a[124:127], a[244:247], v[92:95]
    ds_read_b128 v[136:139], v33 offset:18432
    v_mfma_f32_16x16x32_bf16 v[96:99], a[104:107], a[240:243], v[96:99]
    ds_read_b128 v[140:143], v33 offset:55296
    v_mfma_f32_16x16x32_bf16 v[96:99], a[128:131], a[244:247], v[96:99]
    ds_read_b128 v[144:147], v48 offset:18432
    v_mfma_f32_16x16x32_bf16 v[100:103], a[108:111], a[240:243], v[100:103]
    s_waitcnt lgkmcnt(5)
    ds_read_b128 v[148:151], v48 offset:55296
    v_add_f32 v112, v112, v116
    v_mfma_f32_16x16x32_bf16 v[100:103], a[132:135], a[244:247], v[100:103]
    ds_read_b128 v[152:155], v34 offset:18432
    v_add_f32 v113, v113, v117
    v_mfma_f32_16x16x32_bf16 v[104:107], a[112:115], a[240:243], v[104:107]
    ds_read_b128 v[156:159], v34 offset:55296
    v_add_f32 v114, v114, v118
    v_mfma_f32_16x16x32_bf16 v[104:107], a[136:139], a[244:247], v[104:107]
    v_add_f32 v115, v115, v119
    v_add_f32 v120, v120, v124
    v_mfma_f32_16x16x32_bf16 v[108:111], a[116:119], a[240:243], v[108:111]
    v_add_f32 v121, v121, v125
    v_add_f32 v122, v122, v126
    v_mfma_f32_16x16x32_bf16 v[108:111], a[140:143], a[244:247], v[108:111]
    s_waitcnt vmcnt(10)
    v_add_f32 v123, v123, v127
    v_add_f32 v112, v112, v120
    v_mfma_f32_16x16x32_bf16 v[88:91], a[144:147], a[248:251], v[88:91]
    s_waitcnt vmcnt(9)
    v_add_f32 v113, v113, v121
    v_add_f32 v114, v114, v122
    v_mfma_f32_16x16x32_bf16 v[88:91], a[168:171], a[252:255], v[88:91]
    v_add_f32 v115, v115, v123
    v_mfma_f32_16x16x32_bf16 v[92:95], a[148:151], a[248:251], v[92:95]
    s_waitcnt lgkmcnt(4)
    v_add_f32 v128, v128, v132
    v_add_f32 v129, v129, v133
    v_mfma_f32_16x16x32_bf16 v[92:95], a[172:175], a[252:255], v[92:95]
    v_add_f32 v130, v130, v134
    v_add_f32 v131, v131, v135
    v_mfma_f32_16x16x32_bf16 v[96:99], a[152:155], a[248:251], v[96:99]
    v_add_f32 v136, v136, v140
    v_add_f32 v137, v137, v141
    v_mfma_f32_16x16x32_bf16 v[96:99], a[176:179], a[252:255], v[96:99]
    v_add_f32 v138, v138, v142
    v_add_f32 v139, v139, v143
    v_mfma_f32_16x16x32_bf16 v[100:103], a[156:159], a[248:251], v[100:103]
    v_add_f32 v128, v128, v136
    v_add_f32 v129, v129, v137
    v_mfma_f32_16x16x32_bf16 v[100:103], a[180:183], a[252:255], v[100:103]
    v_add_f32 v130, v130, v138
    v_add_f32 v131, v131, v139
    v_mfma_f32_16x16x32_bf16 v[104:107], a[160:163], a[248:251], v[104:107]
    s_waitcnt lgkmcnt(0)
    v_add_f32 v144, v144, v148
    v_add_f32 v145, v145, v149
    v_mfma_f32_16x16x32_bf16 v[104:107], a[184:187], a[252:255], v[104:107]
    v_add_f32 v146, v146, v150
    v_add_f32 v147, v147, v151
    v_mfma_f32_16x16x32_bf16 v[108:111], a[164:167], a[248:251], v[108:111]
    s_waitcnt lgkmcnt(12)
    ds_write_b128 v19, v[88:91] offset:30720
    v_add_f32 v152, v152, v156
    v_add_f32 v153, v153, v157
    v_mfma_f32_16x16x32_bf16 v[108:111], a[188:191], a[252:255], v[108:111]
    v_add_f32 v154, v154, v158
    v_add_f32 v155, v155, v159
    s_waitcnt lgkmcnt(1)
    s_waitcnt vmcnt(0)
    v_cmp_ne_u64 vcc, v[24:25], v[56:57]
    s_nop 4
    s_cbranch_vccnz L_fb_late
    s_add_u32 s46, s79, 40960
    buffer_load_dwordx4 v[212:215], v16, s[24:27], s46 offen offset:0 sc1
    buffer_load_dwordx4 v[216:219], v16, s[24:27], s46 offen offset:1024 sc1
    buffer_load_dwordx2 v[220:221], v37, s[24:27], s46 offen offset:2048 sc1
    ds_write_b128 v18, v[92:95] offset:30720
    ds_write_b128 v19, v[96:99] offset:30848
    ds_write_b128 v18, v[100:103] offset:30848
    ds_write_b128 v19, v[104:107] offset:30976
    ds_write_b128 v18, v[108:111] offset:30976
    v_add_f32 v144, v144, v152
    v_add_f32 v145, v145, v153
    v_add_f32 v146, v146, v154
    v_add_f32 v147, v147, v155
    v_lshlrev_b32 v26, 16, v192
    v_and_b32 v27, 0xffff0000, v192
    v_lshlrev_b32 v28, 16, v193
    v_and_b32 v29, 0xffff0000, v193
    v_add_f32 v112, v112, v26
    v_add_f32 v113, v113, v27
    v_add_f32 v114, v114, v28
    v_add_f32 v115, v115, v29
    v_lshlrev_b32 v26, 16, v202
    v_and_b32 v27, 0xffff0000, v202
    v_lshlrev_b32 v28, 16, v203
    v_and_b32 v29, 0xffff0000, v203
    v_add_f32 v112, v112, v26
    v_add_f32 v113, v113, v27
    v_add_f32 v114, v114, v28
    v_add_f32 v115, v115, v29
    v_lshlrev_b32 v26, 16, v194
    v_and_b32 v27, 0xffff0000, v194
    v_lshlrev_b32 v28, 16, v195
    v_and_b32 v29, 0xffff0000, v195
    s_waitcnt lgkmcnt(0)
    s_barrier
    ds_read_b128 v[160:163], v49 offset:18432
    ds_read_b128 v[164:167], v49 offset:55296
    ds_read_b128 v[168:171], v35 offset:18432
    ds_read_b128 v[172:175], v35 offset:55296
    ds_read_b128 v[176:179], v50 offset:18432
    ds_read_b128 v[180:183], v50 offset:55296
    ds_read_b128 v[184:187], v36 offset:18432
    ds_read_b128 v[188:191], v36 offset:55296
    v_add_f32 v128, v128, v26
    v_add_f32 v129, v129, v27
    v_add_f32 v130, v130, v28
    v_add_f32 v131, v131, v29
    v_lshlrev_b32 v26, 16, v204
    v_and_b32 v27, 0xffff0000, v204
    v_lshlrev_b32 v28, 16, v205
    v_and_b32 v29, 0xffff0000, v205
    v_add_f32 v128, v128, v26
    v_add_f32 v129, v129, v27
    v_add_f32 v130, v130, v28
    v_add_f32 v131, v131, v29
    v_lshlrev_b32 v26, 16, v196
    v_and_b32 v27, 0xffff0000, v196
    v_lshlrev_b32 v28, 16, v197
    v_and_b32 v29, 0xffff0000, v197
    v_add_f32 v144, v144, v26
    v_add_f32 v145, v145, v27
    v_add_f32 v146, v146, v28
    v_add_f32 v147, v147, v29
    v_lshlrev_b32 v26, 16, v206
    v_and_b32 v27, 0xffff0000, v206
    v_lshlrev_b32 v28, 16, v207
    v_and_b32 v29, 0xffff0000, v207
    v_add_f32 v144, v144, v26
    v_add_f32 v145, v145, v27
    v_add_f32 v146, v146, v28
    v_add_f32 v147, v147, v29
    v_lshlrev_b32 v236, 16, v198
    v_and_b32 v237, 0xffff0000, v198
    v_lshlrev_b32 v238, 16, v199
    v_and_b32 v239, 0xffff0000, v199
    v_lshlrev_b32 v26, 16, v208
    v_and_b32 v27, 0xffff0000, v208
    v_lshlrev_b32 v28, 16, v209
    v_and_b32 v29, 0xffff0000, v209
    v_add_f32 v236, v236, v26
    v_add_f32 v237, v237, v27
    v_add_f32 v238, v238, v28
    v_add_f32 v239, v239, v29
    v_lshlrev_b32 v240, 16, v200
    v_and_b32 v241, 0xffff0000, v200
    v_lshlrev_b32 v242, 16, v201
    v_and_b32 v243, 0xffff0000, v201
    v_lshlrev_b32 v26, 16, v210
    v_and_b32 v27, 0xffff0000, v210
    v_lshlrev_b32 v28, 16, v211
    v_and_b32 v29, 0xffff0000, v211
    v_add_f32 v240, v240, v26
    v_add_f32 v241, v241, v27
    v_add_f32 v242, v242, v28
    v_add_f32 v243, v243, v29
L_fb_join:
    s_waitcnt lgkmcnt(4)
    v_add_f32 v160, v160, v164
    v_add_f32 v161, v161, v165
    v_add_f32 v162, v162, v166
    v_add_f32 v163, v163, v167
    v_add_f32 v168, v168, v172
    v_add_f32 v169, v169, v173
    v_add_f32 v170, v170, v174
    v_add_f32 v171, v171, v175
    v_add_f32 v160, v160, v168
    v_add_f32 v161, v161, v169
    v_add_f32 v162, v162, v170
    v_add_f32 v163, v163, v171
    v_add_f32 v160, v160, v236
    v_add_f32 v161, v161, v237
    v_add_f32 v162, v162, v238
    v_add_f32 v163, v163, v239
    s_waitcnt lgkmcnt(0)
    v_add_f32 v176, v176, v180
    v_add_f32 v177, v177, v181
    v_add_f32 v178, v178, v182
    v_add_f32 v179, v179, v183
    v_add_f32 v184, v184, v188
    v_add_f32 v185, v185, v189
    v_add_f32 v186, v186, v190
    v_add_f32 v187, v187, v191
    v_add_f32 v176, v176, v184
    v_add_f32 v177, v177, v185
    v_add_f32 v178, v178, v186
    v_add_f32 v179, v179, v187
    v_add_f32 v176, v176, v240
    v_add_f32 v177, v177, v241
    v_add_f32 v178, v178, v242
    v_add_f32 v179, v179, v243
    s_waitcnt vmcnt(2)
    v_lshlrev_b32 v26, 16, v212
    v_and_b32 v27, 0xffff0000, v212
    v_lshlrev_b32 v28, 16, v213
    v_and_b32 v29, 0xffff0000, v213
    v_add_f32 v112, v112, v26
    v_add_f32 v113, v113, v27
    v_add_f32 v114, v114, v28
    v_add_f32 v115, v115, v29
    v_cvt_pk_bf16_f32 v112, v112, v113
    v_cvt_pk_bf16_f32 v113, v114, v115
    buffer_store_dwordx2 v[112:113], v51, s[32:35], 0 offen
    v_lshlrev_b32 v26, 16, v214
    v_and_b32 v27, 0xffff0000, v214
    v_lshlrev_b32 v28, 16, v215
    v_and_b32 v29, 0xffff0000, v215
    v_add_f32 v128, v128, v26
    v_add_f32 v129, v129, v27
    v_add_f32 v130, v130, v28
    v_add_f32 v131, v131, v29
    v_cvt_pk_bf16_f32 v128, v128, v129
    v_cvt_pk_bf16_f32 v129, v130, v131
    buffer_store_dwordx2 v[128:129], v52, s[32:35], 0 offen
    s_waitcnt vmcnt(3)
    v_lshlrev_b32 v26, 16, v216
    v_and_b32 v27, 0xffff0000, v216
    v_lshlrev_b32 v28, 16, v217
    v_and_b32 v29, 0xffff0000, v217
    v_add_f32 v144, v144, v26
    v_add_f32 v145, v145, v27
    v_add_f32 v146, v146, v28
    v_add_f32 v147, v147, v29
    v_cvt_pk_bf16_f32 v144, v144, v145
    v_cvt_pk_bf16_f32 v145, v146, v147
    buffer_store_dwordx2 v[144:145], v53, s[32:35], 0 offen
    v_lshlrev_b32 v26, 16, v218
    v_and_b32 v27, 0xffff0000, v218
    v_lshlrev_b32 v28, 16, v219
    v_and_b32 v29, 0xffff0000, v219
    v_add_f32 v160, v160, v26
    v_add_f32 v161, v161, v27
    v_add_f32 v162, v162, v28
    v_add_f32 v163, v163, v29
    v_cvt_pk_bf16_f32 v160, v160, v161
    v_cvt_pk_bf16_f32 v161, v162, v163
    buffer_store_dwordx2 v[160:161], v54, s[32:35], 0 offen
    s_waitcnt vmcnt(4)
    v_lshlrev_b32 v26, 16, v220
    v_and_b32 v27, 0xffff0000, v220
    v_lshlrev_b32 v28, 16, v221
    v_and_b32 v29, 0xffff0000, v221
    v_add_f32 v176, v176, v26
    v_add_f32 v177, v177, v27
    v_add_f32 v178, v178, v28
    v_add_f32 v179, v179, v29
    v_cvt_pk_bf16_f32 v176, v176, v177
    v_cvt_pk_bf16_f32 v177, v178, v179
    buffer_store_dwordx2 v[176:177], v55, s[32:35], 0 offen
L_fin:
L_end:
    s_endpgm
L_fo_spin:
    s_mov_b32 s53, 400000
L_fo_again:
    buffer_load_dwordx2 v[24:25], v58, s[24:27], 0 offen sc1
    s_waitcnt vmcnt(0)
    v_cmp_ne_u64 vcc, v[24:25], v[56:57]
    s_sub_u32 s53, s53, 1
    s_nop 2
    s_cbranch_vccz L_fo_ok
    s_sleep 1
    s_cmp_lg_u32 s53, 0
    s_cbranch_scc1 L_fo_again
    s_branch L_fo_ok
L_fo2_spin:
    s_mov_b32 s53, 400000
L_fo2_again:
    buffer_load_dwordx2 v[24:25], v58, s[24:27], 0 offen offset:128 sc1
    s_waitcnt vmcnt(0)
    v_cmp_ne_u64 vcc, v[24:25], v[56:57]
    s_sub_u32 s53, s53, 1
    s_nop 2
    s_cbranch_vccz L_fo2_ok
    s_sleep 1
    s_cmp_lg_u32 s53, 0
    s_cbranch_scc1 L_fo2_again
    s_branch L_fo2_ok
L_fa_spin:
    s_mov_b32 s53, 400000
L_fa_again:
    buffer_load_dwordx2 v[24:25], v60, s[24:27], 0 offen sc1
    s_waitcnt vmcnt(0)
    v_cmp_ne_u64 vcc, v[24:25], v[56:57]
    s_sub_u32 s53, s53, 1
    s_nop 2
    s_cbranch_vccz L_fa_ok
    s_sleep 1
    s_cmp_lg_u32 s53, 0
    s_cbranch_scc1 L_fa_again
    s_branch L_fa_ok
L_fb_spin:
    s_mov_b32 s53, 400000
L_fb_again:
    buffer_load_dwordx2 v[24:25], v61, s[24:27], 0 offen sc1
    s_waitcnt vmcnt(0)
    v_cmp_ne_u64 vcc, v[24:25], v[56:57]
    s_sub_u32 s53, s53, 1
    s_nop 2
    s_cbranch_vccz L_fb_ok
    s_sleep 1
    s_cmp_lg_u32 s53, 0
    s_cbranch_scc1 L_fb_again
    s_branch L_fb_ok
L_fb_late:
    buffer_load_dwordx2 v[24:25], v61, s[24:27], 0 offen sc1
    ds_write_b128 v18, v[92:95] offset:30720
    ds_write_b128 v19, v[96:99] offset:30848
    ds_write_b128 v18, v[100:103] offset:30848
    ds_write_b128 v19, v[104:107] offset:30976
    ds_write_b128 v18, v[108:111] offset:30976
    v_add_f32 v144, v144, v152
    v_add_f32 v145, v145, v153
    v_add_f32 v146, v146, v154
    v_add_f32 v147, v147, v155
    v_lshlrev_b32 v26, 16, v192
    v_and_b32 v27, 0xffff0000, v192
    v_lshlrev_b32 v28, 16, v193
    v_and_b32 v29, 0xffff0000, v193
    v_add_f32 v112, v112, v26
    v_add_f32 v113, v113, v27
    v_add_f32 v114, v114, v28
    v_add_f32 v115, v115, v29
    v_lshlrev_b32 v26, 16, v202
    v_and_b32 v27, 0xffff0000, v202
    v_lshlrev_b32 v28, 16, v203
    v_and_b32 v29, 0xffff0000, v203
    v_add_f32 v112, v112, v26
    v_add_f32 v113, v113, v27
    v_add_f32 v114, v114, v28
    v_add_f32 v115, v115, v29
    v_lshlrev_b32 v26, 16, v194
    v_and_b32 v27, 0xffff0000, v194
    v_lshlrev_b32 v28, 16, v195
    v_and_b32 v29, 0xffff0000, v195
    s_waitcnt lgkmcnt(0)
    s_barrier
    ds_read_b128 v[160:163], v49 offset:18432
    ds_read_b128 v[164:167], v49 offset:55296
    ds_read_b128 v[168:171], v35 offset:18432
    ds_read_b128 v[172:175], v35 offset:55296
    ds_read_b128 v[176:179], v50 offset:18432
    ds_read_b128 v[180:183], v50 offset:55296
    ds_read_b128 v[184:187], v36 offset:18432
    ds_read_b128 v[188:191], v36 offset:55296
    v_add_f32 v128, v128, v26
    v_add_f32 v129, v129, v27
    v_add_f32 v130, v130, v28
    v_add_f32 v131, v131, v29
    v_lshlrev_b32 v26, 16, v204
    v_and_b32 v27, 0xffff0000, v204
    v_lshlrev_b32 v28, 16, v205
    v_and_b32 v29, 0xffff0000, v205
    v_add_f32 v128, v128, v26
    v_add_f32 v129, v129, v27
    v_add_f32 v130, v130, v28
    v_add_f32 v131, v131, v29
    v_lshlrev_b32 v26, 16, v196
    v_and_b32 v27, 0xffff0000, v196
    v_lshlrev_b32 v28, 16, v197
    v_and_b32 v29, 0xffff0000, v197
    v_add_f32 v144, v144, v26
    v_add_f32 v145, v145, v27
    v_add_f32 v146, v146, v28
    v_add_f32 v147, v147, v29
    v_lshlrev_b32 v26, 16, v206
    v_and_b32 v27, 0xffff0000, v206
    v_lshlrev_b32 v28, 16, v207
    v_and_b32 v29, 0xffff0000, v207
    v_add_f32 v144, v144, v26
    v_add_f32 v145, v145, v27
    v_add_f32 v146, v146, v28
    v_add_f32 v147, v147, v29
    v_lshlrev_b32 v236, 16, v198
    v_and_b32 v237, 0xffff0000, v198
    v_lshlrev_b32 v238, 16, v199
    v_and_b32 v239, 0xffff0000, v199
    v_lshlrev_b32 v26, 16, v208
    v_and_b32 v27, 0xffff0000, v208
    v_lshlrev_b32 v28, 16, v209
    v_and_b32 v29, 0xffff0000, v209
    v_add_f32 v236, v236, v26
    v_add_f32 v237, v237, v27
    v_add_f32 v238, v238, v28
    v_add_f32 v239, v239, v29
    v_lshlrev_b32 v240, 16, v200
    v_and_b32 v241, 0xffff0000, v200
    v_lshlrev_b32 v242, 16, v201
    v_and_b32 v243, 0xffff0000, v201
    v_lshlrev_b32 v26, 16, v210
    v_and_b32 v27, 0xffff0000, v210
    v_lshlrev_b32 v28, 16, v211
    v_and_b32 v29, 0xffff0000, v211
    v_add_f32 v240, v240, v26
    v_add_f32 v241, v241, v27
    v_add_f32 v242, v242, v28
    v_add_f32 v243, v243, v29
    s_waitcnt vmcnt(0)
    v_cmp_ne_u64 vcc, v[24:25], v[56:57]
    s_nop 4
    s_cbranch_vccnz L_fb_spin
L_fb_ok:
    s_add_u32 s46, s79, 40960
    buffer_load_dwordx4 v[212:215], v16, s[24:27], s46 offen offset:0 sc1
    buffer_load_dwordx4 v[216:219], v16, s[24:27], s46 offen offset:1024 sc1
    buffer_load_dwordx2 v[220:221], v37, s[24:27], s46 offen offset:2048 sc1
    s_branch L_fb_join
L_code_end:
L_attn_q4:
    ds_read_b128 a[128:131], v2 offset:8192
    s_nop 0
    ds_read_b128 a[132:135], v3 offset:8192
    s_nop 0
    ds_read_b128 a[136:139], v4 offset:8192
    s_nop 0
    ds_read_b128 a[140:143], v5 offset:8192
    s_nop 0
    ds_read_b128 a[144:147], v2 offset:12288
    s_nop 0
    ds_read_b128 a[148:151], v3 offset:12288
    s_nop 0
    ds_read_b128 a[152:155], v4 offset:12288
    s_nop 0
    ds_read_b128 a[156:159], v5 offset:12288
    s_nop 0
    v_exp_f32 v64, v64
    s_nop 0
    v_exp_f32 v65, v65
    s_nop 0
    s_waitcnt lgkmcnt(0)
    v_cvt_pk_bf16_f32 v128, v64, v65
    v_mfma_f32_16x16x32_bf16 v[96:99], a[128:131], v[192:195], v[160:163]
    s_cmp_eq_u32 s48, 65536
    s_cselect_b32 s49, s50, 16384
    v_exp_f32 v66, v66
    v_mfma_f32_16x16x32_bf16 v[96:99], a[132:135], v[196:199], v[96:99]
    s_add_u32 s48, s48, s49
    v_mfma_f32_16x16x32_bf16 v[96:99], a[136:139], v[200:203], v[96:99]
    v_exp_f32 v67, v67
    v_mfma_f32_16x16x32_bf16 v[96:99], a[140:143], v[204:207], v[96:99]
    v_cvt_pk_bf16_f32 v129, v66, v67
    v_mfma_f32_16x16x32_bf16 v[100:103], a[144:147], v[192:195], v[160:163]
    v_exp_f32 v68, v68
    v_mfma_f32_16x16x32_bf16 v[100:103], a[148:151], v[196:199], v[100:103]
    v_add_u32 v2, s49, v2
    v_mfma_f32_16x16x32_bf16 v[100:103], a[152:155], v[200:203], v[100:103]
    v_exp_f32 v69, v69
    v_mfma_f32_16x16x32_bf16 v[100:103], a[156:159], v[204:207], v[100:103]
    v_cvt_pk_bf16_f32 v130, v68, v69
    v_mfma_f32_16x16x32_bf16 v[104:107], a[128:131], v[208:211], v[164:167]
    v_exp_f32 v70, v70
    v_mfma_f32_16x16x32_bf16 v[104:107], a[132:135], v[212:215], v[104:107]
    v_add_u32 v3, s49, v3
    v_mfma_f32_16x16x32_bf16 v[104:107], a[136:139], v[216:219], v[104:107]
    v_exp_f32 v71, v71
    v_mfma_f32_16x16x32_bf16 v[104:107], a[140:143], v[220:223], v[104:107]
    v_cvt_pk_bf16_f32 v131, v70, v71
    v_mfma_f32_16x16x32_bf16 v[108:111], a[144:147], v[208:211], v[164:167]
    v_exp_f32 v72, v72
    v_mfma_f32_16x16x32_bf16 v[108:111], a[148:151], v[212:215], v[108:111]
    v_add_u32 v4, s49, v4
    v_mfma_f32_16x16x32_bf16 v[108:111], a[152:155], v[216:219], v[108:111]
    v_exp_f32 v73, v73
    v_mfma_f32_16x16x32_bf16 v[108:111], a[156:159], v[220:223], v[108:111]
    v_cvt_pk_bf16_f32 v132, v72, v73
    v_mfma_f32_16x16x32_bf16 v[112:115], a[128:131], v[224:227], v[168:171]
    v_exp_f32 v74, v74
    v_mfma_f32_16x16x32_bf16 v[112:115], a[132:135], v[228:231], v[112:115]
    v_add_u32 v5, s49, v5
    v_mfma_f32_16x16x32_bf16 v[112:115], a[136:139], v[232:235], v[112:115]
    v_exp_f32 v75, v75
    v_mfma_f32_16x16x32_bf16 v[112:115], a[140:143], v[236:239], v[112:115]
    v_cvt_pk_bf16_f32 v133, v74, v75
    v_mfma_f32_16x16x32_bf16 v[116:119], a[144:147], v[224:227], v[168:171]
    v_exp_f32 v76, v76
    v_mfma_f32_16x16x32_bf16 v[116:119], a[148:151], v[228:231], v[116:119]
    v_add_u32 v6, s49, v6
    v_mfma_f32_16x16x32_bf16 v[116:119], a[152:155], v[232:235], v[116:119]
    v_exp_f32 v77, v77
    v_mfma_f32_16x16x32_bf16 v[116:119], a[156:159], v[236:239], v[116:119]
    v_cvt_pk_bf16_f32 v134, v76, v77
    v_mfma_f32_16x16x32_bf16 v[120:123], a[128:131], v[240:243], v[172:175]
    v_exp_f32 v78, v78
    v_mfma_f32_16x16x32_bf16 v[120:123], a[132:135], v[244:247], v[120:123]
    v_add_u32 v7, s49, v7
    v_mfma_f32_16x16x32_bf16 v[120:123], a[136:139], v[248:251], v[120:123]
    v_exp_f32 v79, v79
    v_mfma_f32_16x16x32_bf16 v[120:123], a[140:143], v[252:255], v[120:123]
    v_cvt_pk_bf16_f32 v135, v78, v79
    v_mfma_f32_16x16x32_bf16 v[124:127], a[144:147], v[240:243], v[172:175]
    v_exp_f32 v80, v80
    v_mfma_f32_16x16x32_bf16 v[124:127], a[148:151], v[244:247], v[124:127]
    v_add_u32 v8, s49, v8
    v_mfma_f32_16x16x32_bf16 v[124:127], a[152:155], v[248:251], v[124:127]
    s_barrier
    v_exp_f32 v81, v81
    v_mfma_f32_16x16x32_bf16 v[124:127], a[156:159], v[252:255], v[124:127]
    ds_read_b128 a[128:131], v2 offset:0
    v_cvt_pk_bf16_f32 v136, v80, v81
    s_nop 0
    v_exp_f32 v82, v82
    s_nop 0
    ds_read_b128 a[132:135], v3 offset:0
    v_add_u32 v9, s49, v9
    s_nop 0
    v_exp_f32 v83, v83
    s_nop 0
    ds_read_b128 a[136:139], v4 offset:0
    v_cvt_pk_bf16_f32 v137, v82, v83
    s_nop 0
    v_exp_f32 v84, v84
    s_nop 0
    ds_read_b128 a[140:143], v5 offset:0
    v_add_u32 v10, s49, v10
    s_nop 0
    v_exp_f32 v85, v85
    s_nop 0
    ds_read_b128 a[144:147], v2 offset:4096
    v_cvt_pk_bf16_f32 v138, v84, v85
    s_nop 0
    v_exp_f32 v86, v86
    s_nop 0
    ds_read_b128 a[148:151], v3 offset:4096
    v_add_u32 v11, s49, v11
    s_nop 0
    v_exp_f32 v87, v87
    s_nop 0
    ds_read_b128 a[152:155], v4 offset:4096
    v_cvt_pk_bf16_f32 v139, v86, v87
    s_nop 0
    v_exp_f32 v88, v88
    s_nop 0
    ds_read_b128 a[156:159], v5 offset:4096
    v_add_u32 v12, s49, v12
    s_nop 0
    v_exp_f32 v89, v89
    s_nop 0
    v_cvt_pk_bf16_f32 v140, v88, v89
    s_nop 0
    v_exp_f32 v90, v90
    s_nop 0
    v_add_u32 v13, s49, v13
    s_nop 0
    v_exp_f32 v91, v91
    s_nop 0
    v_cvt_pk_bf16_f32 v141, v90, v91
    s_nop 0
    v_exp_f32 v92, v92
    s_nop 0
    v_exp_f32 v93, v93
    s_nop 0
    ds_read_b64_tr_b16 a[160:161], v6 offset:0
    v_cvt_pk_bf16_f32 v142, v92, v93
    s_nop 0
    v_exp_f32 v94, v94
    s_nop 0
    ds_read_b64_tr_b16 a[162:163], v6 offset:4096
    s_nop 0
    v_exp_f32 v95, v95
    s_nop 0
    ds_read_b64_tr_b16 a[164:165], v7 offset:0
    v_cvt_pk_bf16_f32 v143, v94, v95
    s_nop 0
    ds_read_b64_tr_b16 a[166:167], v7 offset:4096
    s_nop 0
    v_exp_f32 v96, v96
    s_nop 0
    ds_read_b64_tr_b16 a[168:169], v8 offset:0
    s_nop 0
    v_exp_f32 v97, v97
    s_nop 0
    s_waitcnt lgkmcnt(5)
    ds_read_b64_tr_b16 a[170:171], v8 offset:4096
    v_cvt_pk_bf16_f32 v144, v96, v97
    s_branch L_steady_q4
L_non4_spin:
    s_mov_b32 s53, 400000
L_non4_again:
    buffer_load_dwordx2 v[56:57], off, s[36:39], 0 offset:128 sc1
    s_waitcnt vmcnt(0)
    v_cmp_eq_u64 vcc, 0, v[56:57]
    s_sub_u32 s53, s53, 1
    s_nop 2
    s_cbranch_vccz L_non4_ok
    s_sleep 1
    s_cmp_lg_u32 s53, 0
    s_cbranch_scc1 L_non4_again
    s_branch L_non4_ok
L_fallback_q4:
    s_mov_b32 s55, 1
    v_lshrrev_b32 v24, 4, v1
    v_and_b32 v25, 15, v1
    v_and_b32 v26, 7, v25
    v_lshlrev_b32 v26, 1, v26
    v_xor_b32 v26, v24, v26
    v_lshlrev_b32 v28, 8, v25
    v_add_u32 v28, 49152, v28
    v_xor_b32 v27, 0, v26
    v_lshl_add_u32 v2, v27, 4, v28
    v_xor_b32 v27, 4, v26
    v_lshl_add_u32 v3, v27, 4, v28
    v_xor_b32 v27, 8, v26
    v_lshl_add_u32 v4, v27, 4, v28
    v_xor_b32 v27, 12, v26
    v_lshl_add_u32 v5, v27, 4, v28
    v_lshrrev_b32 v26, 2, v25
    v_and_b32 v27, 1, v24
    v_lshl_add_u32 v27, v27, 2, v26
    v_and_b32 v28, 3, v1
    v_cmp_eq_u32 vcc, 0, v28
    v_lshlrev_b32 v28, 3, v28
    v_lshl_add_u32 v29, v24, 2, v26
    v_lshl_add_u32 v29, v29, 8, v28
    v_add_u32 v29, 131072, v29
    v_xor_b32 v30, 0, v27
    v_lshl_add_u32 v6, v30, 5, v29
    v_xor_b32 v30, 1, v27
    v_lshl_add_u32 v7, v30, 5, v29
    v_xor_b32 v30, 2, v27
    v_lshl_add_u32 v8, v30, 5, v29
    v_xor_b32 v30, 3, v27
    v_lshl_add_u32 v9, v30, 5, v29
    v_xor_b32 v30, 4, v27
    v_lshl_add_u32 v10, v30, 5, v29
    v_xor_b32 v30, 5, v27
    v_lshl_add_u32 v11, v30, 5, v29
    v_xor_b32 v30, 6, v27
    v_lshl_add_u32 v12, v30, 5, v29
    v_xor_b32 v30, 7, v27
    v_lshl_add_u32 v13, v30, 5, v29
    v_mov_b32 v27, 0x3f803f80
    v_xor_b32 v26, v24, v25
    v_and_b32 v26, 2, v26
    v_cmp_eq_u32 vcc, 0, v26
    v_and_b32 v26, 1, v1
    v_mul_u32_u24 v26, 0xaaaa, v26
    v_add_u32 v59, 0x4444, v26
    v_cndmask_b32 v20, 0, v27, vcc
    v_cndmask_b32 v21, 0, v27, vcc
    v_cndmask_b32 v22, 0, v27, vcc
    v_cndmask_b32 v23, 0, v27, vcc
    s_mov_b32 s48, 49152
    s_mov_b32 s50, -65536
    s_mov_b32 s51, 16384
    s_mov_b32 s52, 32768
    v_mov_b32 v160, 0xff800000
    v_mov_b32 v164, 0xff800000
    v_mov_b32 v168, 0xff800000
    v_mov_b32 v172, 0xff800000
    s_mov_b32 s45, s54
    s_mov_b32 s53, 16
    s_waitcnt vmcnt(0)
L_fb_loop_q4:
    s_barrier
    s_mov_b32 s46, s45
    s_add_u32 m0, s54, 49152
    s_nop 0
    buffer_load_dwordx4 v14, s[12:15], s46 offen offset:0 nt lds
    buffer_load_dwordx4 v15, s[12:15], s46 offen offset:1024 nt lds
    buffer_load_dwordx4 v14, s[12:15], s46 offen offset:2048 nt lds
    buffer_load_dwordx4 v15, s[12:15], s46 offen offset:3072 nt lds
    s_waitcnt vmcnt(0)
    s_barrier
    ds_read_b128 a[128:131], v2 offset:0
    ds_read_b128 a[132:135], v3 offset:0
    ds_read_b128 a[136:139], v4 offset:0
    ds_read_b128 a[140:143], v5 offset:0
    ds_read_b128 a[144:147], v2 offset:4096
    ds_read_b128 a[148:151], v3 offset:4096
    ds_read_b128 a[152:155], v4 offset:4096
    ds_read_b128 a[156:159], v5 offset:4096
    s_waitcnt lgkmcnt(0)
    v_mfma_f32_16x16x32_bf16 v[64:67], a[128:131], v[192:195], 0
    v_mfma_f32_16x16x32_bf16 v[64:67], a[132:135], v[196:199], v[64:67]
    v_mfma_f32_16x16x32_bf16 v[64:67], a[136:139], v[200:203], v[64:67]
    v_mfma_f32_16x16x32_bf16 v[64:67], a[140:143], v[204:207], v[64:67]
    v_mfma_f32_16x16x32_bf16 v[68:71], a[144:147], v[192:195], 0
    v_mfma_f32_16x16x32_bf16 v[68:71], a[148:151], v[196:199], v[68:71]
    v_mfma_f32_16x16x32_bf16 v[68:71], a[152:155], v[200:203], v[68:71]
    v_mfma_f32_16x16x32_bf16 v[68:71], a[156:159], v[204:207], v[68:71]
    v_mfma_f32_16x16x32_bf16 v[72:75], a[128:131], v[208:211], 0
    v_mfma_f32_16x16x32_bf16 v[72:75], a[132:135], v[212:215], v[72:75]
    v_mfma_f32_16x16x32_bf16 v[72:75], a[136:139], v[216:219], v[72:75]
    v_mfma_f32_16x16x32_bf16 v[72:75], a[140:143], v[220:223], v[72:75]
    v_mfma_f32_16x16x32_bf16 v[76:79], a[144:147], v[208:211], 0
    v_mfma_f32_16x16x32_bf16 v[76:79], a[148:151], v[212:215], v[76:79]
    v_mfma_f32_16x16x32_bf16 v[76:79], a[152:155], v[216:219], v[76:79]
    v_mfma_f32_16x16x32_bf16 v[76:79], a[156:159], v[220:223], v[76:79]
    v_mfma_f32_16x16x32_bf16 v[80:83], a[128:131], v[224:227], 0
    v_mfma_f32_16x16x32_bf16 v[80:83], a[132:135], v[228:231], v[80:83]
    v_mfma_f32_16x16x32_bf16 v[80:83], a[136:139], v[232:235], v[80:83]
    v_mfma_f32_16x16x32_bf16 v[80:83], a[140:143], v[236:239], v[80:83]
    v_mfma_f32_16x16x32_bf16 v[84:87], a[144:147], v[224:227], 0
    v_mfma_f32_16x16x32_bf16 v[84:87], a[148:151], v[228:231], v[84:87]
    v_mfma_f32_16x16x32_bf16 v[84:87], a[152:155], v[232:235], v[84:87]
    v_mfma_f32_16x16x32_bf16 v[84:87], a[156:159], v[236:239], v[84:87]
    v_mfma_f32_16x16x32_bf16 v[88:91], a[128:131], v[240:243], 0
    v_mfma_f32_16x16x32_bf16 v[88:91], a[132:135], v[244:247], v[88:91]
    v_mfma_f32_16x16x32_bf16 v[88:91], a[136:139], v[248:251], v[88:91]
    v_mfma_f32_16x16x32_bf16 v[88:91], a[140:143], v[252:255], v[88:91]
    v_mfma_f32_16x16x32_bf16 v[92:95], a[144:147], v[240:243], 0
    v_mfma_f32_16x16x32_bf16 v[92:95], a[148:151], v[244:247], v[92:95]
    v_mfma_f32_16x16x32_bf16 v[92:95], a[152:155], v[248:251], v[92:95]
    v_mfma_f32_16x16x32_bf16 v[92:95], a[156:159], v[252:255], v[92:95]
    s_nop 7
    v_max3_f32 v160, v160, v64, v65
    v_max3_f32 v160, v160, v66, v67
    v_max3_f32 v160, v160, v68, v69
    v_max3_f32 v160, v160, v70, v71
    v_max3_f32 v164, v164, v72, v73
    v_max3_f32 v164, v164, v74, v75
    v_max3_f32 v164, v164, v76, v77
    v_max3_f32 v164, v164, v78, v79
    v_max3_f32 v168, v168, v80, v81
    v_max3_f32 v168, v168, v82, v83
    v_max3_f32 v168, v168, v84, v85
    v_max3_f32 v168, v168, v86, v87
    v_max3_f32 v172, v172, v88, v89
    v_max3_f32 v172, v172, v90, v91
    v_max3_f32 v172, v172, v92, v93
    v_max3_f32 v172, v172, v94, v95
    ds_read_b128 a[128:131], v2 offset:8192
    ds_read_b128 a[132:135], v3 offset:8192
    ds_read_b128 a[136:139], v4 offset:8192
    ds_read_b128 a[140:143], v5 offset:8192
    ds_read_b128 a[144:147], v2 offset:12288
    ds_read_b128 a[148:151], v3 offset:12288
    ds_read_b128 a[152:155], v4 offset:12288
    ds_read_b128 a[156:159], v5 offset:12288
    s_waitcnt lgkmcnt(0)
    v_mfma_f32_16x16x32_bf16 v[96:99], a[128:131], v[192:195], 0
    v_mfma_f32_16x16x32_bf16 v[96:99], a[132:135], v[196:199], v[96:99]
    v_mfma_f32_16x16x32_bf16 v[96:99], a[136:139], v[200:203], v[96:99]
    v_mfma_f32_16x16x32_bf16 v[96:99], a[140:143], v[204:207], v[96:99]
    v_mfma_f32_16x16x32_bf16 v[100:103], a[144:147], v[192:195], 0
    v_mfma_f32_16x16x32_bf16 v[100:103], a[148:151], v[196:199], v[100:103]
    v_mfma_f32_16x16x32_bf16 v[100:103], a[152:155], v[200:203], v[100:103]
    v_mfma_f32_16x16x32_bf16 v[100:103], a[156:159], v[204:207], v[100:103]
    v_mfma_f32_16x16x32_bf16 v[104:107], a[128:131], v[208:211], 0
    v_mfma_f32_16x16x32_bf16 v[104:107], a[132:135], v[212:215], v[104:107]
    v_mfma_f32_16x16x32_bf16 v[104:107], a[136:139], v[216:219], v[104:107]
    v_mfma_f32_16x16x32_bf16 v[104:107], a[140:143], v[220:223], v[104:107]
    v_mfma_f32_16x16x32_bf16 v[108:111], a[144:147], v[208:211], 0
    v_mfma_f32_16x16x32_bf16 v[108:111], a[148:151], v[212:215], v[108:111]
    v_mfma_f32_16x16x32_bf16 v[108:111], a[152:155], v[216:219], v[108:111]
    v_mfma_f32_16x16x32_bf16 v[108:111], a[156:159], v[220:223], v[108:111]
    v_mfma_f32_16x16x32_bf16 v[112:115], a[128:131], v[224:227], 0
    v_mfma_f32_16x16x32_bf16 v[112:115], a[132:135], v[228:231], v[112:115]
    v_mfma_f32_16x16x32_bf16 v[112:115], a[136:139], v[232:235], v[112:115]
    v_mfma_f32_16x16x32_bf16 v[112:115], a[140:143], v[236:239], v[112:115]
    v_mfma_f32_16x16x32_bf16 v[116:119], a[144:147], v[224:227], 0
    v_mfma_f32_16x16x32_bf16 v[116:119], a[148:151], v[228:231], v[116:119]
    v_mfma_f32_16x16x32_bf16 v[116:119], a[152:155], v[232:235], v[116:119]
    v_mfma_f32_16x16x32_bf16 v[116:119], a[156:159], v[236:239], v[116:119]
    v_mfma_f32_16x16x32_bf16 v[120:123], a[128:131], v[240:243], 0
    v_mfma_f32_16x16x32_bf16 v[120:123], a[132:135], v[244:247], v[120:123]
    v_mfma_f32_16x16x32_bf16 v[120:123], a[136:139], v[248:251], v[120:123]
    v_mfma_f32_16x16x32_bf16 v[120:123], a[140:143], v[252:255], v[120:123]
    v_mfma_f32_16x16x32_bf16 v[124:127], a[144:147], v[240:243], 0
    v_mfma_f32_16x16x32_bf16 v[124:127], a[148:151], v[244:247], v[124:127]
    v_mfma_f32_16x16x32_bf16 v[124:127], a[152:155], v[248:251], v[124:127]
    v_mfma_f32_16x16x32_bf16 v[124:127], a[156:159], v[252:255], v[124:127]
    s_nop 7
    v_max3_f32 v160, v160, v96, v97
    v_max3_f32 v160, v160, v98, v99
    v_max3_f32 v160, v160, v100, v101
    v_max3_f32 v160, v160, v102, v103
    v_max3_f32 v164, v164, v104, v105
    v_max3_f32 v164, v164, v106, v107
    v_max3_f32 v164, v164, v108, v109
    v_max3_f32 v164, v164, v110, v111
    v_max3_f32 v168, v168, v112, v113
    v_max3_f32 v168, v168, v114, v115
    v_max3_f32 v168, v168, v116, v117
    v_max3_f32 v168, v168, v118, v119
    v_max3_f32 v172, v172, v120, v121
    v_max3_f32 v172, v172, v122, v123
    v_max3_f32 v172, v172, v124, v125
    v_max3_f32 v172, v172, v126, v127
    s_add_u32 s45, s45, 16384
    s_sub_u32 s53, s53, 1
    s_cmp_lg_u32 s53, 0
    s_cbranch_scc1 L_fb_loop_q4
    v_mov_b32 v24, v160
    v_mov_b32 v25, v164
    v_mov_b32 v26, v168
    v_mov_b32 v27, v172
    s_nop 1
    v_permlane32_swap_b32 v24, v160
    v_permlane32_swap_b32 v25, v164
    v_permlane32_swap_b32 v26, v168
    v_permlane32_swap_b32 v27, v172
    s_nop 1
    v_max_f32 v160, v160, v24
    v_max_f32 v164, v164, v25
    v_max_f32 v168, v168, v26
    v_max_f32 v172, v172, v27
    v_mov_b32 v24, v160
    v_mov_b32 v25, v164
    v_mov_b32 v26, v168
    v_mov_b32 v27, v172
    s_nop 1
    v_permlane16_swap_b32 v24, v160
    v_permlane16_swap_b32 v25, v164
    v_permlane16_swap_b32 v26, v168
    v_permlane16_swap_b32 v27, v172
    s_nop 1
    v_max_f32 v160, v160, v24
    v_max_f32 v164, v164, v25
    v_max_f32 v168, v168, v26
    v_max_f32 v172, v172, v27
    v_sub_f32 v163, 0, v160
    v_sub_f32 v162, 0, v160
    v_sub_f32 v161, 0, v160
    v_sub_f32 v160, 0, v160
    v_sub_f32 v167, 0, v164
    v_sub_f32 v166, 0, v164
    v_sub_f32 v165, 0, v164
    v_sub_f32 v164, 0, v164
    v_sub_f32 v171, 0, v168
    v_sub_f32 v170, 0, v168
    v_sub_f32 v169, 0, v168
    v_sub_f32 v168, 0, v168
    v_sub_f32 v175, 0, v172
    v_sub_f32 v174, 0, v172
    v_sub_f32 v173, 0, v172
    v_sub_f32 v172, 0, v172
    s_barrier
    s_add_u32 s46, s54, 0
    s_add_u32 m0, s54, 49152
    s_nop 0
    buffer_load_dwordx4 v14, s[12:15], s46 offen offset:0 nt lds
    buffer_load_dwordx4 v15, s[12:15], s46 offen offset:1024 nt lds
    buffer_load_dwordx4 v14, s[12:15], s46 offen offset:2048 nt lds
    buffer_load_dwordx4 v15, s[12:15], s46 offen offset:3072 nt lds
    s_add_u32 s46, s54, 16384
    s_add_u32 m0, s54, 65536
    s_nop 0
    buffer_load_dwordx4 v14, s[12:15], s46 offen offset:0 nt lds
    buffer_load_dwordx4 v15, s[12:15], s46 offen offset:1024 nt lds
    buffer_load_dwordx4 v14, s[12:15], s46 offen offset:2048 nt lds
    buffer_load_dwordx4 v15, s[12:15], s46 offen offset:3072 nt lds
    s_add_u32 s46, s54, 0
    s_add_u32 m0, s54, 147456
    s_nop 0
    buffer_load_dwordx4 v14, s[16:19], s46 offen offset:0 nt lds
    buffer_load_dwordx4 v15, s[16:19], s46 offen offset:1024 nt lds
    buffer_load_dwordx4 v14, s[16:19], s46 offen offset:2048 nt lds
    buffer_load_dwordx4 v15, s[16:19], s46 offen offset:3072 nt lds
    s_add_u32 s46, s54, 32768
    s_add_u32 m0, s54, 0
    s_nop 0
    buffer_load_dwordx4 v14, s[12:15], s46 offen offset:0 nt lds
    buffer_load_dwordx4 v15, s[12:15], s46 offen offset:1024 nt lds
    buffer_load_dwordx4 v14, s[12:15], s46 offen offset:2048 nt lds
    buffer_load_dwordx4 v15, s[12:15], s46 offen offset:3072 nt lds
    s_add_u32 s46, s54, 16384
    s_add_u32 m0, s54, 81920
    s_nop 0
    buffer_load_dwordx4 v14, s[16:19], s46 offen offset:0 nt lds
    buffer_load_dwordx4 v15, s[16:19], s46 offen offset:1024 nt lds
    buffer_load_dwordx4 v14, s[16:19], s46 offen offset:2048 nt lds
    buffer_load_dwordx4 v15, s[16:19], s46 offen offset:3072 nt lds
    s_add_u32 s46, s54, 49152
    s_add_u32 m0, s54, 16384
    s_nop 0
    buffer_load_dwordx4 v14, s[12:15], s46 offen offset:0 nt lds
    buffer_load_dwordx4 v15, s[12:15], s46 offen offset:1024 nt lds
    buffer_load_dwordx4 v14, s[12:15], s46 offen offset:2048 nt lds
    buffer_load_dwordx4 v15, s[12:15], s46 offen offset:3072 nt lds
    s_add_u32 s46, s54, 32768
    s_add_u32 m0, s54, 98304
    s_nop 0
    buffer_load_dwordx4 v14, s[16:19], s46 offen offset:0 nt lds
    buffer_load_dwordx4 v15, s[16:19], s46 offen offset:1024 nt lds
    buffer_load_dwordx4 v14, s[16:19], s46 offen offset:2048 nt lds
    buffer_load_dwordx4 v15, s[16:19], s46 offen offset:3072 nt lds
    s_add_u32 s46, s54, 65536
    s_add_u32 m0, s54, 32768
    s_nop 0
    buffer_load_dwordx4 v14, s[12:15], s46 offen offset:0 nt lds
    buffer_load_dwordx4 v15, s[12:15], s46 offen offset:1024 nt lds
    buffer_load_dwordx4 v14, s[12:15], s46 offen offset:2048 nt lds
    buffer_load_dwordx4 v15, s[12:15], s46 offen offset:3072 nt lds
    s_add_u32 s46, s54, 49152
    s_add_u32 m0, s54, 114688
    s_nop 0
    buffer_load_dwordx4 v14, s[16:19], s46 offen offset:0 nt lds
    buffer_load_dwordx4 v15, s[16:19], s46 offen offset:1024 nt lds
    buffer_load_dwordx4 v14, s[16:19], s46 offen offset:2048 nt lds
    buffer_load_dwordx4 v15, s[16:19], s46 offen offset:3072 nt lds
    v_accvgpr_write_b32 a0, 0
    v_accvgpr_write_b32 a1, 0
    v_accvgpr_write_b32 a2, 0
    v_accvgpr_write_b32 a3, 0
    v_accvgpr_write_b32 a4, 0
    v_accvgpr_write_b32 a5, 0
    v_accvgpr_write_b32 a6, 0
    v_accvgpr_write_b32 a7, 0
    v_accvgpr_write_b32 a8, 0
    v_accvgpr_write_b32 a9, 0
    v_accvgpr_write_b32 a10, 0
    v_accvgpr_write_b32 a11, 0
    v_accvgpr_write_b32 a12, 0
    v_accvgpr_write_b32 a13, 0
    v_accvgpr_write_b32 a14, 0
    v_accvgpr_write_b32 a15, 0
    v_accvgpr_write_b32 a16, 0
    v_accvgpr_write_b32 a17, 0
    v_accvgpr_write_b32 a18, 0
    v_accvgpr_write_b32 a19, 0
    v_accvgpr_write_b32 a20, 0
    v_accvgpr_write_b32 a21, 0
    v_accvgpr_write_b32 a22, 0
    v_accvgpr_write_b32 a23, 0
    v_accvgpr_write_b32 a24, 0
    v_accvgpr_write_b32 a25, 0
    v_accvgpr_write_b32 a26, 0
    v_accvgpr_write_b32 a27, 0
    v_accvgpr_write_b32 a28, 0
    v_accvgpr_write_b32 a29, 0
    v_accvgpr_write_b32 a30, 0
    v_accvgpr_write_b32 a31, 0
    v_accvgpr_write_b32 a32, 0
    v_accvgpr_write_b32 a33, 0
    v_accvgpr_write_b32 a34, 0
    v_accvgpr_write_b32 a35, 0
    v_accvgpr_write_b32 a36, 0
    v_accvgpr_write_b32 a37, 0
    v_accvgpr_write_b32 a38, 0
    v_accvgpr_write_b32 a39, 0
    v_accvgpr_write_b32 a40, 0
    v_accvgpr_write_b32 a41, 0
    v_accvgpr_write_b32 a42, 0
    v_accvgpr_write_b32 a43, 0
    v_accvgpr_write_b32 a44, 0
    v_accvgpr_write_b32 a45, 0
    v_accvgpr_write_b32 a46, 0
    v_accvgpr_write_b32 a47, 0
    v_accvgpr_write_b32 a48, 0
    v_accvgpr_write_b32 a49, 0
    v_accvgpr_write_b32 a50, 0
    v_accvgpr_write_b32 a51, 0
    v_accvgpr_write_b32 a52, 0
    v_accvgpr_write_b32 a53, 0
    v_accvgpr_write_b32 a54, 0
    v_accvgpr_write_b32 a55, 0
    v_accvgpr_write_b32 a56, 0
    v_accvgpr_write_b32 a57, 0
    v_accvgpr_write_b32 a58, 0
    v_accvgpr_write_b32 a59, 0
    v_accvgpr_write_b32 a60, 0
    v_accvgpr_write_b32 a61, 0
    v_accvgpr_write_b32 a62, 0
    v_accvgpr_write_b32 a63, 0
    v_accvgpr_write_b32 a64, 0
    v_accvgpr_write_b32 a65, 0
    v_accvgpr_write_b32 a66, 0
    v_accvgpr_write_b32 a67, 0
    v_accvgpr_write_b32 a68, 0
    v_accvgpr_write_b32 a69, 0
    v_accvgpr_write_b32 a70, 0
    v_accvgpr_write_b32 a71, 0
    v_accvgpr_write_b32 a72, 0
    v_accvgpr_write_b32 a73, 0
    v_accvgpr_write_b32 a74, 0
    v_accvgpr_write_b32 a75, 0
    v_accvgpr_write_b32 a76, 0
    v_accvgpr_write_b32 a77, 0
    v_accvgpr_write_b32 a78, 0
    v_accvgpr_write_b32 a79, 0
    v_accvgpr_write_b32 a80, 0
    v_accvgpr_write_b32 a81, 0
    v_accvgpr_write_b32 a82, 0
    v_accvgpr_write_b32 a83, 0
    v_accvgpr_write_b32 a84, 0
    v_accvgpr_write_b32 a85, 0
    v_accvgpr_write_b32 a86, 0
    v_accvgpr_write_b32 a87, 0
    v_accvgpr_write_b32 a88, 0
    v_accvgpr_write_b32 a89, 0
    v_accvgpr_write_b32 a90, 0
    v_accvgpr_write_b32 a91, 0
    v_accvgpr_write_b32 a92, 0
    v_accvgpr_write_b32 a93, 0
    v_accvgpr_write_b32 a94, 0
    v_accvgpr_write_b32 a95, 0
    v_accvgpr_write_b32 a96, 0
    v_accvgpr_write_b32 a97, 0
    v_accvgpr_write_b32 a98, 0
    v_accvgpr_write_b32 a99, 0
    v_accvgpr_write_b32 a100, 0
    v_accvgpr_write_b32 a101, 0
    v_accvgpr_write_b32 a102, 0
    v_accvgpr_write_b32 a103, 0
    v_accvgpr_write_b32 a104, 0
    v_accvgpr_write_b32 a105, 0
    v_accvgpr_write_b32 a106, 0
    v_accvgpr_write_b32 a107, 0
    v_accvgpr_write_b32 a108, 0
    v_accvgpr_write_b32 a109, 0
    v_accvgpr_write_b32 a110, 0
    v_accvgpr_write_b32 a111, 0
    v_accvgpr_write_b32 a112, 0
    v_accvgpr_write_b32 a113, 0
    v_accvgpr_write_b32 a114, 0
    v_accvgpr_write_b32 a115, 0
    v_accvgpr_write_b32 a116, 0
    v_accvgpr_write_b32 a117, 0
    v_accvgpr_write_b32 a118, 0
    v_accvgpr_write_b32 a119, 0
    v_accvgpr_write_b32 a120, 0
    v_accvgpr_write_b32 a121, 0
    v_accvgpr_write_b32 a122, 0
    v_accvgpr_write_b32 a123, 0
    v_accvgpr_write_b32 a124, 0
    v_accvgpr_write_b32 a125, 0
    v_accvgpr_write_b32 a126, 0
    v_accvgpr_write_b32 a127, 0
    v_accvgpr_write_b32 a192, 0
    v_accvgpr_write_b32 a193, 0
    v_accvgpr_write_b32 a194, 0
    v_accvgpr_write_b32 a195, 0
    v_accvgpr_write_b32 a196, 0
    v_accvgpr_write_b32 a197, 0
    v_accvgpr_write_b32 a198, 0
    v_accvgpr_write_b32 a199, 0
    s_mov_b32 s51, 49152
    s_mov_b32 s52, 65536
    s_mov_b32 s58, 65536
    s_mov_b32 s60, 16384
    s_waitcnt vmcnt(0)
    s_barrier
    ds_read_b128 a[128:131], v2 offset:0
    ds_read_b128 a[132:135], v3 offset:0
    ds_read_b128 a[136:139], v4 offset:0
    ds_read_b128 a[140:143], v5 offset:0
    ds_read_b128 a[144:147], v2 offset:4096
    ds_read_b128 a[148:151], v3 offset:4096
    ds_read_b128 a[152:155], v4 offset:4096
    ds_read_b128 a[156:159], v5 offset:4096
    s_waitcnt lgkmcnt(0)
    v_mfma_f32_16x16x32_bf16 v[64:67], a[128:131], v[192:195], v[160:163]
    v_mfma_f32_16x16x32_bf16 v[64:67], a[132:135], v[196:199], v[64:67]
    v_mfma_f32_16x16x32_bf16 v[64:67], a[136:139], v[200:203], v[64:67]
    v_mfma_f32_16x16x32_bf16 v[64:67], a[140:143], v[204:207], v[64:67]
    v_mfma_f32_16x16x32_bf16 v[68:71], a[144:147], v[192:195], v[160:163]
    v_mfma_f32_16x16x32_bf16 v[68:71], a[148:151], v[196:199], v[68:71]
    v_mfma_f32_16x16x32_bf16 v[68:71], a[152:155], v[200:203], v[68:71]
    v_mfma_f32_16x16x32_bf16 v[68:71], a[156:159], v[204:207], v[68:71]
    v_mfma_f32_16x16x32_bf16 v[72:75], a[128:131], v[208:211], v[164:167]
    v_mfma_f32_16x16x32_bf16 v[72:75], a[132:135], v[212:215], v[72:75]
    v_mfma_f32_16x16x32_bf16 v[72:75], a[136:139], v[216:219], v[72:75]
    v_mfma_f32_16x16x32_bf16 v[72:75], a[140:143], v[220:223], v[72:75]
    v_mfma_f32_16x16x32_bf16 v[76:79], a[144:147], v[208:211], v[164:167]
    v_mfma_f32_16x16x32_bf16 v[76:79], a[148:151], v[212:215], v[76:79]
    v_mfma_f32_16x16x32_bf16 v[76:79], a[152:155], v[216:219], v[76:79]
    v_mfma_f32_16x16x32_bf16 v[76:79], a[156:159], v[220:223], v[76:79]
    v_mfma_f32_16x16x32_bf16 v[80:83], a[128:131], v[224:227], v[168:171]
    v_mfma_f32_16x16x32_bf16 v[80:83], a[132:135], v[228:231], v[80:83]
    v_mfma_f32_16x16x32_bf16 v[80:83], a[136:139], v[232:235], v[80:83]
    v_mfma_f32_16x16x32_bf16 v[80:83], a[140:143], v[236:239], v[80:83]
    v_mfma_f32_16x16x32_bf16 v[84:87], a[144:147], v[224:227], v[168:171]
    v_mfma_f32_16x16x32_bf16 v[84:87], a[148:151], v[228:231], v[84:87]
    v_mfma_f32_16x16x32_bf16 v[84:87], a[152:155], v[232:235], v[84:87]
    v_mfma_f32_16x16x32_bf16 v[84:87], a[156:159], v[236:239], v[84:87]
    v_mfma_f32_16x16x32_bf16 v[88:91], a[128:131], v[240:243], v[172:175]
    v_mfma_f32_16x16x32_bf16 v[88:91], a[132:135], v[244:247], v[88:91]
    v_mfma_f32_16x16x32_bf16 v[88:91], a[136:139], v[248:251], v[88:91]
    v_mfma_f32_16x16x32_bf16 v[88:91], a[140:143], v[252:255], v[88:91]
    v_mfma_f32_16x16x32_bf16 v[92:95], a[144:147], v[240:243], v[172:175]
    v_mfma_f32_16x16x32_bf16 v[92:95], a[148:151], v[244:247], v[92:95]
    v_mfma_f32_16x16x32_bf16 v[92:95], a[152:155], v[248:251], v[92:95]
    v_mfma_f32_16x16x32_bf16 v[92:95], a[156:159], v[252:255], v[92:95]
    s_nop 7
    s_branch L_attn_q4
L_attn_q3:
    ds_read_b128 a[128:131], v2 offset:8192
    s_nop 0
    ds_read_b128 a[132:135], v3 offset:8192
    s_nop 0
    ds_read_b128 a[136:139], v4 offset:8192
    s_nop 0
    ds_read_b128 a[140:143], v5 offset:8192
    s_nop 0
    ds_read_b128 a[144:147], v2 offset:12288
    s_nop 0
    ds_read_b128 a[148:151], v3 offset:12288
    s_nop 0
    ds_read_b128 a[152:155], v4 offset:12288
    s_nop 0
    ds_read_b128 a[156:159], v5 offset:12288
    s_nop 0
    v_exp_f32 v64, v64
    s_nop 0
    v_exp_f32 v65, v65
    s_nop 0
    s_waitcnt lgkmcnt(0)
    v_cvt_pk_bf16_f32 v128, v64, v65
    v_mfma_f32_16x16x32_bf16 v[96:99], a[128:131], v[192:195], v[160:163]
    s_cmp_eq_u32 s48, 65536
    s_cselect_b32 s49, s50, 16384
    v_exp_f32 v66, v66
    v_mfma_f32_16x16x32_bf16 v[96:99], a[132:135], v[196:199], v[96:99]
    s_add_u32 s48, s48, s49
    v_mfma_f32_16x16x32_bf16 v[96:99], a[136:139], v[200:203], v[96:99]
    v_exp_f32 v67, v67
    v_mfma_f32_16x16x32_bf16 v[96:99], a[140:143], v[204:207], v[96:99]
    v_cvt_pk_bf16_f32 v129, v66, v67
    v_mfma_f32_16x16x32_bf16 v[100:103], a[144:147], v[192:195], v[160:163]
    v_exp_f32 v68, v68
    v_mfma_f32_16x16x32_bf16 v[100:103], a[148:151], v[196:199], v[100:103]
    v_add_u32 v2, s49, v2
    v_mfma_f32_16x16x32_bf16 v[100:103], a[152:155], v[200:203], v[100:103]
    v_exp_f32 v69, v69
    v_mfma_f32_16x16x32_bf16 v[100:103], a[156:159], v[204:207], v[100:103]
    v_cvt_pk_bf16_f32 v130, v68, v69
    v_mfma_f32_16x16x32_bf16 v[104:107], a[128:131], v[208:211], v[164:167]
    v_exp_f32 v70, v70
    v_mfma_f32_16x16x32_bf16 v[104:107], a[132:135], v[212:215], v[104:107]
    v_add_u32 v3, s49, v3
    v_mfma_f32_16x16x32_bf16 v[104:107], a[136:139], v[216:219], v[104:107]
    v_exp_f32 v71, v71
    v_mfma_f32_16x16x32_bf16 v[104:107], a[140:143], v[220:223], v[104:107]
    v_cvt_pk_bf16_f32 v131, v70, v71
    v_mfma_f32_16x16x32_bf16 v[108:111], a[144:147], v[208:211], v[164:167]
    v_exp_f32 v72, v72
    v_mfma_f32_16x16x32_bf16 v[108:111], a[148:151], v[212:215], v[108:111]
    v_add_u32 v4, s49, v4
    v_mfma_f32_16x16x32_bf16 v[108:111], a[152:155], v[216:219], v[108:111]
    v_exp_f32 v73, v73
    v_mfma_f32_16x16x32_bf16 v[108:111], a[156:159], v[220:223], v[108:111]
    s_getreg_b32 s47, hwreg(HW_REG_IB_STS, 0, 24)
    v_cvt_pk_bf16_f32 v132, v72, v73
    v_mfma_f32_16x16x32_bf16 v[112:115], a[128:131], v[224:227], v[168:171]
    s_lshr_b32 s59, s47, 22
    v_exp_f32 v74, v74
    v_mfma_f32_16x16x32_bf16 v[112:115], a[132:135], v[228:231], v[112:115]
    s_and_b32 s47, s47, 15
    v_add_u32 v5, s49, v5
    v_mfma_f32_16x16x32_bf16 v[112:115], a[136:139], v[232:235], v[112:115]
    s_lshl4_add_u32 s47, s59, s47
    v_exp_f32 v75, v75
    v_mfma_f32_16x16x32_bf16 v[112:115], a[140:143], v[236:239], v[112:115]
    s_lshl_b32 s47, s47, 9
    v_cvt_pk_bf16_f32 v133, v74, v75
    v_mfma_f32_16x16x32_bf16 v[116:119], a[144:147], v[224:227], v[168:171]
    s_add_u32 s47, s47, s60
    v_exp_f32 v76, v76
    v_mfma_f32_16x16x32_bf16 v[116:119], a[148:151], v[228:231], v[116:119]
    s_cmp_le_u32 s47, s52
    v_add_u32 v6, s49, v6
    v_add_u32 v7, s49, v7
    v_mfma_f32_16x16x32_bf16 v[116:119], a[152:155], v[232:235], v[116:119]
    s_cbranch_scc0 L_dqwait_p
L_dqok_p:
    s_barrier
    v_exp_f32 v77, v77
    v_mfma_f32_16x16x32_bf16 v[116:119], a[156:159], v[236:239], v[116:119]
    s_cmp_lt_u32 s60, 16384
    s_cselect_b32 s47, -3, 0
    ds_read_b128 a[128:131], v2 offset:0
    v_cvt_pk_bf16_f32 v134, v76, v77
    s_nop 0
    s_lshl_b32 s47, s47, 9
    s_sub_u32 s58, s58, s47
    v_exp_f32 v78, v78
    s_nop 0
    s_add_u32 s58, s58, 14848
    s_add_u32 s47, s60, 65536
    ds_read_b128 a[132:135], v3 offset:0
    v_add_u32 v8, s49, v8
    v_add_u32 v9, s49, v9
    s_nop 0
    s_min_u32 s58, s58, s47
    s_min_u32 s58, s58, 262144
    s_add_u32 s60, s60, 16384
    v_exp_f32 v79, v79
    s_nop 0
    s_bitcmp1_b32 s52, 12
    s_cselect_b64 s[4:5], s[16:17], s[20:21]
    ds_read_b128 a[136:139], v4 offset:0
    v_cvt_pk_bf16_f32 v135, v78, v79
    s_nop 0
    s_cselect_b32 s6, s18, s22
    s_cselect_b32 s59, 77824, 0
    v_exp_f32 v80, v80
    s_nop 0
    s_add_u32 m0, s51, s59
    s_andn2_b32 s59, s52, 4096
    ds_read_b128 a[140:143], v5 offset:0
    v_add_u32 v10, s49, v10
    v_add_u32 v11, s49, v11
    s_nop 0
    s_getreg_b32 s47, hwreg(HW_REG_IB_STS, 0, 24)
    v_exp_f32 v81, v81
    s_nop 0
    s_and_b32 s47, s47, 0xc0000f
    ds_read_b128 a[144:147], v2 offset:4096
    v_cvt_pk_bf16_f32 v136, v80, v81
    s_nop 0
    s_cmp_le_u32 s47, 4194306
    v_exp_f32 v82, v82
    s_nop 0
    s_cselect_b32 s47, s58, 0
    ds_read_b128 a[148:151], v3 offset:4096
    v_add_u32 v12, s49, v12
    s_nop 0
    s_cmp_lt_u32 s52, s47
    v_exp_f32 v83, v83
    s_nop 0
    s_cbranch_scc0 L_dq_p_0
    buffer_load_dwordx4 v14, s[4:7], s59 offen offset:0 nt lds
    buffer_load_dwordx4 v15, s[4:7], s59 offen offset:1024 nt lds
    buffer_load_dwordx4 v14, s[4:7], s59 offen offset:2048 nt lds
    buffer_load_dwordx4 v15, s[4:7], s59 offen offset:3072 nt lds
    s_add_u32 m0, m0, 4096
    s_add_u32 s59, s59, 4096
    buffer_load_dwordx4 v14, s[4:7], s59 offen offset:0 nt lds
    buffer_load_dwordx4 v15, s[4:7], s59 offen offset:1024 nt lds
    buffer_load_dwordx4 v14, s[4:7], s59 offen offset:2048 nt lds
    buffer_load_dwordx4 v15, s[4:7], s59 offen offset:3072 nt lds
    s_add_u32 s52, s52, 4096
    s_add_u32 s51, s51, 4096
L_dq_p_0:
    ds_read_b128 a[152:155], v4 offset:4096
    v_cvt_pk_bf16_f32 v137, v82, v83
    s_nop 0
    s_cmp_eq_u32 s51, 81920
    v_exp_f32 v84, v84
    s_nop 0
    s_cselect_b32 s51, 0, s51
    ds_read_b128 a[156:159], v5 offset:4096
    v_add_u32 v13, s49, v13
    s_nop 0
    v_exp_f32 v85, v85
    s_nop 0
    ds_read_b64_tr_b16 a[160:161], v6 offset:0
    v_cvt_pk_bf16_f32 v138, v84, v85
    s_nop 0
    v_exp_f32 v86, v86
    s_nop 0
    ds_read_b64_tr_b16 a[162:163], v6 offset:4096
    s_nop 0
    v_exp_f32 v87, v87
    s_nop 0
    ds_read_b64_tr_b16 a[164:165], v7 offset:0
    v_cvt_pk_bf16_f32 v139, v86, v87
    s_nop 0
    ds_read_b64_tr_b16 a[166:167], v7 offset:4096
    s_nop 0
    ds_read_b64_tr_b16 a[168:169], v8 offset:0
    s_nop 0
    v_exp_f32 v96, v96
    s_nop 0
    ds_read_b64_tr_b16 a[170:171], v8 offset:4096
    s_nop 0
    v_exp_f32 v97, v97
    s_nop 0
    s_waitcnt lgkmcnt(6)
    ds_read_b64_tr_b16 a[172:173], v9 offset:0
    v_cvt_pk_bf16_f32 v144, v96, v97
    s_branch L_steady_q3
L_non3_spin:
    s_mov_b32 s53, 400000
L_non3_again:
    buffer_load_dwordx2 v[56:57], off, s[36:39], 0 offset:128 sc1
    s_waitcnt vmcnt(0)
    v_cmp_eq_u64 vcc, 0, v[56:57]
    s_sub_u32 s53, s53, 1
    s_nop 2
    s_cbranch_vccz L_non3_ok
    s_sleep 1
    s_cmp_lg_u32 s53, 0
    s_cbranch_scc1 L_non3_again
    s_branch L_non3_ok
L_fallback_q3:
    s_mov_b32 s55, 1
    v_lshrrev_b32 v24, 4, v1
    v_and_b32 v25, 15, v1
    v_and_b32 v26, 7, v25
    v_lshlrev_b32 v26, 1, v26
    v_xor_b32 v26, v24, v26
    v_lshlrev_b32 v28, 8, v25
    v_add_u32 v28, 49152, v28
    v_xor_b32 v27, 0, v26
    v_lshl_add_u32 v2, v27, 4, v28
    v_xor_b32 v27, 4, v26
    v_lshl_add_u32 v3, v27, 4, v28
    v_xor_b32 v27, 8, v26
    v_lshl_add_u32 v4, v27, 4, v28
    v_xor_b32 v27, 12, v26
    v_lshl_add_u32 v5, v27, 4, v28
    v_lshrrev_b32 v26, 2, v25
    v_and_b32 v27, 1, v24
    v_lshl_add_u32 v27, v27, 2, v26
    v_and_b32 v28, 3, v1
    v_cmp_eq_u32 vcc, 0, v28
    v_lshlrev_b32 v28, 3, v28
    v_lshl_add_u32 v29, v24, 2, v26
    v_lshl_add_u32 v29, v29, 8, v28
    v_add_u32 v29, 131072, v29
    v_xor_b32 v30, 0, v27
    v_lshl_add_u32 v6, v30, 5, v29
    v_xor_b32 v30, 1, v27
    v_lshl_add_u32 v7, v30, 5, v29
    v_xor_b32 v30, 2, v27
    v_lshl_add_u32 v8, v30, 5, v29
    v_xor_b32 v30, 3, v27
    v_lshl_add_u32 v9, v30, 5, v29
    v_xor_b32 v30, 4, v27
    v_lshl_add_u32 v10, v30, 5, v29
    v_xor_b32 v30, 5, v27
    v_lshl_add_u32 v11, v30, 5, v29
    v_xor_b32 v30, 6, v27
    v_lshl_add_u32 v12, v30, 5, v29
    v_xor_b32 v30, 7, v27
    v_lshl_add_u32 v13, v30, 5, v29
    v_mov_b32 v27, 0x3f803f80
    v_xor_b32 v26, v24, v25
    v_and_b32 v26, 2, v26
    v_cmp_eq_u32 vcc, 0, v26
    v_and_b32 v26, 1, v1
    v_mul_u32_u24 v26, 0xaaaa, v26
    v_add_u32 v59, 0x4444, v26
    v_cndmask_b32 v20, 0, v27, vcc
    v_cndmask_b32 v21, 0, v27, vcc
    v_cndmask_b32 v22, 0, v27, vcc
    v_cndmask_b32 v23, 0, v27, vcc
    s_mov_b32 s48, 49152
    s_mov_b32 s50, -65536
    s_mov_b32 s51, 16384
    s_mov_b32 s52, 32768
    v_mov_b32 v160, 0xff800000
    v_mov_b32 v164, 0xff800000
    v_mov_b32 v168, 0xff800000
    s_mov_b32 s45, s54
    s_mov_b32 s53, 16
    s_waitcnt vmcnt(0)
L_fb_loop_q3:
    s_barrier
    s_mov_b32 s46, s45
    s_add_u32 m0, s54, 49152
    s_nop 0
    buffer_load_dwordx4 v14, s[12:15], s46 offen offset:0 nt lds
    buffer_load_dwordx4 v15, s[12:15], s46 offen offset:1024 nt lds
    buffer_load_dwordx4 v14, s[12:15], s46 offen offset:2048 nt lds
    buffer_load_dwordx4 v15, s[12:15], s46 offen offset:3072 nt lds
    s_waitcnt vmcnt(0)
    s_barrier
    ds_read_b128 a[128:131], v2 offset:0
    ds_read_b128 a[132:135], v3 offset:0
    ds_read_b128 a[136:139], v4 offset:0
    ds_read_b128 a[140:143], v5 offset:0
    ds_read_b128 a[144:147], v2 offset:4096
    ds_read_b128 a[148:151], v3 offset:4096
    ds_read_b128 a[152:155], v4 offset:4096
    ds_read_b128 a[156:159], v5 offset:4096
    s_waitcnt lgkmcnt(0)
    v_mfma_f32_16x16x32_bf16 v[64:67], a[128:131], v[192:195], 0
    v_mfma_f32_16x16x32_bf16 v[64:67], a[132:135], v[196:199], v[64:67]
    v_mfma_f32_16x16x32_bf16 v[64:67], a[136:139], v[200:203], v[64:67]
    v_mfma_f32_16x16x32_bf16 v[64:67], a[140:143], v[204:207], v[64:67]
    v_mfma_f32_16x16x32_bf16 v[68:71], a[144:147], v[192:195], 0
    v_mfma_f32_16x16x32_bf16 v[68:71], a[148:151], v[196:199], v[68:71]
    v_mfma_f32_16x16x32_bf16 v[68:71], a[152:155], v[200:203], v[68:71]
    v_mfma_f32_16x16x32_bf16 v[68:71], a[156:159], v[204:207], v[68:71]
    v_mfma_f32_16x16x32_bf16 v[72:75], a[128:131], v[208:211], 0
    v_mfma_f32_16x16x32_bf16 v[72:75], a[132:135], v[212:215], v[72:75]
    v_mfma_f32_16x16x32_bf16 v[72:75], a[136:139], v[216:219], v[72:75]
    v_mfma_f32_16x16x32_bf16 v[72:75], a[140:143], v[220:223], v[72:75]
    v_mfma_f32_16x16x32_bf16 v[76:79], a[144:147], v[208:211], 0
    v_mfma_f32_16x16x32_bf16 v[76:79], a[148:151], v[212:215], v[76:79]
    v_mfma_f32_16x16x32_bf16 v[76:79], a[152:155], v[216:219], v[76:79]
    v_mfma_f32_16x16x32_bf16 v[76:79], a[156:159], v[220:223], v[76:79]
    v_mfma_f32_16x16x32_bf16 v[80:83], a[128:131], v[224:227], 0
    v_mfma_f32_16x16x32_bf16 v[80:83], a[132:135], v[228:231], v[80:83]
    v_mfma_f32_16x16x32_bf16 v[80:83], a[136:139], v[232:235], v[80:83]
    v_mfma_f32_16x16x32_bf16 v[80:83], a[140:143], v[236:239], v[80:83]
    v_mfma_f32_16x16x32_bf16 v[84:87], a[144:147], v[224:227], 0
    v_mfma_f32_16x16x32_bf16 v[84:87], a[148:151], v[228:231], v[84:87]
    v_mfma_f32_16x16x32_bf16 v[84:87], a[152:155], v[232:235], v[84:87]
    v_mfma_f32_16x16x32_bf16 v[84:87], a[156:159], v[236:239], v[84:87]
    s_nop 7
    v_max3_f32 v160, v160, v64, v65
    v_max3_f32 v160, v160, v66, v67
    v_max3_f32 v160, v160, v68, v69
    v_max3_f32 v160, v160, v70, v71
    v_max3_f32 v164, v164, v72, v73
    v_max3_f32 v164, v164, v74, v75
    v_max3_f32 v164, v164, v76, v77
    v_max3_f32 v164, v164, v78, v79
    v_max3_f32 v168, v168, v80, v81
    v_max3_f32 v168, v168, v82, v83
    v_max3_f32 v168, v168, v84, v85
    v_max3_f32 v168, v168, v86, v87
    ds_read_b128 a[128:131], v2 offset:8192
    ds_read_b128 a[132:135], v3 offset:8192
    ds_read_b128 a[136:139], v4 offset:8192
    ds_read_b128 a[140:143], v5 offset:8192
    ds_read_b128 a[144:147], v2 offset:12288
    ds_read_b128 a[148:151], v3 offset:12288
    ds_read_b128 a[152:155], v4 offset:12288
    ds_read_b128 a[156:159], v5 offset:12288
    s_waitcnt lgkmcnt(0)
    v_mfma_f32_16x16x32_bf16 v[96:99], a[128:131], v[192:195], 0
    v_mfma_f32_16x16x32_bf16 v[96:99], a[132:135], v[196:199], v[96:99]
    v_mfma_f32_16x16x32_bf16 v[96:99], a[136:139], v[200:203], v[96:99]
    v_mfma_f32_16x16x32_bf16 v[96:99], a[140:143], v[204:207], v[96:99]
    v_mfma_f32_16x16x32_bf16 v[100:103], a[144:147], v[192:195], 0
    v_mfma_f32_16x16x32_bf16 v[100:103], a[148:151], v[196:199], v[100:103]
    v_mfma_f32_16x16x32_bf16 v[100:103], a[152:155], v[200:203], v[100:103]
    v_mfma_f32_16x16x32_bf16 v[100:103], a[156:159], v[204:207], v[100:103]
    v_mfma_f32_16x16x32_bf16 v[104:107], a[128:131], v[208:211], 0
    v_mfma_f32_16x16x32_bf16 v[104:107], a[132:135], v[212:215], v[104:107]
    v_mfma_f32_16x16x32_bf16 v[104:107], a[136:139], v[216:219], v[104:107]
    v_mfma_f32_16x16x32_bf16 v[104:107], a[140:143], v[220:223], v[104:107]
    v_mfma_f32_16x16x32_bf16 v[108:111], a[144:147], v[208:211], 0
    v_mfma_f32_16x16x32_bf16 v[108:111], a[148:151], v[212:215], v[108:111]
    v_mfma_f32_16x16x32_bf16 v[108:111], a[152:155], v[216:219], v[108:111]
    v_mfma_f32_16x16x32_bf16 v[108:111], a[156:159], v[220:223], v[108:111]
    v_mfma_f32_16x16x32_bf16 v[112:115], a[128:131], v[224:227], 0
    v_mfma_f32_16x16x32_bf16 v[112:115], a[132:135], v[228:231], v[112:115]
    v_mfma_f32_16x16x32_bf16 v[112:115], a[136:139], v[232:235], v[112:115]
    v_mfma_f32_16x16x32_bf16 v[112:115], a[140:143], v[236:239], v[112:115]
    v_mfma_f32_16x16x32_bf16 v[116:119], a[144:147], v[224:227], 0
    v_mfma_f32_16x16x32_bf16 v[116:119], a[148:151], v[228:231], v[116:119]
    v_mfma_f32_16x16x32_bf16 v[116:119], a[152:155], v[232:235], v[116:119]
    v_mfma_f32_16x16x32_bf16 v[116:119], a[156:159], v[236:239], v[116:119]
    s_nop 7
    v_max3_f32 v160, v160, v96, v97
    v_max3_f32 v160, v160, v98, v99
    v_max3_f32 v160, v160, v100, v101
    v_max3_f32 v160, v160, v102, v103
    v_max3_f32 v164, v164, v104, v105
    v_max3_f32 v164, v164, v106, v107
    v_max3_f32 v164, v164, v108, v109
    v_max3_f32 v164, v164, v110, v111
    v_max3_f32 v168, v168, v112, v113
    v_max3_f32 v168, v168, v114, v115
    v_max3_f32 v168, v168, v116, v117
    v_max3_f32 v168, v168, v118, v119
    s_add_u32 s45, s45, 16384
    s_sub_u32 s53, s53, 1
    s_cmp_lg_u32 s53, 0
    s_cbranch_scc1 L_fb_loop_q3
    v_mov_b32 v24, v160
    v_mov_b32 v25, v164
    v_mov_b32 v26, v168
    s_nop 1
    v_permlane32_swap_b32 v24, v160
    v_permlane32_swap_b32 v25, v164
    v_permlane32_swap_b32 v26, v168
    s_nop 1
    v_max_f32 v160, v160, v24
    v_max_f32 v164, v164, v25
    v_max_f32 v168, v168, v26
    v_mov_b32 v24, v160
    v_mov_b32 v25, v164
    v_mov_b32 v26, v168
    s_nop 1
    v_permlane16_swap_b32 v24, v160
    v_permlane16_swap_b32 v25, v164
    v_permlane16_swap_b32 v26, v168
    s_nop 1
    v_max_f32 v160, v160, v24
    v_max_f32 v164, v164, v25
    v_max_f32 v168, v168, v26
    v_sub_f32 v163, 0, v160
    v_sub_f32 v162, 0, v160
    v_sub_f32 v161, 0, v160
    v_sub_f32 v160, 0, v160
    v_sub_f32 v167, 0, v164
    v_sub_f32 v166, 0, v164
    v_sub_f32 v165, 0, v164
    v_sub_f32 v164, 0, v164
    v_sub_f32 v171, 0, v168
    v_sub_f32 v170, 0, v168
    v_sub_f32 v169, 0, v168
    v_sub_f32 v168, 0, v168
    s_barrier
    s_add_u32 s46, s54, 0
    s_add_u32 m0, s54, 49152
    s_nop 0
    buffer_load_dwordx4 v14, s[12:15], s46 offen offset:0 nt lds
    buffer_load_dwordx4 v15, s[12:15], s46 offen offset:1024 nt lds
    buffer_load_dwordx4 v14, s[12:15], s46 offen offset:2048 nt lds
    buffer_load_dwordx4 v15, s[12:15], s46 offen offset:3072 nt lds
    s_add_u32 s46, s54, 16384
    s_add_u32 m0, s54, 65536
    s_nop 0
    buffer_load_dwordx4 v14, s[12:15], s46 offen offset:0 nt lds
    buffer_load_dwordx4 v15, s[12:15], s46 offen offset:1024 nt lds
    buffer_load_dwordx4 v14, s[12:15], s46 offen offset:2048 nt lds
    buffer_load_dwordx4 v15, s[12:15], s46 offen offset:3072 nt lds
    s_add_u32 s46, s54, 0
    s_add_u32 m0, s54, 147456
    s_nop 0
    buffer_load_dwordx4 v14, s[16:19], s46 offen offset:0 nt lds
    buffer_load_dwordx4 v15, s[16:19], s46 offen offset:1024 nt lds
    buffer_load_dwordx4 v14, s[16:19], s46 offen offset:2048 nt lds
    buffer_load_dwordx4 v15, s[16:19], s46 offen offset:3072 nt lds
    s_add_u32 s46, s54, 32768
    s_add_u32 m0, s54, 0
    s_nop 0
    buffer_load_dwordx4 v14, s[12:15], s46 offen offset:0 nt lds
    buffer_load_dwordx4 v15, s[12:15], s46 offen offset:1024 nt lds
    buffer_load_dwordx4 v14, s[12:15], s46 offen offset:2048 nt lds
    buffer_load_dwordx4 v15, s[12:15], s46 offen offset:3072 nt lds
    s_add_u32 s46, s54, 16384
    s_add_u32 m0, s54, 81920
    s_nop 0
    buffer_load_dwordx4 v14, s[16:19], s46 offen offset:0 nt lds
    buffer_load_dwordx4 v15, s[16:19], s46 offen offset:1024 nt lds
    buffer_load_dwordx4 v14, s[16:19], s46 offen offset:2048 nt lds
    buffer_load_dwordx4 v15, s[16:19], s46 offen offset:3072 nt lds
    s_add_u32 s46, s54, 49152
    s_add_u32 m0, s54, 16384
    s_nop 0
    buffer_load_dwordx4 v14, s[12:15], s46 offen offset:0 nt lds
    buffer_load_dwordx4 v15, s[12:15], s46 offen offset:1024 nt lds
    buffer_load_dwordx4 v14, s[12:15], s46 offen offset:2048 nt lds
    buffer_load_dwordx4 v15, s[12:15], s46 offen offset:3072 nt lds
    s_add_u32 s46, s54, 32768
    s_add_u32 m0, s54, 98304
    s_nop 0
    buffer_load_dwordx4 v14, s[16:19], s46 offen offset:0 nt lds
    buffer_load_dwordx4 v15, s[16:19], s46 offen offset:1024 nt lds
    buffer_load_dwordx4 v14, s[16:19], s46 offen offset:2048 nt lds
    buffer_load_dwordx4 v15, s[16:19], s46 offen offset:3072 nt lds
    s_add_u32 s46, s54, 65536
    s_add_u32 m0, s54, 32768
    s_nop 0
    buffer_load_dwordx4 v14, s[12:15], s46 offen offset:0 nt lds
    buffer_load_dwordx4 v15, s[12:15], s46 offen offset:1024 nt lds
    buffer_load_dwordx4 v14, s[12:15], s46 offen offset:2048 nt lds
    buffer_load_dwordx4 v15, s[12:15], s46 offen offset:3072 nt lds
    s_add_u32 s46, s54, 49152
    s_add_u32 m0, s54, 114688
    s_nop 0
    buffer_load_dwordx4 v14, s[16:19], s46 offen offset:0 nt lds
    buffer_load_dwordx4 v15, s[16:19], s46 offen offset:1024 nt lds
    buffer_load_dwordx4 v14, s[16:19], s46 offen offset:2048 nt lds
    buffer_load_dwordx4 v15, s[16:19], s46 offen offset:3072 nt lds
    v_accvgpr_write_b32 a0, 0
    v_accvgpr_write_b32 a1, 0
    v_accvgpr_write_b32 a2, 0
    v_accvgpr_write_b32 a3, 0
    v_accvgpr_write_b32 a4, 0
    v_accvgpr_write_b32 a5, 0
    v_accvgpr_write_b32 a6, 0
    v_accvgpr_write_b32 a7, 0
    v_accvgpr_write_b32 a8, 0
    v_accvgpr_write_b32 a9, 0
    v_accvgpr_write_b32 a10, 0
    v_accvgpr_write_b32 a11, 0
    v_accvgpr_write_b32 a12, 0
    v_accvgpr_write_b32 a13, 0
    v_accvgpr_write_b32 a14, 0
    v_accvgpr_write_b32 a15, 0
    v_accvgpr_write_b32 a16, 0
    v_accvgpr_write_b32 a17, 0
    v_accvgpr_write_b32 a18, 0
    v_accvgpr_write_b32 a19, 0
    v_accvgpr_write_b32 a20, 0
    v_accvgpr_write_b32 a21, 0
    v_accvgpr_write_b32 a22, 0
    v_accvgpr_write_b32 a23, 0
    v_accvgpr_write_b32 a24, 0
    v_accvgpr_write_b32 a25, 0
    v_accvgpr_write_b32 a26, 0
    v_accvgpr_write_b32 a27, 0
    v_accvgpr_write_b32 a28, 0
    v_accvgpr_write_b32 a29, 0
    v_accvgpr_write_b32 a30, 0
    v_accvgpr_write_b32 a31, 0
    v_accvgpr_write_b32 a32, 0
    v_accvgpr_write_b32 a33, 0
    v_accvgpr_write_b32 a34, 0
    v_accvgpr_write_b32 a35, 0
    v_accvgpr_write_b32 a36, 0
    v_accvgpr_write_b32 a37, 0
    v_accvgpr_write_b32 a38, 0
    v_accvgpr_write_b32 a39, 0
    v_accvgpr_write_b32 a40, 0
    v_accvgpr_write_b32 a41, 0
    v_accvgpr_write_b32 a42, 0
    v_accvgpr_write_b32 a43, 0
    v_accvgpr_write_b32 a44, 0
    v_accvgpr_write_b32 a45, 0
    v_accvgpr_write_b32 a46, 0
    v_accvgpr_write_b32 a47, 0
    v_accvgpr_write_b32 a48, 0
    v_accvgpr_write_b32 a49, 0
    v_accvgpr_write_b32 a50, 0
    v_accvgpr_write_b32 a51, 0
    v_accvgpr_write_b32 a52, 0
    v_accvgpr_write_b32 a53, 0
    v_accvgpr_write_b32 a54, 0
    v_accvgpr_write_b32 a55, 0
    v_accvgpr_write_b32 a56, 0
    v_accvgpr_write_b32 a57, 0
    v_accvgpr_write_b32 a58, 0
    v_accvgpr_write_b32 a59, 0
    v_accvgpr_write_b32 a60, 0
    v_accvgpr_write_b32 a61, 0
    v_accvgpr_write_b32 a62, 0
    v_accvgpr_write_b32 a63, 0
    v_accvgpr_write_b32 a64, 0
    v_accvgpr_write_b32 a65, 0
    v_accvgpr_write_b32 a66, 0
    v_accvgpr_write_b32 a67, 0
    v_accvgpr_write_b32 a68, 0
    v_accvgpr_write_b32 a69, 0
    v_accvgpr_write_b32 a70, 0
    v_accvgpr_write_b32 a71, 0
    v_accvgpr_write_b32 a72, 0
    v_accvgpr_write_b32 a73, 0
    v_accvgpr_write_b32 a74, 0
    v_accvgpr_write_b32 a75, 0
    v_accvgpr_write_b32 a76, 0
    v_accvgpr_write_b32 a77, 0
    v_accvgpr_write_b32 a78, 0
    v_accvgpr_write_b32 a79, 0
    v_accvgpr_write_b32 a80, 0
    v_accvgpr_write_b32 a81, 0
    v_accvgpr_write_b32 a82, 0
    v_accvgpr_write_b32 a83, 0
    v_accvgpr_write_b32 a84, 0
    v_accvgpr_write_b32 a85, 0
    v_accvgpr_write_b32 a86, 0
    v_accvgpr_write_b32 a87, 0
    v_accvgpr_write_b32 a88, 0
    v_accvgpr_write_b32 a89, 0
    v_accvgpr_write_b32 a90, 0
    v_accvgpr_write_b32 a91, 0
    v_accvgpr_write_b32 a92, 0
    v_accvgpr_write_b32 a93, 0
    v_accvgpr_write_b32 a94, 0
    v_accvgpr_write_b32 a95, 0
    v_accvgpr_write_b32 a192, 0
    v_accvgpr_write_b32 a193, 0
    v_accvgpr_write_b32 a194, 0
    v_accvgpr_write_b32 a195, 0
    v_accvgpr_write_b32 a196, 0
    v_accvgpr_write_b32 a197, 0
    v_accvgpr_write_b32 a198, 0
    v_accvgpr_write_b32 a199, 0
    s_mov_b32 s51, 49152
    s_mov_b32 s52, 65536
    s_mov_b32 s58, 65536
    s_mov_b32 s60, 16384
    s_waitcnt vmcnt(0)
    s_barrier
    ds_read_b128 a[128:131], v2 offset:0
    ds_read_b128 a[132:135], v3 offset:0
    ds_read_b128 a[136:139], v4 offset:0
    ds_read_b128 a[140:143], v5 offset:0
    ds_read_b128 a[144:147], v2 offset:4096
    ds_read_b128 a[148:151], v3 offset:4096
    ds_read_b128 a[152:155], v4 offset:4096
    ds_read_b128 a[156:159], v5 offset:4096
    s_waitcnt lgkmcnt(0)
    v_mfma_f32_16x16x32_bf16 v[64:67], a[128:131], v[192:195], v[160:163]
    v_mfma_f32_16x16x32_bf16 v[64:67], a[132:135], v[196:199], v[64:67]
    v_mfma_f32_16x16x32_bf16 v[64:67], a[136:139], v[200:203], v[64:67]
    v_mfma_f32_16x16x32_bf16 v[64:67], a[140:143], v[204:207], v[64:67]
    v_mfma_f32_16x16x32_bf16 v[68:71], a[144:147], v[192:195], v[160:163]
    v_mfma_f32_16x16x32_bf16 v[68:71], a[148:151], v[196:199], v[68:71]
    v_mfma_f32_16x16x32_bf16 v[68:71], a[152:155], v[200:203], v[68:71]
    v_mfma_f32_16x16x32_bf16 v[68:71], a[156:159], v[204:207], v[68:71]
    v_mfma_f32_16x16x32_bf16 v[72:75], a[128:131], v[208:211], v[164:167]
    v_mfma_f32_16x16x32_bf16 v[72:75], a[132:135], v[212:215], v[72:75]
    v_mfma_f32_16x16x32_bf16 v[72:75], a[136:139], v[216:219], v[72:75]
    v_mfma_f32_16x16x32_bf16 v[72:75], a[140:143], v[220:223], v[72:75]
    v_mfma_f32_16x16x32_bf16 v[76:79], a[144:147], v[208:211], v[164:167]
    v_mfma_f32_16x16x32_bf16 v[76:79], a[148:151], v[212:215], v[76:79]
    v_mfma_f32_16x16x32_bf16 v[76:79], a[152:155], v[216:219], v[76:79]
    v_mfma_f32_16x16x32_bf16 v[76:79], a[156:159], v[220:223], v[76:79]
    v_mfma_f32_16x16x32_bf16 v[80:83], a[128:131], v[224:227], v[168:171]
    v_mfma_f32_16x16x32_bf16 v[80:83], a[132:135], v[228:231], v[80:83]
    v_mfma_f32_16x16x32_bf16 v[80:83], a[136:139], v[232:235], v[80:83]
    v_mfma_f32_16x16x32_bf16 v[80:83], a[140:143], v[236:239], v[80:83]
    v_mfma_f32_16x16x32_bf16 v[84:87], a[144:147], v[224:227], v[168:171]
    v_mfma_f32_16x16x32_bf16 v[84:87], a[148:151], v[228:231], v[84:87]
    v_mfma_f32_16x16x32_bf16 v[84:87], a[152:155], v[232:235], v[84:87]
    v_mfma_f32_16x16x32_bf16 v[84:87], a[156:159], v[236:239], v[84:87]
    s_nop 7
    s_branch L_attn_q3
L_dqwait_p:
    s_bitcmp1_b32 s52, 12
    s_cselect_b64 s[4:5], s[16:17], s[20:21]
    s_cselect_b32 s6, s18, s22
    s_cselect_b32 s59, 77824, 0
    s_add_u32 m0, s51, s59
    s_andn2_b32 s59, s52, 4096
    s_getreg_b32 s47, hwreg(HW_REG_IB_STS, 0, 24)
    s_and_b32 s47, s47, 0xc0000f
    s_cmp_le_u32 s47, 8388613
    s_cselect_b32 s47, s58, 0
    s_cmp_lt_u32 s52, s47
    s_cbranch_scc0 L_dq_p_slow
    buffer_load_dwordx4 v14, s[4:7], s59 offen offset:0 nt lds
    buffer_load_dwordx4 v15, s[4:7], s59 offen offset:1024 nt lds
    buffer_load_dwordx4 v14, s[4:7], s59 offen offset:2048 nt lds
    buffer_load_dwordx4 v15, s[4:7], s59 offen offset:3072 nt lds
    s_add_u32 m0, m0, 4096
    s_add_u32 s59, s59, 4096
    buffer_load_dwordx4 v14, s[4:7], s59 offen offset:0 nt lds
    buffer_load_dwordx4 v15, s[4:7], s59 offen offset:1024 nt lds
    buffer_load_dwordx4 v14, s[4:7], s59 offen offset:2048 nt lds
    buffer_load_dwordx4 v15, s[4:7], s59 offen offset:3072 nt lds
    s_add_u32 s52, s52, 4096
    s_add_u32 s51, s51, 4096
L_dq_p_slow:
    s_cmp_eq_u32 s51, 81920
    s_cselect_b32 s51, 0, s51
    s_getreg_b32 s47, hwreg(HW_REG_IB_STS, 0, 24)
    s_lshr_b32 s59, s47, 22
    s_and_b32 s47, s47, 15
    s_lshl4_add_u32 s47, s59, s47
    s_lshl_b32 s47, s47, 9
    s_add_u32 s47, s47, s60
    s_cmp_le_u32 s47, s52
    s_cbranch_scc0 L_dqwait_p
    s_branch L_dqok_p
L_dqwait_l:
    s_bitcmp1_b32 s52, 12
    s_cselect_b64 s[4:5], s[16:17], s[20:21]
    s_cselect_b32 s6, s18, s22
    s_cselect_b32 s59, 77824, 0
    s_add_u32 m0, s51, s59
    s_andn2_b32 s59, s52, 4096
    s_getreg_b32 s47, hwreg(HW_REG_IB_STS, 0, 24)
    s_and_b32 s47, s47, 0xc0000f
    s_cmp_le_u32 s47, 8388613
    s_cselect_b32 s47, s58, 0
    s_cmp_lt_u32 s52, s47
    s_cbranch_scc0 L_dq_l_slow
    buffer_load_dwordx4 v14, s[4:7], s59 offen offset:0 nt lds
    buffer_load_dwordx4 v15, s[4:7], s59 offen offset:1024 nt lds
    buffer_load_dwordx4 v14, s[4:7], s59 offen offset:2048 nt lds
    buffer_load_dwordx4 v15, s[4:7], s59 offen offset:3072 nt lds
    s_add_u32 m0, m0, 4096
    s_add_u32 s59, s59, 4096
    buffer_load_dwordx4 v14, s[4:7], s59 offen offset:0 nt lds
    buffer_load_dwordx4 v15, s[4:7], s59 offen offset:1024 nt lds
    buffer_load_dwordx4 v14, s[4:7], s59 offen offset:2048 nt lds
    buffer_load_dwordx4 v15, s[4:7], s59 offen offset:3072 nt lds
    s_add_u32 s52, s52, 4096
    s_add_u32 s51, s51, 4096
L_dq_l_slow:
    s_cmp_eq_u32 s51, 81920
    s_cselect_b32 s51, 0, s51
    s_getreg_b32 s47, hwreg(HW_REG_IB_STS, 0, 24)
    s_lshr_b32 s59, s47, 22
    s_and_b32 s47, s47, 15
    s_lshl4_add_u32 s47, s59, s47
    s_lshl_b32 s47, s47, 9
    s_add_u32 s47, s47, s60
    s_cmp_le_u32 s47, s52
    s_cbranch_scc0 L_dqwait_l
    s_branch L_dqok_l
L_dqwait_m:
    s_bitcmp1_b32 s52, 12
    s_cselect_b64 s[4:5], s[16:17], s[20:21]
    s_cselect_b32 s6, s18, s22
    s_cselect_b32 s59, 77824, 0
    s_add_u32 m0, s51, s59
    s_andn2_b32 s59, s52, 4096
    s_getreg_b32 s47, hwreg(HW_REG_IB_STS, 0, 24)
    s_and_b32 s47, s47, 0xc0000f
    s_cmp_le_u32 s47, 8388613
    s_cselect_b32 s47, s58, 0
    s_cmp_lt_u32 s52, s47
    s_cbranch_scc0 L_dq_m_slow
    buffer_load_dwordx4 v14, s[4:7], s59 offen offset:0 nt lds
    buffer_load_dwordx4 v15, s[4:7], s59 offen offset:1024 nt lds
    buffer_load_dwordx4 v14, s[4:7], s59 offen offset:2048 nt lds
    buffer_load_dwordx4 v15, s[4:7], s59 offen offset:3072 nt lds
    s_add_u32 m0, m0, 4096
    s_add_u32 s59, s59, 4096
    buffer_load_dwordx4 v14, s[4:7], s59 offen offset:0 nt lds
    buffer_load_dwordx4 v15, s[4:7], s59 offen offset:1024 nt lds
    buffer_load_dwordx4 v14, s[4:7], s59 offen offset:2048 nt lds
    buffer_load_dwordx4 v15, s[4:7], s59 offen offset:3072 nt lds
    s_add_u32 s52, s52, 4096
    s_add_u32 s51, s51, 4096
L_dq_m_slow:
    s_cmp_eq_u32 s51, 81920
    s_cselect_b32 s51, 0, s51
    s_getreg_b32 s47, hwreg(HW_REG_IB_STS, 0, 24)
    s_lshr_b32 s59, s47, 22
    s_and_b32 s47, s47, 15
    s_lshl4_add_u32 s47, s59, s47
    s_lshl_b32 s47, s47, 9
    s_add_u32 s47, s47, s60
    s_cmp_le_u32 s47, s52
    s_cbranch_scc0 L_dqwait_m
    s_branch L_dqok_m
.fill 900, 4, 0xbf800000
L_text_end:
.section .rodata,"a"
.p2align 6
.amdhsa_kernel standalone__mha_block_cached__near_ridge_kernel
  .amdhsa_next_free_vgpr 512
  .amdhsa_next_free_sgpr 102
  .amdhsa_accum_offset 256
  .amdhsa_group_segment_fixed_size 0
  .amdhsa_kernarg_size 64
  .amdhsa_user_sgpr_count 2
  .amdhsa_user_sgpr_kernarg_segment_ptr 1
  .amdhsa_system_sgpr_workgroup_id_x 1
  .amdhsa_float_denorm_mode_32 3
.end_amdhsa_kernel
```
